```python
import torch

def _softmax(x, axis=-1):
    return torch.softmax(x, dim=axis)

def _gelu(x):
    return torch.nn.functional.gelu(x, approximate='tanh')

def _silu(x):
    return torch.nn.functional.silu(x)

def _sigmoid(x):
    return torch.sigmoid(x)

def _layernorm(x, axis=-1, eps=1e-05):
    m = x.mean(dim=axis, keepdim=True)
    v = x.var(dim=axis, keepdim=True, unbiased=False)
    return (x - m) / torch.sqrt(v + eps)

def _scatter_add(tgt, idx, src, axis=0):
    return tgt.clone().index_add_(axis, idx, src)

def _segment_sum(src, seg, n):
    out = torch.zeros((n,) + src.shape[1:], dtype=src.dtype)
    return out.index_add_(0, seg, src)

def _pad(x, pw):
    flat = tuple((v for pair in reversed(pw) for v in pair))
    return torch.nn.functional.pad(x, flat)
kernel_name = 'concat_heads__memory_aug_recurrent_mem_tr__linear_attn_block__prompt'

def setup_inputs():

    _w = lambda a: (lambda t: t.to(torch.bfloat16) if t.is_floating_point() else t)(torch.as_tensor(a))

    def _A_setup():
        B, S, Dm = (1, 2048, 640)
        H, Dh = (32, 128)
        M, seg = (8, 32)
        seg = min(seg, S)
        S = S // seg * seg
        return {'x': _w((lambda *s: torch.randn(*s, dtype=torch.bfloat16) * 0.05)(B, S, Dm)), 'mem0': _w((lambda *s: torch.randn(*s, dtype=torch.bfloat16) * 0.8)(B, M, Dm)), 'Wq': _w((lambda *s: torch.randn(*s, dtype=torch.bfloat16) * 1.6)(Dm, H, Dh) * Dm ** (-0.5)), 'Wk': _w((lambda *s: torch.randn(*s, dtype=torch.bfloat16) * 1.6)(Dm, H, Dh) * Dm ** (-0.5)), 'Wv': _w((lambda *s: torch.randn(*s, dtype=torch.bfloat16) * 0.8)(Dm, H, Dh) * Dm ** (-0.5)), 'Wo': _w((lambda *s: torch.randn(*s, dtype=torch.bfloat16) * 0.8)(H, Dh, Dm) * (H * Dh) ** (-0.5)), 'seg_len': seg}
    _A_in = _A_setup()

    def _B_setup():
        B, S, D = (1, 2048, 640)
        return {'x': _w((lambda *s: torch.randn(*s, dtype=torch.bfloat16) * 0.05)(B, S, D)), 'wqkv': _w((lambda *s: torch.randn(*s, dtype=torch.bfloat16) * 1.6)(D, 3 * D)), 'wo': _w((lambda *s: torch.randn(*s, dtype=torch.bfloat16) * 0.1)(D, D))}
    _B_in = _B_setup()
    return {'A_x': _A_in['x'], 'A_mem0': _A_in['mem0'], 'A_Wq': _A_in['Wq'], 'A_Wk': _A_in['Wk'], 'A_Wv': _A_in['Wv'], 'A_Wo': _A_in['Wo'], 'A_seg_len': _A_in['seg_len'], 'B_x': _B_in['x'], 'B_wqkv': _B_in['wqkv'], 'B_wo': _B_in['wo']}

def reference(A_x, A_mem0, A_Wq, A_Wk, A_Wv, A_Wo, A_seg_len, B_x, B_wqkv, B_wo):

    def _A_ref(x, mem0, Wq, Wk, Wv, Wo, seg_len):
        B, S, Dm = x.shape
        H, Dh = (Wq.shape[1], Wq.shape[2])
        M = mem0.shape[1]
        scale = Dh ** (-0.5)
        n_seg = S // seg_len
        L = M + seg_len
        idx = torch.arange(L)
        mask = (idx[:, None] < M) | (idx[:, None] >= idx[None, :])
        mem = mem0
        outs = []
        for s in range(n_seg):
            xs = x[:, s * seg_len:(s + 1) * seg_len, :].clone()
            h = torch.concatenate([mem, xs], axis=1)
            q = torch.einsum('btd,dhe->bhte', h, Wq)
            k = torch.einsum('btd,dhe->bhte', h, Wk)
            v = torch.einsum('btd,dhe->bhte', h, Wv)
            scores = torch.einsum('bhqe,bhke->bhqk', q, k) * scale
            scores = torch.where(mask[None, None], scores, -1000000000.0)
            p = _softmax(scores, axis=-1)
            o = torch.einsum('bhqk,bhke->bhqe', p, v)
            o = torch.einsum('bhte,hed->btd', o, Wo)
            mem = o[:, :M, :].clone()
            outs.append(o[:, M:, :])
        return torch.concatenate(outs, axis=1)

    def _B_ref(x, wqkv, wo):
        B, S, D = x.shape
        H = 32
        Dh = D // H
        qkv = (lambda x, *d: x.permute(*d))((x @ wqkv).reshape(B, S, 3, H, Dh), 2, 0, 3, 1, 4)
        q, k, v = (qkv[0], qkv[1], qkv[2])
        phi = lambda t: torch.where(t > 0, t + 1, torch.exp(t)) + 1e-06
        pq, pk = (phi(q), phi(k))
        kv = torch.einsum('bhsd,bhse->bhde', pk, v)
        z = torch.einsum('bhsd->bhd', pk)
        num = torch.einsum('bhqd,bhde->bhqe', pq, kv)
        den = torch.einsum('bhqd,bhd->bhq', pq, z)[..., None] + 1e-06
        o = num / den
        return (lambda x, *d: x.permute(*d))(o, 0, 2, 1, 3).reshape(B, S, D) @ wo
    a = _A_ref(A_x, A_mem0, A_Wq, A_Wk, A_Wv, A_Wo, A_seg_len)
    b = _B_ref(B_x, B_wqkv, B_wo)
    return torch.concatenate([a, b], axis=-1)
```

```asm
; @launch grid=(256,1,1) block=(256,1,1) lds=163840
.amdgcn_target "amdgcn-amd-amdhsa--gfx950"
.text
.globl concat_heads__memory_aug_recurrent_mem_tr__linear_attn_block__prompt_kernel
.p2align 8
.type concat_heads__memory_aug_recurrent_mem_tr__linear_attn_block__prompt_kernel,@function
concat_heads__memory_aug_recurrent_mem_tr__linear_attn_block__prompt_kernel:
    s_cmp_ge_u32 s2, 256
    s_cbranch_scc1 k_exit
    s_load_dwordx8 s[4:11], s[0:1], 0
    s_load_dwordx4 s[12:15], s[0:1], 32
    s_load_dwordx8 s[16:23], s[0:1], 56
    s_load_dwordx4 s[24:27], s[0:1], 88
    v_lshrrev_b32 v1, 6, v0
    s_nop 0
    v_readfirstlane_b32 s28, v1
    v_and_b32 v0, 63, v0
    s_waitcnt lgkmcnt(0)
    s_mov_b32 s3, 0
    s_mov_b32 s98, 0
    s_getreg_b32 s100, hwreg(HW_REG_XCC_ID, 0, 4)
    s_and_b32 s40, s100, 7
    s_lshl_b32 s40, s40, 5
    s_cmp_eq_u32 s28, 0
    s_cbranch_scc0 cen_1
    v_mov_b32 v1, s40
    v_mov_b32 v2, 1
    s_mov_b64 exec, 1
    global_atomic_add v3, v1, v2, s[24:25] sc0 sc1
    s_waitcnt vmcnt(0)
    v_mov_b32 v1, 0
    ds_write_b32 v1, v3
    s_waitcnt lgkmcnt(0)
    s_mov_b64 exec, -1
cen_1:
    s_barrier
    v_mov_b32 v1, 0
    ds_read_b32 v3, v1
    s_waitcnt lgkmcnt(0)
    v_readfirstlane_b32 s101, v3
    s_and_b32 s100, s100, 7
    s_barrier
    s_add_u32 s32, s26, 0x5000000
    s_addc_u32 s33, s27, 0
    s_and_b32 s33, s33, 0xffff
    s_mov_b32 s34, 0xca000
    s_mov_b32 s35, 0x20000
    s_mul_i32 s40, s2, 4096
    s_lshl_b32 s41, s28, 10
    s_add_u32 s40, s40, s41
    v_lshlrev_b32 v1, 4, v0
    v_mov_b32 v4, -1
    v_mov_b32 v5, -1
    v_mov_b32 v6, -1
    v_mov_b32 v7, -1
    buffer_store_dwordx4 v[4:7], v1, s[32:35], s40 offen sc1
    s_add_u32 s40, s40, 4096
    s_add_u32 s32, s26, 0x5c0ffff
    s_addc_u32 s33, s27, 0
    s_and_b32 s32, s32, 0xffff0000
    s_and_b32 s33, s33, 0xffff
    s_mov_b32 s34, 0x400000
    s_mov_b32 s35, 0x20000
    s_add_u32 s42, s2, 0
    s_mul_hi_u32 s43, s42, 715827883
    s_mul_i32 s44, s43, 6
    s_sub_u32 s44, s42, s44
    s_lshl_b32 s45, s44, 12
    s_cmp_ge_u32 s44, 4
    s_sub_u32 s46, s44, 4
    s_lshl_b32 s46, s46, 13
    s_add_u32 s46, s46, 16384
    s_cmp_ge_u32 s44, 4
    s_cselect_b32 s45, s46, s45
    s_lshl_b32 s43, s43, 15
    s_add_u32 s43, s43, s45
    s_add_u32 s43, s43, s41
    buffer_store_dwordx4 v[4:7], v1, s[32:35], s43 offen sc1
    s_add_u32 s42, s2, 256
    s_mul_hi_u32 s43, s42, 715827883
    s_mul_i32 s44, s43, 6
    s_sub_u32 s44, s42, s44
    s_lshl_b32 s45, s44, 12
    s_cmp_ge_u32 s44, 4
    s_sub_u32 s46, s44, 4
    s_lshl_b32 s46, s46, 13
    s_add_u32 s46, s46, 16384
    s_cmp_ge_u32 s44, 4
    s_cselect_b32 s45, s46, s45
    s_lshl_b32 s43, s43, 15
    s_add_u32 s43, s43, s45
    s_add_u32 s43, s43, s41
    buffer_store_dwordx4 v[4:7], v1, s[32:35], s43 offen sc1
    s_add_u32 s42, s2, 512
    s_mul_hi_u32 s43, s42, 715827883
    s_mul_i32 s44, s43, 6
    s_sub_u32 s44, s42, s44
    s_lshl_b32 s45, s44, 12
    s_cmp_ge_u32 s44, 4
    s_sub_u32 s46, s44, 4
    s_lshl_b32 s46, s46, 13
    s_add_u32 s46, s46, 16384
    s_cmp_ge_u32 s44, 4
    s_cselect_b32 s45, s46, s45
    s_lshl_b32 s43, s43, 15
    s_add_u32 s43, s43, s45
    s_add_u32 s43, s43, s41
    buffer_store_dwordx4 v[4:7], v1, s[32:35], s43 offen sc1
    s_add_u32 s36, s26, 0x5500000
    s_addc_u32 s37, s27, 0
    s_and_b32 s37, s37, 0xffff
    s_mov_b32 s38, 0x8000
    s_mov_b32 s39, 0x20000
    s_lshl_b32 s40, s2, 7
    s_lshl_b32 s41, s28, 5
    s_add_u32 s40, s40, s41
    v_lshlrev_b32 v2, 2, v0
    v_mov_b32 v3, 0
    s_mov_b64 exec, 0xff
    buffer_store_dword v3, v2, s[36:39], s40 offen sc1
    s_mov_b64 exec, -1
    s_cmp_ge_u32 s101, 32
    s_cbranch_scc1 k_waitall
    s_cmp_ge_u32 s100, 2
    s_cbranch_scc1 k_worker_spec
    s_mov_b32 s30, s100
    s_mov_b32 s31, s101
    s_lshr_b32 s88, s31, 1
    s_lshl_b32 s84, s30, 4
    s_add_u32 s84, s84, s88
    s_and_b32 s88, s31, 1
    s_lshl_b32 s73, s84, 1
    s_add_u32 s73, s73, s88
    s_mov_b32 s48, s6
    s_mov_b32 s49, s7
    s_and_b32 s49, s49, 0xffff
    s_mov_b32 s50, 0x2800
    s_mov_b32 s51, 0x20000
    s_lshl_b32 s88, s28, 6
    v_add_u32 v16, s88, v0
    v_add_u32 v17, 0, v16
    v_and_b32 v18, 7, v17
    v_mul_u32_u24 v18, 1280, v18
    v_lshrrev_b32_e64 v19, 5, v17
    v_lshl_add_u32 v18, v19, 6, v18
    v_bfe_u32 v19, v17, 3, 2
    v_lshl_add_u32 v18, v19, 3, v18
    buffer_load_dwordx2 v[124:125], v18, s[48:51], 0 offen
    buffer_load_dwordx2 v[126:127], v18, s[48:51], 0 offen offset:32
    v_add_u32 v17, 256, v16
    v_and_b32_e64 v18, 7, v17
    v_mul_u32_u24 v18, 1280, v18
    v_lshrrev_b32_e64 v19, 5, v17
    v_lshl_add_u32 v18, v19, 6, v18
    v_bfe_u32 v19, v17, 3, 2
    v_lshl_add_u32 v18, v19, 3, v18
    buffer_load_dwordx2 v[128:129], v18, s[48:51], 0 offen
    buffer_load_dwordx2 v[130:131], v18, s[48:51], 0 offen offset:32
    v_add_u32 v17, 512, v16
    v_and_b32_e64 v18, 7, v17
    v_mul_u32_u24 v18, 1280, v18
    v_lshrrev_b32_e64 v19, 5, v17
    v_lshl_add_u32 v18, v19, 6, v18
    v_bfe_u32 v19, v17, 3, 2
    v_lshl_add_u32 v18, v19, 3, v18
    buffer_load_dwordx2 v[132:133], v18, s[48:51], 0 offen
    buffer_load_dwordx2 v[134:135], v18, s[48:51], 0 offen offset:32
    s_mov_b32 s44, s8
    s_mov_b32 s45, s9
    s_and_b32 s45, s45, 0xffff
    s_mov_b32 s46, 0x500000
    s_mov_b32 s47, 0x20000
    s_lshl_b32 s94, s73, 7
    v_lshrrev_b32 v16, 5, v0
    s_and_b32 s88, s28, 2
    v_or_b32 v16, s88, v16
    v_lshlrev_b32 v16, 1, v16
    v_and_b32 v17, 7, v0
    v_xor_b32 v16, v16, v17
    v_lshlrev_b32 v16, 4, v16
    v_lshrrev_b32 v17, 3, v0
    v_lshlrev_b32 v17, 13, v17
    v_add_u32 v16, v16, v17
    s_lshl_b32 s88, s28, 16
    s_add_u32 s88, s88, s94
    s_lshl_b32 s89, s28, 10
    s_add_u32 s89, s89, 0
    s_mov_b32 m0, s89
    s_add_u32 s89, s89, 4096
    buffer_load_dwordx4 v16, s[44:47], s88 offen lds
    s_add_u32 s88, s88, 262144
    s_mov_b32 m0, s89
    s_add_u32 s89, s89, 4096
    buffer_load_dwordx4 v16, s[44:47], s88 offen lds
    s_add_u32 s88, s88, 262144
    s_mov_b32 m0, s89
    s_add_u32 s89, s89, 4096
    buffer_load_dwordx4 v16, s[44:47], s88 offen lds
    s_add_u32 s88, s88, 262144
    s_mov_b32 m0, s89
    s_add_u32 s89, s89, 4096
    buffer_load_dwordx4 v16, s[44:47], s88 offen lds
    s_add_u32 s88, s88, 262144
    s_mov_b32 m0, s89
    s_add_u32 s89, s89, 4096
    buffer_load_dwordx4 v16, s[44:47], s88 offen lds
    s_add_u32 s88, s88, 262144
    s_mov_b32 m0, s89
    s_add_u32 s89, s89, 4096
    buffer_load_dwordx4 v16, s[44:47], s88 offen lds
    s_add_u32 s88, s88, 262144
    s_mov_b32 m0, s89
    s_add_u32 s89, s89, 4096
    buffer_load_dwordx4 v16, s[44:47], s88 offen lds
    s_add_u32 s88, s88, 262144
    s_mov_b32 m0, s89
    s_add_u32 s89, s89, 4096
    buffer_load_dwordx4 v16, s[44:47], s88 offen lds
    s_add_u32 s88, s88, 262144
    s_mov_b32 m0, s89
    s_add_u32 s89, s89, 4096
    buffer_load_dwordx4 v16, s[44:47], s88 offen lds
    s_add_u32 s88, s88, 262144
    s_mov_b32 m0, s89
    s_add_u32 s89, s89, 4096
    buffer_load_dwordx4 v16, s[44:47], s88 offen lds
    s_add_u32 s88, s88, 262144
    s_mov_b32 s44, s8
    s_mov_b32 s45, s9
    s_and_b32 s45, s45, 0xffff
    s_mov_b32 s46, 0x500000
    s_mov_b32 s47, 0x20000
    s_lshl_b32 s94, s73, 7
    s_add_u32 s94, s94, 2621440
    v_lshrrev_b32 v16, 5, v0
    s_and_b32 s88, s28, 2
    v_or_b32 v16, s88, v16
    v_lshlrev_b32 v16, 1, v16
    v_and_b32 v17, 7, v0
    v_xor_b32 v16, v16, v17
    v_lshlrev_b32 v16, 4, v16
    v_lshrrev_b32 v17, 3, v0
    v_lshlrev_b32 v17, 13, v17
    v_add_u32 v16, v16, v17
    s_lshl_b32 s88, s28, 16
    s_add_u32 s88, s88, s94
    s_lshl_b32 s89, s28, 10
    s_add_u32 s89, s89, 40960
    s_mov_b32 m0, s89
    s_add_u32 s89, s89, 4096
    buffer_load_dwordx4 v16, s[44:47], s88 offen lds
    s_add_u32 s88, s88, 262144
    s_mov_b32 m0, s89
    s_add_u32 s89, s89, 4096
    buffer_load_dwordx4 v16, s[44:47], s88 offen lds
    s_add_u32 s88, s88, 262144
    s_mov_b32 m0, s89
    s_add_u32 s89, s89, 4096
    buffer_load_dwordx4 v16, s[44:47], s88 offen lds
    s_add_u32 s88, s88, 262144
    s_mov_b32 m0, s89
    s_add_u32 s89, s89, 4096
    buffer_load_dwordx4 v16, s[44:47], s88 offen lds
    s_add_u32 s88, s88, 262144
    s_mov_b32 m0, s89
    s_add_u32 s89, s89, 4096
    buffer_load_dwordx4 v16, s[44:47], s88 offen lds
    s_add_u32 s88, s88, 262144
    s_mov_b32 m0, s89
    s_add_u32 s89, s89, 4096
    buffer_load_dwordx4 v16, s[44:47], s88 offen lds
    s_add_u32 s88, s88, 262144
    s_mov_b32 m0, s89
    s_add_u32 s89, s89, 4096
    buffer_load_dwordx4 v16, s[44:47], s88 offen lds
    s_add_u32 s88, s88, 262144
    s_mov_b32 m0, s89
    s_add_u32 s89, s89, 4096
    buffer_load_dwordx4 v16, s[44:47], s88 offen lds
    s_add_u32 s88, s88, 262144
    s_mov_b32 m0, s89
    s_add_u32 s89, s89, 4096
    buffer_load_dwordx4 v16, s[44:47], s88 offen lds
    s_add_u32 s88, s88, 262144
    s_mov_b32 m0, s89
    s_add_u32 s89, s89, 4096
    buffer_load_dwordx4 v16, s[44:47], s88 offen lds
    s_add_u32 s88, s88, 262144
    s_mov_b32 s44, s10
    s_mov_b32 s45, s11
    s_and_b32 s45, s45, 0xffff
    s_mov_b32 s46, 0x500000
    s_mov_b32 s47, 0x20000
    s_lshl_b32 s94, s73, 7
    v_lshrrev_b32 v16, 5, v0
    s_and_b32 s88, s28, 2
    v_or_b32 v16, s88, v16
    v_lshlrev_b32 v16, 1, v16
    v_and_b32 v17, 7, v0
    v_xor_b32 v16, v16, v17
    v_lshlrev_b32 v16, 4, v16
    v_lshrrev_b32 v17, 3, v0
    v_lshlrev_b32 v17, 13, v17
    v_add_u32 v16, v16, v17
    s_lshl_b32 s88, s28, 16
    s_add_u32 s88, s88, s94
    s_lshl_b32 s89, s28, 10
    s_add_u32 s89, s89, 81920
    s_mov_b32 m0, s89
    s_add_u32 s89, s89, 4096
    buffer_load_dwordx4 v16, s[44:47], s88 offen lds
    s_add_u32 s88, s88, 262144
    s_mov_b32 m0, s89
    s_add_u32 s89, s89, 4096
    buffer_load_dwordx4 v16, s[44:47], s88 offen lds
    s_add_u32 s88, s88, 262144
    s_mov_b32 m0, s89
    s_add_u32 s89, s89, 4096
    buffer_load_dwordx4 v16, s[44:47], s88 offen lds
    s_add_u32 s88, s88, 262144
    s_mov_b32 m0, s89
    s_add_u32 s89, s89, 4096
    buffer_load_dwordx4 v16, s[44:47], s88 offen lds
    s_add_u32 s88, s88, 262144
    s_mov_b32 m0, s89
    s_add_u32 s89, s89, 4096
    buffer_load_dwordx4 v16, s[44:47], s88 offen lds
    s_add_u32 s88, s88, 262144
    s_mov_b32 m0, s89
    s_add_u32 s89, s89, 4096
    buffer_load_dwordx4 v16, s[44:47], s88 offen lds
    s_add_u32 s88, s88, 262144
    s_mov_b32 m0, s89
    s_add_u32 s89, s89, 4096
    buffer_load_dwordx4 v16, s[44:47], s88 offen lds
    s_add_u32 s88, s88, 262144
    s_mov_b32 m0, s89
    s_add_u32 s89, s89, 4096
    buffer_load_dwordx4 v16, s[44:47], s88 offen lds
    s_add_u32 s88, s88, 262144
    s_mov_b32 m0, s89
    s_add_u32 s89, s89, 4096
    buffer_load_dwordx4 v16, s[44:47], s88 offen lds
    s_add_u32 s88, s88, 262144
    s_mov_b32 m0, s89
    s_add_u32 s89, s89, 4096
    buffer_load_dwordx4 v16, s[44:47], s88 offen lds
    s_add_u32 s88, s88, 262144
    s_mov_b32 s44, s10
    s_mov_b32 s45, s11
    s_and_b32 s45, s45, 0xffff
    s_mov_b32 s46, 0x500000
    s_mov_b32 s47, 0x20000
    s_lshl_b32 s94, s73, 7
    s_add_u32 s94, s94, 2621440
    v_lshrrev_b32 v16, 5, v0
    s_and_b32 s88, s28, 2
    v_or_b32 v16, s88, v16
    v_lshlrev_b32 v16, 1, v16
    v_and_b32 v17, 7, v0
    v_xor_b32 v16, v16, v17
    v_lshlrev_b32 v16, 4, v16
    v_lshrrev_b32 v17, 3, v0
    v_lshlrev_b32 v17, 13, v17
    v_add_u32 v16, v16, v17
    s_lshl_b32 s88, s28, 16
    s_add_u32 s88, s88, s94
    s_lshl_b32 s89, s28, 10
    s_add_u32 s89, s89, 122880
    s_mov_b32 m0, s89
    s_add_u32 s89, s89, 4096
    buffer_load_dwordx4 v16, s[44:47], s88 offen lds
    s_add_u32 s88, s88, 262144
    s_mov_b32 m0, s89
    s_add_u32 s89, s89, 4096
    buffer_load_dwordx4 v16, s[44:47], s88 offen lds
    s_add_u32 s88, s88, 262144
    s_mov_b32 m0, s89
    s_add_u32 s89, s89, 4096
    buffer_load_dwordx4 v16, s[44:47], s88 offen lds
    s_add_u32 s88, s88, 262144
    s_mov_b32 m0, s89
    s_add_u32 s89, s89, 4096
    buffer_load_dwordx4 v16, s[44:47], s88 offen lds
    s_add_u32 s88, s88, 262144
    s_mov_b32 m0, s89
    s_add_u32 s89, s89, 4096
    buffer_load_dwordx4 v16, s[44:47], s88 offen lds
    s_add_u32 s88, s88, 262144
    s_mov_b32 m0, s89
    s_add_u32 s89, s89, 4096
    buffer_load_dwordx4 v16, s[44:47], s88 offen lds
    s_add_u32 s88, s88, 262144
    s_mov_b32 m0, s89
    s_add_u32 s89, s89, 4096
    buffer_load_dwordx4 v16, s[44:47], s88 offen lds
    s_add_u32 s88, s88, 262144
    s_mov_b32 m0, s89
    s_add_u32 s89, s89, 4096
    buffer_load_dwordx4 v16, s[44:47], s88 offen lds
    s_add_u32 s88, s88, 262144
    s_mov_b32 m0, s89
    s_add_u32 s89, s89, 4096
    buffer_load_dwordx4 v16, s[44:47], s88 offen lds
    s_add_u32 s88, s88, 262144
    s_mov_b32 m0, s89
    s_add_u32 s89, s89, 4096
    buffer_load_dwordx4 v16, s[44:47], s88 offen lds
    s_add_u32 s88, s88, 262144
    s_waitcnt vmcnt(30)
    s_barrier
    s_cmp_eq_u32 s98, 1
    s_cbranch_scc1 idone_2
    s_mov_b32 s98, 1
    s_cmp_eq_u32 s28, 0
    s_cbranch_scc0 idone_2
    s_lshl_b32 s90, s100, 5
    s_add_u32 s90, s90, 4
    v_mov_b32_e64 v16, s90
    v_mov_b32 v17, 1
    s_mov_b64 exec, 1
    global_atomic_add v16, v17, s[24:25] sc1
    s_mov_b64 exec, -1
idone_2:
    v_bfe_u32 v17, v0, 3, 2
    v_xor_b32 v16, s28, v17
    v_lshlrev_b32_e64 v16, 5, v16
    v_bfe_u32 v17, v0, 4, 1
    v_lshlrev_b32_e64 v17, 4, v17
    v_bfe_u32 v18, v0, 5, 1
    v_lshl_add_u32 v17, v18, 3, v17
    v_bfe_u32 v18, v0, 3, 1
    v_lshl_add_u32 v17, v18, 2, v17
    v_bfe_u32 v18, v0, 2, 1
    v_add_u32 v17, v17, v18
    v_lshlrev_b32 v17, 7, v17
    v_and_b32_e64 v18, 3, v0
    v_lshl_add_u32 v17, v18, 3, v17
    v_add_u32 v16, v16, v17
    v_add_u32 v16, 0, v16
    ds_read_b64_tr_b16 a[0:1], v16 offset:0
    ds_read_b64_tr_b16 a[2:3], v16 offset:256
    ds_read_b64_tr_b16 a[4:5], v16 offset:4096
    ds_read_b64_tr_b16 a[6:7], v16 offset:4352
    ds_read_b64_tr_b16 a[8:9], v16 offset:8192
    ds_read_b64_tr_b16 a[10:11], v16 offset:8448
    ds_read_b64_tr_b16 a[12:13], v16 offset:12288
    ds_read_b64_tr_b16 a[14:15], v16 offset:12544
    ds_read_b64_tr_b16 a[16:17], v16 offset:16384
    ds_read_b64_tr_b16 a[18:19], v16 offset:16640
    ds_read_b64_tr_b16 a[20:21], v16 offset:20480
    ds_read_b64_tr_b16 a[22:23], v16 offset:20736
    s_waitcnt lgkmcnt(0)
    ds_read_b64_tr_b16 a[24:25], v16 offset:24576
    ds_read_b64_tr_b16 a[26:27], v16 offset:24832
    ds_read_b64_tr_b16 a[28:29], v16 offset:28672
    ds_read_b64_tr_b16 a[30:31], v16 offset:28928
    ds_read_b64_tr_b16 a[32:33], v16 offset:32768
    ds_read_b64_tr_b16 a[34:35], v16 offset:33024
    ds_read_b64_tr_b16 a[36:37], v16 offset:36864
    ds_read_b64_tr_b16 a[38:39], v16 offset:37120
    s_waitcnt lgkmcnt(0)
    s_waitcnt lgkmcnt(0)
    s_barrier
    s_mov_b32 s44, s12
    s_mov_b32 s45, s13
    s_and_b32 s45, s45, 0xffff
    s_mov_b32 s46, 0x500000
    s_mov_b32 s47, 0x20000
    s_lshl_b32 s94, s73, 7
    v_lshrrev_b32 v16, 5, v0
    s_and_b32 s88, s28, 2
    v_or_b32 v16, s88, v16
    v_lshlrev_b32 v16, 1, v16
    v_and_b32 v17, 7, v0
    v_xor_b32 v16, v16, v17
    v_lshlrev_b32 v16, 4, v16
    v_lshrrev_b32 v17, 3, v0
    v_lshlrev_b32 v17, 13, v17
    v_add_u32 v16, v16, v17
    s_lshl_b32 s88, s28, 16
    s_add_u32 s88, s88, s94
    s_lshl_b32 s89, s28, 10
    s_add_u32 s89, s89, 0
    s_mov_b32 m0, s89
    s_add_u32 s89, s89, 4096
    buffer_load_dwordx4 v16, s[44:47], s88 offen lds
    s_add_u32 s88, s88, 262144
    s_mov_b32 m0, s89
    s_add_u32 s89, s89, 4096
    buffer_load_dwordx4 v16, s[44:47], s88 offen lds
    s_add_u32 s88, s88, 262144
    s_mov_b32 m0, s89
    s_add_u32 s89, s89, 4096
    buffer_load_dwordx4 v16, s[44:47], s88 offen lds
    s_add_u32 s88, s88, 262144
    s_mov_b32 m0, s89
    s_add_u32 s89, s89, 4096
    buffer_load_dwordx4 v16, s[44:47], s88 offen lds
    s_add_u32 s88, s88, 262144
    s_mov_b32 m0, s89
    s_add_u32 s89, s89, 4096
    buffer_load_dwordx4 v16, s[44:47], s88 offen lds
    s_add_u32 s88, s88, 262144
    s_mov_b32 m0, s89
    s_add_u32 s89, s89, 4096
    buffer_load_dwordx4 v16, s[44:47], s88 offen lds
    s_add_u32 s88, s88, 262144
    s_mov_b32 m0, s89
    s_add_u32 s89, s89, 4096
    buffer_load_dwordx4 v16, s[44:47], s88 offen lds
    s_add_u32 s88, s88, 262144
    s_mov_b32 m0, s89
    s_add_u32 s89, s89, 4096
    buffer_load_dwordx4 v16, s[44:47], s88 offen lds
    s_add_u32 s88, s88, 262144
    s_mov_b32 m0, s89
    s_add_u32 s89, s89, 4096
    buffer_load_dwordx4 v16, s[44:47], s88 offen lds
    s_add_u32 s88, s88, 262144
    s_mov_b32 m0, s89
    s_add_u32 s89, s89, 4096
    buffer_load_dwordx4 v16, s[44:47], s88 offen lds
    s_add_u32 s88, s88, 262144
    s_waitcnt vmcnt(30)
    s_barrier
    v_bfe_u32 v17, v0, 3, 2
    v_xor_b32 v16, s28, v17
    v_lshlrev_b32_e64 v16, 5, v16
    v_bfe_u32 v17, v0, 4, 1
    v_lshlrev_b32_e64 v17, 4, v17
    v_bfe_u32 v18, v0, 5, 1
    v_lshl_add_u32 v17, v18, 3, v17
    v_bfe_u32 v18, v0, 3, 1
    v_lshl_add_u32 v17, v18, 2, v17
    v_bfe_u32 v18, v0, 2, 1
    v_add_u32 v17, v17, v18
    v_lshlrev_b32 v17, 7, v17
    v_and_b32_e64 v18, 3, v0
    v_lshl_add_u32 v17, v18, 3, v17
    v_add_u32_e64 v16, v16, v17
    v_add_u32 v16, 40960, v16
    ds_read_b64_tr_b16 a[40:41], v16 offset:0
    ds_read_b64_tr_b16 a[42:43], v16 offset:256
    ds_read_b64_tr_b16 a[44:45], v16 offset:4096
    ds_read_b64_tr_b16 a[46:47], v16 offset:4352
    ds_read_b64_tr_b16 a[48:49], v16 offset:8192
    ds_read_b64_tr_b16 a[50:51], v16 offset:8448
    ds_read_b64_tr_b16 a[52:53], v16 offset:12288
    ds_read_b64_tr_b16 a[54:55], v16 offset:12544
    ds_read_b64_tr_b16 a[56:57], v16 offset:16384
    ds_read_b64_tr_b16 a[58:59], v16 offset:16640
    ds_read_b64_tr_b16 a[60:61], v16 offset:20480
    ds_read_b64_tr_b16 a[62:63], v16 offset:20736
    s_waitcnt lgkmcnt(0)
    ds_read_b64_tr_b16 a[64:65], v16 offset:24576
    ds_read_b64_tr_b16 a[66:67], v16 offset:24832
    ds_read_b64_tr_b16 a[68:69], v16 offset:28672
    ds_read_b64_tr_b16 a[70:71], v16 offset:28928
    ds_read_b64_tr_b16 a[72:73], v16 offset:32768
    ds_read_b64_tr_b16 a[74:75], v16 offset:33024
    ds_read_b64_tr_b16 a[76:77], v16 offset:36864
    ds_read_b64_tr_b16 a[78:79], v16 offset:37120
    s_waitcnt lgkmcnt(0)
    s_waitcnt lgkmcnt(0)
    s_barrier
    s_mov_b32 s44, s12
    s_mov_b32 s45, s13
    s_and_b32 s45, s45, 0xffff
    s_mov_b32 s46, 0x500000
    s_mov_b32 s47, 0x20000
    s_lshl_b32 s94, s73, 7
    s_add_u32 s94, s94, 2621440
    v_lshrrev_b32 v16, 5, v0
    s_and_b32 s88, s28, 2
    v_or_b32 v16, s88, v16
    v_lshlrev_b32 v16, 1, v16
    v_and_b32 v17, 7, v0
    v_xor_b32 v16, v16, v17
    v_lshlrev_b32 v16, 4, v16
    v_lshrrev_b32 v17, 3, v0
    v_lshlrev_b32 v17, 13, v17
    v_add_u32 v16, v16, v17
    s_lshl_b32 s88, s28, 16
    s_add_u32 s88, s88, s94
    s_lshl_b32 s89, s28, 10
    s_add_u32 s89, s89, 40960
    s_mov_b32 m0, s89
    s_add_u32 s89, s89, 4096
    buffer_load_dwordx4 v16, s[44:47], s88 offen lds
    s_add_u32 s88, s88, 262144
    s_mov_b32 m0, s89
    s_add_u32 s89, s89, 4096
    buffer_load_dwordx4 v16, s[44:47], s88 offen lds
    s_add_u32 s88, s88, 262144
    s_mov_b32 m0, s89
    s_add_u32 s89, s89, 4096
    buffer_load_dwordx4 v16, s[44:47], s88 offen lds
    s_add_u32 s88, s88, 262144
    s_mov_b32 m0, s89
    s_add_u32 s89, s89, 4096
    buffer_load_dwordx4 v16, s[44:47], s88 offen lds
    s_add_u32 s88, s88, 262144
    s_mov_b32 m0, s89
    s_add_u32 s89, s89, 4096
    buffer_load_dwordx4 v16, s[44:47], s88 offen lds
    s_add_u32 s88, s88, 262144
    s_mov_b32 m0, s89
    s_add_u32 s89, s89, 4096
    buffer_load_dwordx4 v16, s[44:47], s88 offen lds
    s_add_u32 s88, s88, 262144
    s_mov_b32 m0, s89
    s_add_u32 s89, s89, 4096
    buffer_load_dwordx4 v16, s[44:47], s88 offen lds
    s_add_u32 s88, s88, 262144
    s_mov_b32 m0, s89
    s_add_u32 s89, s89, 4096
    buffer_load_dwordx4 v16, s[44:47], s88 offen lds
    s_add_u32 s88, s88, 262144
    s_mov_b32 m0, s89
    s_add_u32 s89, s89, 4096
    buffer_load_dwordx4 v16, s[44:47], s88 offen lds
    s_add_u32 s88, s88, 262144
    s_mov_b32 m0, s89
    s_add_u32 s89, s89, 4096
    buffer_load_dwordx4 v16, s[44:47], s88 offen lds
    s_add_u32 s88, s88, 262144
    s_waitcnt vmcnt(30)
    s_barrier
    v_bfe_u32 v17, v0, 3, 2
    v_xor_b32 v16, s28, v17
    v_lshlrev_b32 v16, 5, v16
    v_bfe_u32 v17, v0, 4, 1
    v_lshlrev_b32_e64 v17, 4, v17
    v_bfe_u32 v18, v0, 5, 1
    v_lshl_add_u32 v17, v18, 3, v17
    v_bfe_u32 v18, v0, 3, 1
    v_lshl_add_u32 v17, v18, 2, v17
    v_bfe_u32 v18, v0, 2, 1
    v_add_u32 v17, v17, v18
    v_lshlrev_b32 v17, 7, v17
    v_and_b32_e64 v18, 3, v0
    v_lshl_add_u32 v17, v18, 3, v17
    v_add_u32_e64 v16, v16, v17
    v_add_u32 v16, 81920, v16
    ds_read_b64_tr_b16 a[80:81], v16 offset:0
    ds_read_b64_tr_b16 a[82:83], v16 offset:256
    ds_read_b64_tr_b16 a[84:85], v16 offset:4096
    ds_read_b64_tr_b16 a[86:87], v16 offset:4352
    ds_read_b64_tr_b16 a[88:89], v16 offset:8192
    ds_read_b64_tr_b16 a[90:91], v16 offset:8448
    ds_read_b64_tr_b16 a[92:93], v16 offset:12288
    ds_read_b64_tr_b16 a[94:95], v16 offset:12544
    ds_read_b64_tr_b16 a[96:97], v16 offset:16384
    ds_read_b64_tr_b16 a[98:99], v16 offset:16640
    ds_read_b64_tr_b16 a[100:101], v16 offset:20480
    ds_read_b64_tr_b16 a[102:103], v16 offset:20736
    s_waitcnt lgkmcnt(0)
    ds_read_b64_tr_b16 a[104:105], v16 offset:24576
    ds_read_b64_tr_b16 a[106:107], v16 offset:24832
    ds_read_b64_tr_b16 a[108:109], v16 offset:28672
    ds_read_b64_tr_b16 a[110:111], v16 offset:28928
    ds_read_b64_tr_b16 a[112:113], v16 offset:32768
    ds_read_b64_tr_b16 a[114:115], v16 offset:33024
    ds_read_b64_tr_b16 a[116:117], v16 offset:36864
    ds_read_b64_tr_b16 a[118:119], v16 offset:37120
    s_waitcnt lgkmcnt(0)
    s_waitcnt lgkmcnt(0)
    s_barrier
    s_mov_b32 s44, s14
    s_mov_b32 s45, s15
    s_and_b32 s45, s45, 0xffff
    s_mov_b32 s46, 0x500000
    s_mov_b32 s47, 0x20000
    s_mul_i32 s94, s73, 81920
    s_lshl_b32 s89, s28, 10
    s_add_u32 s89, s89, 81920
    s_lshl_b32 s88, s28, 6
    v_add_u32 v16, s88, v0
    s_mov_b32 s90, 52429
    v_mul_lo_u32 v17, v16, s90
    v_lshrrev_b32 v17, 22, v17
    v_mul_u32_u24 v18, 80, v17
    v_sub_u32 v18, v16, v18
    v_and_b32 v19, 7, v17
    v_lshlrev_b32 v19, 1, v19
    v_xor_b32 v18, v18, v19
    v_mul_u32_u24 v17, 1280, v17
    v_lshl_add_u32 v17, v18, 4, v17
    s_mov_b32 m0, s89
    s_add_u32 s89, s89, 4096
    buffer_load_dwordx4 v17, s[44:47], s94 offen lds
    v_add_u32 v16, 256, v16
    v_mul_lo_u32 v20, v16, s90
    v_lshrrev_b32 v20, 22, v20
    v_mul_u32_u24 v21, 80, v20
    v_sub_u32 v21, v16, v21
    v_and_b32 v22, 7, v20
    v_lshlrev_b32 v22, 1, v22
    v_xor_b32 v21, v21, v22
    v_mul_u32_u24 v20, 1280, v20
    v_lshl_add_u32 v20, v21, 4, v20
    s_mov_b32 m0, s89
    s_add_u32 s89, s89, 4096
    buffer_load_dwordx4 v20, s[44:47], s94 offen lds
    v_add_u32 v16, 256, v16
    v_mul_lo_u32 v17, v16, s90
    v_lshrrev_b32 v17, 22, v17
    v_mul_u32_u24 v18, 80, v17
    v_sub_u32 v18, v16, v18
    v_and_b32 v19, 7, v17
    v_lshlrev_b32 v19, 1, v19
    v_xor_b32 v18, v18, v19
    v_mul_u32_u24 v17, 1280, v17
    v_lshl_add_u32 v17, v18, 4, v17
    s_mov_b32 m0, s89
    s_add_u32 s89, s89, 4096
    buffer_load_dwordx4 v17, s[44:47], s94 offen lds
    v_add_u32 v16, 256, v16
    v_mul_lo_u32 v20, v16, s90
    v_lshrrev_b32 v20, 22, v20
    v_mul_u32_u24 v21, 80, v20
    v_sub_u32 v21, v16, v21
    v_and_b32 v22, 7, v20
    v_lshlrev_b32 v22, 1, v22
    v_xor_b32 v21, v21, v22
    v_mul_u32_u24 v20, 1280, v20
    v_lshl_add_u32 v20, v21, 4, v20
    s_mov_b32 m0, s89
    s_add_u32 s89, s89, 4096
    buffer_load_dwordx4 v20, s[44:47], s94 offen lds
    v_add_u32 v16, 256, v16
    v_mul_lo_u32 v17, v16, s90
    v_lshrrev_b32 v17, 22, v17
    v_mul_u32_u24 v18, 80, v17
    v_sub_u32 v18, v16, v18
    v_and_b32 v19, 7, v17
    v_lshlrev_b32 v19, 1, v19
    v_xor_b32 v18, v18, v19
    v_mul_u32_u24 v17, 1280, v17
    v_lshl_add_u32 v17, v18, 4, v17
    s_mov_b32 m0, s89
    s_add_u32 s89, s89, 4096
    buffer_load_dwordx4 v17, s[44:47], s94 offen lds
    v_add_u32 v16, 256, v16
    v_mul_lo_u32 v20, v16, s90
    v_lshrrev_b32 v20, 22, v20
    v_mul_u32_u24 v21, 80, v20
    v_sub_u32 v21, v16, v21
    v_and_b32 v22, 7, v20
    v_lshlrev_b32 v22, 1, v22
    v_xor_b32 v21, v21, v22
    v_mul_u32_u24 v20, 1280, v20
    v_lshl_add_u32 v20, v21, 4, v20
    s_mov_b32 m0, s89
    s_add_u32 s89, s89, 4096
    buffer_load_dwordx4 v20, s[44:47], s94 offen lds
    v_add_u32 v16, 256, v16
    v_mul_lo_u32 v17, v16, s90
    v_lshrrev_b32 v17, 22, v17
    v_mul_u32_u24 v18, 80, v17
    v_sub_u32 v18, v16, v18
    v_and_b32 v19, 7, v17
    v_lshlrev_b32 v19, 1, v19
    v_xor_b32 v18, v18, v19
    v_mul_u32_u24 v17, 1280, v17
    v_lshl_add_u32 v17, v18, 4, v17
    s_mov_b32 m0, s89
    s_add_u32 s89, s89, 4096
    buffer_load_dwordx4 v17, s[44:47], s94 offen lds
    v_add_u32 v16, 256, v16
    v_mul_lo_u32 v20, v16, s90
    v_lshrrev_b32 v20, 22, v20
    v_mul_u32_u24 v21, 80, v20
    v_sub_u32 v21, v16, v21
    v_and_b32 v22, 7, v20
    v_lshlrev_b32 v22, 1, v22
    v_xor_b32 v21, v21, v22
    v_mul_u32_u24 v20, 1280, v20
    v_lshl_add_u32 v20, v21, 4, v20
    s_mov_b32 m0, s89
    s_add_u32 s89, s89, 4096
    buffer_load_dwordx4 v20, s[44:47], s94 offen lds
    v_add_u32 v16, 256, v16
    v_mul_lo_u32 v17, v16, s90
    v_lshrrev_b32 v17, 22, v17
    v_mul_u32_u24 v18, 80, v17
    v_sub_u32 v18, v16, v18
    v_and_b32 v19, 7, v17
    v_lshlrev_b32 v19, 1, v19
    v_xor_b32 v18, v18, v19
    v_mul_u32_u24 v17, 1280, v17
    v_lshl_add_u32 v17, v18, 4, v17
    s_mov_b32 m0, s89
    s_add_u32 s89, s89, 4096
    buffer_load_dwordx4 v17, s[44:47], s94 offen lds
    v_add_u32 v16, 256, v16
    v_mul_lo_u32 v20, v16, s90
    v_lshrrev_b32 v20, 22, v20
    v_mul_u32_u24 v21, 80, v20
    v_sub_u32 v21, v16, v21
    v_and_b32 v22, 7, v20
    v_lshlrev_b32 v22, 1, v22
    v_xor_b32 v21, v21, v22
    v_mul_u32_u24 v20, 1280, v20
    v_lshl_add_u32 v20, v21, 4, v20
    s_mov_b32 m0, s89
    s_add_u32 s89, s89, 4096
    buffer_load_dwordx4 v20, s[44:47], s94 offen lds
    v_add_u32 v16, 256, v16
    s_waitcnt vmcnt(30)
    s_barrier
    v_bfe_u32 v17, v0, 3, 2
    v_xor_b32 v16, s28, v17
    v_lshlrev_b32_e64 v16, 5, v16
    v_bfe_u32 v17, v0, 4, 1
    v_lshlrev_b32_e64 v17, 4, v17
    v_bfe_u32 v18, v0, 5, 1
    v_lshl_add_u32 v17, v18, 3, v17
    v_bfe_u32 v18, v0, 3, 1
    v_lshl_add_u32 v17, v18, 2, v17
    v_bfe_u32 v18, v0, 2, 1
    v_add_u32 v17, v17, v18
    v_lshlrev_b32 v17, 7, v17
    v_and_b32_e64 v18, 3, v0
    v_lshl_add_u32 v17, v18, 3, v17
    v_add_u32_e64 v16, v16, v17
    v_add_u32 v16, 122880, v16
    ds_read_b64_tr_b16 a[120:121], v16 offset:0
    ds_read_b64_tr_b16 a[122:123], v16 offset:256
    ds_read_b64_tr_b16 a[124:125], v16 offset:4096
    ds_read_b64_tr_b16 a[126:127], v16 offset:4352
    ds_read_b64_tr_b16 a[128:129], v16 offset:8192
    ds_read_b64_tr_b16 a[130:131], v16 offset:8448
    ds_read_b64_tr_b16 a[132:133], v16 offset:12288
    ds_read_b64_tr_b16 a[134:135], v16 offset:12544
    ds_read_b64_tr_b16 a[136:137], v16 offset:16384
    ds_read_b64_tr_b16 a[138:139], v16 offset:16640
    ds_read_b64_tr_b16 a[140:141], v16 offset:20480
    ds_read_b64_tr_b16 a[142:143], v16 offset:20736
    s_waitcnt lgkmcnt(0)
    ds_read_b64_tr_b16 a[144:145], v16 offset:24576
    ds_read_b64_tr_b16 a[146:147], v16 offset:24832
    ds_read_b64_tr_b16 a[148:149], v16 offset:28672
    ds_read_b64_tr_b16 a[150:151], v16 offset:28928
    ds_read_b64_tr_b16 a[152:153], v16 offset:32768
    ds_read_b64_tr_b16 a[154:155], v16 offset:33024
    ds_read_b64_tr_b16 a[156:157], v16 offset:36864
    ds_read_b64_tr_b16 a[158:159], v16 offset:37120
    s_waitcnt lgkmcnt(0)
    s_waitcnt lgkmcnt(0)
    s_barrier
    s_mov_b32 s44, s14
    s_mov_b32 s45, s15
    s_and_b32 s45, s45, 0xffff
    s_mov_b32 s46, 0x500000
    s_mov_b32 s47, 0x20000
    s_mul_i32 s94, s73, 81920
    s_add_u32 s94, s94, 40960
    s_lshl_b32 s89, s28, 10
    s_add_u32 s89, s89, 122880
    s_lshl_b32 s88, s28, 6
    v_add_u32 v16, s88, v0
    s_mov_b32 s90, 52429
    v_mul_lo_u32 v17, v16, s90
    v_lshrrev_b32 v17, 22, v17
    v_mul_u32_u24 v18, 80, v17
    v_sub_u32 v18, v16, v18
    v_and_b32 v19, 7, v17
    v_lshlrev_b32 v19, 1, v19
    v_xor_b32 v18, v18, v19
    v_mul_u32_u24 v17, 1280, v17
    v_lshl_add_u32 v17, v18, 4, v17
    s_mov_b32 m0, s89
    s_add_u32 s89, s89, 4096
    buffer_load_dwordx4 v17, s[44:47], s94 offen lds
    v_add_u32 v16, 256, v16
    v_mul_lo_u32 v20, v16, s90
    v_lshrrev_b32 v20, 22, v20
    v_mul_u32_u24 v21, 80, v20
    v_sub_u32 v21, v16, v21
    v_and_b32 v22, 7, v20
    v_lshlrev_b32 v22, 1, v22
    v_xor_b32 v21, v21, v22
    v_mul_u32_u24 v20, 1280, v20
    v_lshl_add_u32 v20, v21, 4, v20
    s_mov_b32 m0, s89
    s_add_u32 s89, s89, 4096
    buffer_load_dwordx4 v20, s[44:47], s94 offen lds
    v_add_u32 v16, 256, v16
    v_mul_lo_u32 v17, v16, s90
    v_lshrrev_b32 v17, 22, v17
    v_mul_u32_u24 v18, 80, v17
    v_sub_u32 v18, v16, v18
    v_and_b32 v19, 7, v17
    v_lshlrev_b32 v19, 1, v19
    v_xor_b32 v18, v18, v19
    v_mul_u32_u24 v17, 1280, v17
    v_lshl_add_u32 v17, v18, 4, v17
    s_mov_b32 m0, s89
    s_add_u32 s89, s89, 4096
    buffer_load_dwordx4 v17, s[44:47], s94 offen lds
    v_add_u32 v16, 256, v16
    v_mul_lo_u32 v20, v16, s90
    v_lshrrev_b32 v20, 22, v20
    v_mul_u32_u24 v21, 80, v20
    v_sub_u32 v21, v16, v21
    v_and_b32 v22, 7, v20
    v_lshlrev_b32 v22, 1, v22
    v_xor_b32 v21, v21, v22
    v_mul_u32_u24 v20, 1280, v20
    v_lshl_add_u32 v20, v21, 4, v20
    s_mov_b32 m0, s89
    s_add_u32 s89, s89, 4096
    buffer_load_dwordx4 v20, s[44:47], s94 offen lds
    v_add_u32 v16, 256, v16
    v_mul_lo_u32 v17, v16, s90
    v_lshrrev_b32 v17, 22, v17
    v_mul_u32_u24 v18, 80, v17
    v_sub_u32 v18, v16, v18
    v_and_b32 v19, 7, v17
    v_lshlrev_b32 v19, 1, v19
    v_xor_b32 v18, v18, v19
    v_mul_u32_u24 v17, 1280, v17
    v_lshl_add_u32 v17, v18, 4, v17
    s_mov_b32 m0, s89
    s_add_u32 s89, s89, 4096
    buffer_load_dwordx4 v17, s[44:47], s94 offen lds
    v_add_u32 v16, 256, v16
    v_mul_lo_u32 v20, v16, s90
    v_lshrrev_b32 v20, 22, v20
    v_mul_u32_u24 v21, 80, v20
    v_sub_u32 v21, v16, v21
    v_and_b32 v22, 7, v20
    v_lshlrev_b32 v22, 1, v22
    v_xor_b32 v21, v21, v22
    v_mul_u32_u24 v20, 1280, v20
    v_lshl_add_u32 v20, v21, 4, v20
    s_mov_b32 m0, s89
    s_add_u32 s89, s89, 4096
    buffer_load_dwordx4 v20, s[44:47], s94 offen lds
    v_add_u32 v16, 256, v16
    v_mul_lo_u32 v17, v16, s90
    v_lshrrev_b32 v17, 22, v17
    v_mul_u32_u24 v18, 80, v17
    v_sub_u32 v18, v16, v18
    v_and_b32 v19, 7, v17
    v_lshlrev_b32 v19, 1, v19
    v_xor_b32 v18, v18, v19
    v_mul_u32_u24 v17, 1280, v17
    v_lshl_add_u32 v17, v18, 4, v17
    s_mov_b32 m0, s89
    s_add_u32 s89, s89, 4096
    buffer_load_dwordx4 v17, s[44:47], s94 offen lds
    v_add_u32 v16, 256, v16
    v_mul_lo_u32 v20, v16, s90
    v_lshrrev_b32 v20, 22, v20
    v_mul_u32_u24 v21, 80, v20
    v_sub_u32 v21, v16, v21
    v_and_b32 v22, 7, v20
    v_lshlrev_b32 v22, 1, v22
    v_xor_b32 v21, v21, v22
    v_mul_u32_u24 v20, 1280, v20
    v_lshl_add_u32 v20, v21, 4, v20
    s_mov_b32 m0, s89
    s_add_u32 s89, s89, 4096
    buffer_load_dwordx4 v20, s[44:47], s94 offen lds
    v_add_u32 v16, 256, v16
    v_mul_lo_u32 v17, v16, s90
    v_lshrrev_b32 v17, 22, v17
    v_mul_u32_u24 v18, 80, v17
    v_sub_u32 v18, v16, v18
    v_and_b32 v19, 7, v17
    v_lshlrev_b32 v19, 1, v19
    v_xor_b32 v18, v18, v19
    v_mul_u32_u24 v17, 1280, v17
    v_lshl_add_u32 v17, v18, 4, v17
    s_mov_b32 m0, s89
    s_add_u32 s89, s89, 4096
    buffer_load_dwordx4 v17, s[44:47], s94 offen lds
    v_add_u32 v16, 256, v16
    v_mul_lo_u32 v20, v16, s90
    v_lshrrev_b32 v20, 22, v20
    v_mul_u32_u24 v21, 80, v20
    v_sub_u32 v21, v16, v21
    v_and_b32 v22, 7, v20
    v_lshlrev_b32 v22, 1, v22
    v_xor_b32 v21, v21, v22
    v_mul_u32_u24 v20, 1280, v20
    v_lshl_add_u32 v20, v21, 4, v20
    s_mov_b32 m0, s89
    s_add_u32 s89, s89, 4096
    buffer_load_dwordx4 v20, s[44:47], s94 offen lds
    v_add_u32 v16, 256, v16
    s_waitcnt vmcnt(30)
    s_barrier
    v_bfe_u32 v17, v0, 3, 2
    v_xor_b32 v16, s28, v17
    v_lshlrev_b32_e64 v16, 5, v16
    v_bfe_u32 v17, v0, 4, 1
    v_lshlrev_b32_e64 v17, 4, v17
    v_bfe_u32 v18, v0, 5, 1
    v_lshl_add_u32 v17, v18, 3, v17
    v_bfe_u32 v18, v0, 3, 1
    v_lshl_add_u32 v17, v18, 2, v17
    v_bfe_u32 v18, v0, 2, 1
    v_add_u32 v17, v17, v18
    v_lshlrev_b32 v17, 7, v17
    v_and_b32_e64 v18, 3, v0
    v_lshl_add_u32 v17, v18, 3, v17
    v_add_u32 v16, v16, v17
    v_add_u32 v16, 0, v16
    ds_read_b64_tr_b16 a[160:161], v16 offset:0
    ds_read_b64_tr_b16 a[162:163], v16 offset:256
    ds_read_b64_tr_b16 a[164:165], v16 offset:4096
    ds_read_b64_tr_b16 a[166:167], v16 offset:4352
    ds_read_b64_tr_b16 a[168:169], v16 offset:8192
    ds_read_b64_tr_b16 a[170:171], v16 offset:8448
    ds_read_b64_tr_b16 a[172:173], v16 offset:12288
    ds_read_b64_tr_b16 a[174:175], v16 offset:12544
    ds_read_b64_tr_b16 a[176:177], v16 offset:16384
    ds_read_b64_tr_b16 a[178:179], v16 offset:16640
    ds_read_b64_tr_b16 a[180:181], v16 offset:20480
    ds_read_b64_tr_b16 a[182:183], v16 offset:20736
    s_waitcnt lgkmcnt(0)
    ds_read_b64_tr_b16 a[184:185], v16 offset:24576
    ds_read_b64_tr_b16 a[186:187], v16 offset:24832
    ds_read_b64_tr_b16 a[188:189], v16 offset:28672
    ds_read_b64_tr_b16 a[190:191], v16 offset:28928
    ds_read_b64_tr_b16 a[192:193], v16 offset:32768
    ds_read_b64_tr_b16 a[194:195], v16 offset:33024
    ds_read_b64_tr_b16 a[196:197], v16 offset:36864
    ds_read_b64_tr_b16 a[198:199], v16 offset:37120
    s_waitcnt lgkmcnt(0)
    s_waitcnt lgkmcnt(0)
    s_barrier
    s_waitcnt vmcnt(20)
    s_barrier
    v_bfe_u32 v17, v0, 3, 2
    v_xor_b32 v16, s28, v17
    v_lshlrev_b32 v16, 5, v16
    v_bfe_u32 v17, v0, 4, 1
    v_lshlrev_b32_e64 v17, 4, v17
    v_bfe_u32 v18, v0, 5, 1
    v_lshl_add_u32 v17, v18, 3, v17
    v_bfe_u32 v18, v0, 3, 1
    v_lshl_add_u32 v17, v18, 2, v17
    v_bfe_u32 v18, v0, 2, 1
    v_add_u32 v17, v17, v18
    v_lshlrev_b32 v17, 7, v17
    v_and_b32_e64 v18, 3, v0
    v_lshl_add_u32 v17, v18, 3, v17
    v_add_u32_e64 v16, v16, v17
    v_add_u32 v16, 40960, v16
    ds_read_b64_tr_b16 a[200:201], v16 offset:0
    ds_read_b64_tr_b16 a[202:203], v16 offset:256
    ds_read_b64_tr_b16 a[204:205], v16 offset:4096
    ds_read_b64_tr_b16 a[206:207], v16 offset:4352
    ds_read_b64_tr_b16 a[208:209], v16 offset:8192
    ds_read_b64_tr_b16 a[210:211], v16 offset:8448
    ds_read_b64_tr_b16 a[212:213], v16 offset:12288
    ds_read_b64_tr_b16 a[214:215], v16 offset:12544
    ds_read_b64_tr_b16 a[216:217], v16 offset:16384
    ds_read_b64_tr_b16 a[218:219], v16 offset:16640
    ds_read_b64_tr_b16 a[220:221], v16 offset:20480
    ds_read_b64_tr_b16 a[222:223], v16 offset:20736
    s_waitcnt lgkmcnt(0)
    ds_read_b64_tr_b16 a[224:225], v16 offset:24576
    ds_read_b64_tr_b16 a[226:227], v16 offset:24832
    ds_read_b64_tr_b16 a[228:229], v16 offset:28672
    ds_read_b64_tr_b16 a[230:231], v16 offset:28928
    ds_read_b64_tr_b16 a[232:233], v16 offset:32768
    ds_read_b64_tr_b16 a[234:235], v16 offset:33024
    ds_read_b64_tr_b16 a[236:237], v16 offset:36864
    ds_read_b64_tr_b16 a[238:239], v16 offset:37120
    s_waitcnt lgkmcnt(0)
    s_waitcnt lgkmcnt(0)
    s_barrier
    s_add_u32 s32, s26, 0x5000000
    s_addc_u32 s33, s27, 0
    s_and_b32 s33, s33, 0xffff
    s_mov_b32 s34, 0xa0000
    s_mov_b32 s35, 0x20000
    s_mul_i32 s88, s30, 327680
    s_add_u32 s32, s32, s88
    s_addc_u32 s33, s33, 0
    s_mov_b32 s34, 327680
    s_add_u32 s36, s26, 0x50a0000
    s_addc_u32 s37, s27, 0
    s_and_b32 s37, s37, 0xffff
    s_mov_b32 s38, 0x20000
    s_mov_b32 s39, 0x20000
    s_add_u32 s40, s26, 0x5c0ffff
    s_addc_u32 s41, s27, 0
    s_and_b32 s40, s40, 0xffff0000
    s_and_b32 s41, s41, 0xffff
    s_mov_b32 s42, 0x400000
    s_mov_b32 s43, 0x20000
    s_add_u32 s44, s26, 0x4000000
    s_addc_u32 s45, s27, 0
    s_and_b32 s45, s45, 0xffff
    s_mov_b32 s46, 0x800000
    s_mov_b32 s47, 0x20000
    s_add_u32 s48, s26, 0x4800000
    s_addc_u32 s49, s27, 0
    s_and_b32 s49, s49, 0xffff
    s_mov_b32 s50, 0x400000
    s_mov_b32 s51, 0x20000
    s_mov_b32 s52, s26
    s_mov_b32 s53, s27
    s_and_b32 s53, s53, 0xffff
    s_mov_b32 s54, 0x1000000
    s_mov_b32 s55, 0x20000
    s_add_u32 s56, s26, 0x2000000
    s_addc_u32 s57, s27, 0
    s_and_b32 s57, s57, 0xffff
    s_mov_b32 s58, 0x1000000
    s_mov_b32 s59, 0x20000
    s_add_u32 s60, s26, 0x5500000
    s_addc_u32 s61, s27, 0
    s_and_b32 s61, s61, 0xffff
    s_mov_b32 s62, 0x8000
    s_mov_b32 s63, 0x20000
    s_lshl_b32 s88, s30, 5
    s_add_u32 s88, s88, s31
    s_mul_i32 s67, s88, 2048
    s_lshl_b32 s96, s88, 4
    s_add_u32 s96, s96, 17408
    s_xor_b32 s88, s88, 1
    s_mul_i32 s68, s88, 2048
    s_mov_b32 s80, 16384
    s_mov_b32 s81, 32768
    s_mov_b32 s82, 49152
    s_mov_b32 s83, 65536
    s_lshl_b32 s88, s28, 5
    s_add_u32 s88, s88, s31
    s_lshl_b32 s69, s88, 12
    s_cmp_lt_u32 s88, 80
    s_cselect_b32 s69, s69, -1
    s_lshl_b32 s70, s88, 7
    s_lshr_b32 s89, s88, 5
    s_lshl_b32 s90, s89, 12
    s_cmp_eq_u32 s89, 2
    s_cselect_b32 s90, 16384, s90
    s_and_b32 s89, s88, 31
    s_lshl_b32 s89, s89, 7
    s_add_u32 s90, s90, s89
    s_mul_i32 s71, s30, 32768
    s_add_u32 s71, s71, s90
    s_mov_b32 s72, 0
    s_mov_b32 s77, 0
    s_lshl_b32 s74, s73, 11
    s_lshl_b32 s75, s73, 10
    s_lshl_b32 s76, s73, 12
    s_mov_b32 s87, 0
    s_mov_b32 s78, 0x3e0293ee
    s_mov_b32 s79, 0x3e0293ee
    v_lshrrev_b32 v16, 4, v0
    v_and_b32_e64 v17, 15, v0
    v_bfe_u32 v18, v0, 2, 2
    v_and_b32 v19, 3, v0
    v_lshlrev_b32 v2, 4, v0
    v_cmp_lt_u32_e64 vcc, 7, v17
    v_mov_b32 v1, 0x4444
    v_mov_b32 v20, 0xeeee
    v_cndmask_b32 v1, v1, v20, vcc
    v_and_b32 v20, 7, v0
    v_lshl_add_u32 v20, v16, 3, v20
    v_lshlrev_b32 v10, 4, v20
    v_mov_b32 v21, 1073741824
    v_cndmask_b32 v11, v10, v21, vcc
    s_mul_i32 s88, s28, 81920
    s_lshl_b32 s89, s31, 7
    s_add_u32 s88, s88, s89
    v_lshlrev_b32 v20, 12, v16
    v_lshl_add_u32 v20, v17, 4, v20
    v_add_u32 v20, s88, v20
    v_cndmask_b32 v12, v20, v21, vcc
    v_lshlrev_b32_e64 v20, 4, v17
    v_lshl_add_u32 v20, v16, 3, v20
    v_cndmask_b32 v20, v20, v21, vcc
    v_cmp_lt_u32 vcc, 31, v0
    s_nop 1
    v_cndmask_b32 v13, v20, v21, vcc
    s_lshl_b32 s88, s28, 4
    v_add_u32 v20, s88, v17
    v_and_b32 v21, 1, v16
    v_lshlrev_b32 v22, 4, v20
    v_lshl_add_u32 v22, v21, 3, v22
    v_add_u32 v22, 20480, v22
    v_lshlrev_b32_e64 v23, 5, v20
    v_lshl_add_u32 v23, v21, 4, v23
    v_add_u32 v23, 21504, v23
    v_cndmask_b32 v3, v22, v23, vcc
    v_add_u32 v22, 4, v22
    v_add_u32 v23, 8, v23
    v_cndmask_b32 v4, v22, v23, vcc
    v_lshlrev_b32_e64 v22, 4, v20
    v_lshl_add_u32 v22, v21, 3, v22
    v_lshrrev_b32_e64 v23, 5, v0
    v_lshl_add_u32 v22, v23, 2, v22
    v_add_u32 v5, 23552, v22
    v_lshl_add_u32 v20, v16, 2, v18
    v_and_b32 v21, 1, v19
    v_lshlrev_b32 v21, 3, v21
    v_lshl_add_u32 v6, v20, 4, v21
    v_add_u32 v6, 20480, v6
    v_lshlrev_b32_e64 v21, 3, v19
    v_lshl_add_u32 v7, v20, 5, v21
    v_add_u32 v7, 21504, v7
    v_add_u32 v8, 32768, v2
    v_lshlrev_b32_e64 v21, 2, v16
    v_lshl_add_u32 v9, v17, 4, v21
    v_add_u32 v9, 23552, v9
    s_mul_i32 s88, s28, 160
    v_add_u32 v20, s88, v0
    v_lshlrev_b32 v15, 4, v20
    v_lshrrev_b32 v21, 8, v20
    v_lshlrev_b32 v22, 12, v21
    v_cmp_eq_u32_e64 vcc, 2, v21
    v_mov_b32 v23, 16384
    s_nop 0
    v_cndmask_b32 v22, v22, v23, vcc
    v_and_b32 v21, 255, v20
    v_lshl_add_u32 v14, v21, 4, v22
    v_add_u32 v20, 64, v20
    v_lshrrev_b32 v21, 8, v20
    v_lshlrev_b32 v22, 12, v21
    v_cmp_eq_u32 vcc, 2, v21
    v_mov_b32 v23, 16384
    s_nop 0
    v_cndmask_b32 v22, v22, v23, vcc
    v_and_b32 v21, 255, v20
    v_lshl_add_u32 v188, v21, 4, v22
    v_lshrrev_b32 v20, 1, v0
    v_add_u32 v20, s88, v20
    v_add_u32 v20, 128, v20
    v_lshlrev_b32 v190, 4, v20
    v_lshrrev_b32 v21, 8, v20
    v_lshlrev_b32 v22, 12, v21
    v_cmp_eq_u32 vcc, 2, v21
    v_mov_b32 v23, 16384
    s_nop 0
    v_cndmask_b32 v22, v22, v23, vcc
    v_and_b32 v21, 255, v20
    v_lshl_add_u32 v189, v21, 4, v22
    v_and_b32 v20, 1, v0
    v_lshlrev_b32 v20, 3, v20
    v_add_u32 v189, v189, v20
    v_add_u32 v190, v190, v20
    v_mov_b32 v24, 0x3f803f80
    v_mov_b32 v25, 0x3f803f80
    v_mov_b32 v26, 0x3f803f80
    v_mov_b32 v27, 0x3f803f80
    v_mov_b32 v20, 0x3f80
    v_mov_b32 v21, 0x3f800000
    v_cmp_eq_u32 vcc, 0, v17
    s_nop 1
    v_cndmask_b32 v28, 0, v20, vcc
    v_cmp_eq_u32 vcc, 1, v17
    s_nop 1
    v_cndmask_b32 v28, v28, v21, vcc
    v_cmp_eq_u32 vcc, 2, v17
    s_nop 1
    v_cndmask_b32 v29, 0, v20, vcc
    v_cmp_eq_u32 vcc, 3, v17
    s_nop 1
    v_cndmask_b32 v29, v29, v21, vcc
    v_cmp_eq_u32 vcc, 4, v17
    s_nop 1
    v_cndmask_b32 v30, 0, v20, vcc
    v_cmp_eq_u32 vcc, 5, v17
    s_nop 1
    v_cndmask_b32 v30, v30, v21, vcc
    v_cmp_eq_u32 vcc, 6, v17
    s_nop 1
    v_cndmask_b32 v31, 0, v20, vcc
    v_cmp_eq_u32 vcc, 7, v17
    s_nop 1
    v_cndmask_b32 v31, v31, v21, vcc
    s_lshl_b32 s88, s28, 10
    v_add_u32_e64 v16, s88, v2
    ds_write_b128 v16, v[124:127] offset:0
    ds_write_b128 v16, v[128:131] offset:4096
    s_cmp_ge_u32 s28, 2
    s_cbranch_scc1 m0skip_3
    ds_write_b128 v16, v[132:135] offset:8192
m0skip_3:
    v_lshrrev_b32 v16, 1, v16
    v_mov_b32 v18, 0
    v_mov_b32_e64 v19, 0
    ds_write_b64 v16, v[18:19] offset:21504
    s_mov_b32 s64, 0
    s_mov_b32 s65, 0
    s_waitcnt vmcnt(10)
    s_barrier
    v_lshrrev_b32_e64 v16, 4, v0
    v_bfe_u32 v17, v0, 2, 2
    v_lshl_add_u32 v17, v16, 2, v17
    v_and_b32 v19, 7, v17
    v_lshlrev_b32 v19, 1, v19
    v_mul_u32_u24 v22, 1280, v17
    v_and_b32_e64 v20, 1, v0
    v_lshl_add_u32 v22, v20, 3, v22
    v_add_u32 v22, 81920, v22
    v_bfe_u32 v20, v0, 1, 1
    s_mul_i32 s88, s28, 20
    s_add_u32 s89, s88, 0
    v_add_u32 v16, s89, v20
    v_xor_b32 v16, v16, v19
    v_lshl_add_u32 v16, v16, 4, v22
    ds_read_b64_tr_b16 a[240:241], v16 offset:0
    ds_read_b64_tr_b16 a[242:243], v16 offset:20480
    s_add_u32 s89, s88, 2
    v_add_u32 v17, s89, v20
    v_xor_b32_e64 v17, v17, v19
    v_lshl_add_u32 v17, v17, 4, v22
    ds_read_b64_tr_b16 a[248:249], v17 offset:0
    ds_read_b64_tr_b16 a[250:251], v17 offset:20480
    s_add_u32 s89, s88, 4
    v_add_u32 v16, s89, v20
    v_xor_b32_e64 v16, v16, v19
    v_lshl_add_u32 v16, v16, 4, v22
    ds_read_b64_tr_b16 v[192:193], v16 offset:0
    ds_read_b64_tr_b16 v[194:195], v16 offset:20480
    s_add_u32 s89, s88, 6
    v_add_u32 v17, s89, v20
    v_xor_b32_e64 v17, v17, v19
    v_lshl_add_u32 v17, v17, 4, v22
    ds_read_b64_tr_b16 v[200:201], v17 offset:0
    ds_read_b64_tr_b16 v[202:203], v17 offset:20480
    s_add_u32 s89, s88, 8
    v_add_u32 v16, s89, v20
    v_xor_b32_e64 v16, v16, v19
    v_lshl_add_u32 v16, v16, 4, v22
    ds_read_b64_tr_b16 v[208:209], v16 offset:0
    ds_read_b64_tr_b16 v[210:211], v16 offset:20480
    s_waitcnt lgkmcnt(0)
    s_add_u32 s89, s88, 10
    v_add_u32 v17, s89, v20
    v_xor_b32 v17, v17, v19
    v_lshl_add_u32 v17, v17, 4, v22
    ds_read_b64_tr_b16 v[216:217], v17 offset:0
    ds_read_b64_tr_b16 v[218:219], v17 offset:20480
    s_add_u32 s89, s88, 12
    v_add_u32 v16, s89, v20
    v_xor_b32_e64 v16, v16, v19
    v_lshl_add_u32 v16, v16, 4, v22
    ds_read_b64_tr_b16 v[224:225], v16 offset:0
    ds_read_b64_tr_b16 v[226:227], v16 offset:20480
    s_add_u32 s89, s88, 14
    v_add_u32 v17, s89, v20
    v_xor_b32_e64 v17, v17, v19
    v_lshl_add_u32 v17, v17, 4, v22
    ds_read_b64_tr_b16 v[232:233], v17 offset:0
    ds_read_b64_tr_b16 v[234:235], v17 offset:20480
    s_add_u32 s89, s88, 16
    v_add_u32 v16, s89, v20
    v_xor_b32_e64 v16, v16, v19
    v_lshl_add_u32 v16, v16, 4, v22
    ds_read_b64_tr_b16 v[240:241], v16 offset:0
    ds_read_b64_tr_b16 v[242:243], v16 offset:20480
    s_add_u32 s89, s88, 18
    v_add_u32 v17, s89, v20
    v_xor_b32_e64 v17, v17, v19
    v_lshl_add_u32 v17, v17, 4, v22
    ds_read_b64_tr_b16 v[248:249], v17 offset:0
    ds_read_b64_tr_b16 v[250:251], v17 offset:20480
    s_waitcnt lgkmcnt(0)
    s_waitcnt vmcnt(0)
    s_barrier
    v_lshrrev_b32 v16, 4, v0
    v_bfe_u32 v17, v0, 2, 2
    v_lshl_add_u32 v17, v16, 2, v17
    v_and_b32 v19, 7, v17
    v_lshlrev_b32 v19, 1, v19
    v_mul_u32_u24 v22, 1280, v17
    v_and_b32_e64 v20, 1, v0
    v_lshl_add_u32 v22, v20, 3, v22
    v_add_u32 v22, 122880, v22
    v_bfe_u32 v20, v0, 1, 1
    s_mul_i32 s88, s28, 20
    s_add_u32 s89, s88, 0
    v_add_u32 v16, s89, v20
    v_xor_b32 v16, v16, v19
    v_lshl_add_u32 v16, v16, 4, v22
    ds_read_b64_tr_b16 a[244:245], v16 offset:0
    ds_read_b64_tr_b16 a[246:247], v16 offset:20480
    s_add_u32 s89, s88, 2
    v_add_u32 v17, s89, v20
    v_xor_b32_e64 v17, v17, v19
    v_lshl_add_u32 v17, v17, 4, v22
    ds_read_b64_tr_b16 a[252:253], v17 offset:0
    ds_read_b64_tr_b16 a[254:255], v17 offset:20480
    s_add_u32 s89, s88, 4
    v_add_u32 v16, s89, v20
    v_xor_b32_e64 v16, v16, v19
    v_lshl_add_u32 v16, v16, 4, v22
    ds_read_b64_tr_b16 v[196:197], v16 offset:0
    ds_read_b64_tr_b16 v[198:199], v16 offset:20480
    s_add_u32 s89, s88, 6
    v_add_u32 v17, s89, v20
    v_xor_b32_e64 v17, v17, v19
    v_lshl_add_u32 v17, v17, 4, v22
    ds_read_b64_tr_b16 v[204:205], v17 offset:0
    ds_read_b64_tr_b16 v[206:207], v17 offset:20480
    s_add_u32 s89, s88, 8
    v_add_u32 v16, s89, v20
    v_xor_b32_e64 v16, v16, v19
    v_lshl_add_u32 v16, v16, 4, v22
    ds_read_b64_tr_b16 v[212:213], v16 offset:0
    ds_read_b64_tr_b16 v[214:215], v16 offset:20480
    s_waitcnt lgkmcnt(0)
    s_add_u32 s89, s88, 10
    v_add_u32 v17, s89, v20
    v_xor_b32 v17, v17, v19
    v_lshl_add_u32 v17, v17, 4, v22
    ds_read_b64_tr_b16 v[220:221], v17 offset:0
    ds_read_b64_tr_b16 v[222:223], v17 offset:20480
    s_add_u32 s89, s88, 12
    v_add_u32 v16, s89, v20
    v_xor_b32_e64 v16, v16, v19
    v_lshl_add_u32 v16, v16, 4, v22
    ds_read_b64_tr_b16 v[228:229], v16 offset:0
    ds_read_b64_tr_b16 v[230:231], v16 offset:20480
    s_add_u32 s89, s88, 14
    v_add_u32 v17, s89, v20
    v_xor_b32_e64 v17, v17, v19
    v_lshl_add_u32 v17, v17, 4, v22
    ds_read_b64_tr_b16 v[236:237], v17 offset:0
    ds_read_b64_tr_b16 v[238:239], v17 offset:20480
    s_add_u32 s89, s88, 16
    v_add_u32 v16, s89, v20
    v_xor_b32_e64 v16, v16, v19
    v_lshl_add_u32 v16, v16, 4, v22
    ds_read_b64_tr_b16 v[244:245], v16 offset:0
    ds_read_b64_tr_b16 v[246:247], v16 offset:20480
    s_add_u32 s89, s88, 18
    v_add_u32 v17, s89, v20
    v_xor_b32_e64 v17, v17, v19
    v_lshl_add_u32 v17, v17, 4, v22
    ds_read_b64_tr_b16 v[252:253], v17 offset:0
    ds_read_b64_tr_b16 v[254:255], v17 offset:20480
    s_waitcnt lgkmcnt(0)
    s_waitcnt lgkmcnt(0)
    s_cmp_eq_u32 s3, 1
    s_cbranch_scc1 cck_ok_4
    s_mov_b32 s90, 0
    v_and_b32 v16, 7, v0
    v_lshlrev_b32 v16, 5, v16
    v_lshrrev_b32 v17, 3, v0
    v_lshl_add_u32 v16, v17, 2, v16
cck_5:
    s_mov_b64 exec, 0xffff
    global_load_dword v17, v16, s[24:25] sc1
    s_waitcnt vmcnt(0)
    v_cmp_ne_u32_e64 vcc, 32, v17
    s_mov_b64 exec, -1
    s_cbranch_vccz cck_ok_4
    s_mov_b32 s91, 0
    v_readlane_b32 s92, v17, 8
    s_add_u32 s91, s91, s92
    v_readlane_b32 s92, v17, 9
    s_add_u32 s91, s91, s92
    v_readlane_b32 s92, v17, 10
    s_add_u32 s91, s91, s92
    v_readlane_b32 s92, v17, 11
    s_add_u32 s91, s91, s92
    v_readlane_b32 s92, v17, 12
    s_add_u32 s91, s91, s92
    v_readlane_b32 s92, v17, 13
    s_add_u32 s91, s91, s92
    v_readlane_b32 s92, v17, 14
    s_add_u32 s91, s91, s92
    v_readlane_b32 s92, v17, 15
    s_add_u32 s91, s91, s92
    s_cmp_ge_u32 s91, 256
    s_cbranch_scc1 k_reassign
    s_add_u32 s90, s90, 1
    s_cmp_lt_u32 s90, 300000
    s_cbranch_scc0 k_fail
    s_sleep 1
    s_branch cck_5
cck_ok_4:
    s_lshl_b32 s8, s73, 4
    s_add_u32 s8, s8, 0
    s_add_u32 s9, s8, 1024
    v_mov_b32 v112, 0
    v_mov_b32 v113, 0
    v_mov_b32 v114, 0
    v_mov_b32 v115, 0
    v_mov_b32 v116, 0
    v_mov_b32 v117, 0
    v_mov_b32 v118, 0
    v_mov_b32 v119, 0
    v_mov_b32 v120, 0
    v_mov_b32 v121, 0
    v_mov_b32 v122, 0
    v_mov_b32 v123, 0
    s_cmp_eq_u32 s28, 3
    s_cbranch_scc0 pf0skip_6
    s_lshr_b32 s88, s64, 2
    s_add_u32 s88, s88, 1
    s_min_u32 s88, s88, 16
    s_cmp_ge_u32 s87, s88
    s_cbranch_scc1 w1ok_7
    v_mov_b32 v16, 0
    s_mov_b32 s66, 0
w1poll_8:
    buffer_load_dwordx4 v[144:147], v16, s[60:63], s8 offen sc1
    buffer_load_dwordx4 v[140:143], v16, s[60:63], s9 offen sc1
    s_waitcnt vmcnt(0)
    v_min3_u32 v17, v144, v145, v146
    v_min3_u32 v17, v147, v140, v17
    v_min3_u32 v17, v141, v142, v17
    v_min_u32 v17, v143, v17
    s_nop 0
    v_readfirstlane_b32 s87, v17
    s_cmp_ge_u32 s87, s88
    s_cbranch_scc1 w1ok_7
    s_add_u32 s66, s66, 1
    s_cmp_lt_u32 s66, 400000
    s_cbranch_scc1 w1poll_8
    s_branch k_fail
w1ok_7:
    s_mov_b32 s93, 32768
    s_lshl_b32 s88, s64, 18
    s_add_u32 s88, s88, s76
    s_mov_b32 m0, s93
    s_nop 0
    buffer_load_dwordx4 v2, s[52:55], s88 offen offset:0 sc1 lds
    buffer_load_dwordx4 v2, s[52:55], s88 offen offset:1024 sc1 lds
    buffer_load_dwordx4 v2, s[52:55], s88 offen offset:2048 sc1 lds
    buffer_load_dwordx4 v2, s[52:55], s88 offen offset:3072 sc1 lds
    s_add_u32 s89, s93, 4096
    s_mov_b32 m0, s89
    s_nop 0
    buffer_load_dwordx4 v2, s[56:59], s88 offen offset:0 sc1 lds
    buffer_load_dwordx4 v2, s[56:59], s88 offen offset:1024 sc1 lds
    buffer_load_dwordx4 v2, s[56:59], s88 offen offset:2048 sc1 lds
    buffer_load_dwordx4 v2, s[56:59], s88 offen offset:3072 sc1 lds
    s_mov_b32 s93, 40960
    s_mov_b32 s94, 1
    s_lshl_b32 s88, s94, 18
    s_add_u32 s88, s88, s76
    s_mov_b32 m0, s93
    s_nop 0
    buffer_load_dwordx4 v2, s[52:55], s88 offen offset:0 sc1 lds
    buffer_load_dwordx4 v2, s[52:55], s88 offen offset:1024 sc1 lds
    buffer_load_dwordx4 v2, s[52:55], s88 offen offset:2048 sc1 lds
    buffer_load_dwordx4 v2, s[52:55], s88 offen offset:3072 sc1 lds
    s_add_u32 s89, s93, 4096
    s_mov_b32 m0, s89
    s_nop 0
    buffer_load_dwordx4 v2, s[56:59], s88 offen offset:0 sc1 lds
    buffer_load_dwordx4 v2, s[56:59], s88 offen offset:1024 sc1 lds
    buffer_load_dwordx4 v2, s[56:59], s88 offen offset:2048 sc1 lds
    buffer_load_dwordx4 v2, s[56:59], s88 offen offset:3072 sc1 lds
pf0skip_6:
    s_lshr_b32 s18, s40, 21
    s_xor_b32 s18, s18, 0
    s_add_u32 s88, s40, s72
    s_lshr_b32 s88, s88, 21
    s_xor_b32 s88, s88, s18
    s_and_b32 s88, s88, 1
    s_lshl_b32 s19, s88, 13
    s_mov_b32 s77, 0x3f80
    s_mov_b32 s70, 0x3f800000
    s_mov_b32 s86, 0xffff0000
    s_cmp_lt_u32 s28, 2
    s_mov_b32 s89, 75497472
    s_cselect_b32 s88, 67108864, s89
    s_add_u32 s44, s26, s88
    s_addc_u32 s45, s27, 0
    s_and_b32 s45, s45, 0xffff
    s_mov_b32 s46, 8388608
    s_mov_b32 s47, 0x20000
    s_lshl_b32 s88, s28, 10
    s_add_u32 s88, s88, s74
    s_cmp_lt_u32 s28, 2
    s_cselect_b32 s100, s88, s75
    s_mov_b32 s89, 65536
    s_cselect_b32 s74, 131072, s89
    s_lshl_b32 s88, s28, 10
    s_add_u32 s88, s88, 21504
    s_cmp_lt_u32 s28, 2
    s_cselect_b32 s88, s88, 23552
    v_add_u32 v22, s88, v2
    s_cmp_eq_u32 s28, 3
    s_cselect_b32 s88, 1073741824, 0
    v_add_u32 v21, s88, v2
    s_lshl_b32 s89, s30, 7
    s_add_u32 s89, s89, 16384
    v_mov_b32 v23, 1073741824
    v_mov_b32 v20, s89
    v_cmp_eq_u32 vcc, 0, v0
    s_nop 1
    v_cndmask_b32 v23, v23, v20, vcc
    s_or_b32 s95, s31, s28
    s_cmp_lt_u32 s28, 2
    s_mov_b32 s89, 33554432
    s_cselect_b32 s88, 0, s89
    s_add_u32 s52, s26, s88
    s_addc_u32 s53, s27, 0
    s_and_b32 s53, s53, 0xffff
    s_mov_b32 s54, 16777216
    s_mov_b32 s55, 0x20000
    s_and_b32 s88, s28, 1
    s_lshl_b32 s88, s88, 11
    s_add_u32 s101, s88, s76
    s_lshl_b32 s85, s28, 11
    s_add_u32 s85, s85, 32768
    s_waitcnt vmcnt(0) lgkmcnt(0)
    s_barrier
    ds_read_b128 v[72:75], v2 offset:0
    ds_read_b128 v[76:79], v2 offset:1024
    ds_read_b128 v[80:83], v2 offset:2048
    ds_read_b128 v[84:87], v2 offset:3072
    s_waitcnt lgkmcnt(3)
    v_smfmac_f32_16x16x64_bf16 v[112:115], v[72:75], a[0:7], v1
    ds_read_b128 v[88:91], v2 offset:4096
    v_smfmac_f32_16x16x64_bf16 v[116:119], v[72:75], a[80:87], v1
    s_waitcnt lgkmcnt(3)
    v_smfmac_f32_16x16x64_bf16 v[112:115], v[76:79], a[8:15], v1
    ds_read_b128 v[92:95], v2 offset:5120
    v_smfmac_f32_16x16x64_bf16 v[116:119], v[76:79], a[88:95], v1
    s_waitcnt lgkmcnt(3)
    v_smfmac_f32_16x16x64_bf16 v[112:115], v[80:83], a[16:23], v1
    ds_read_b128 v[96:99], v2 offset:6144
    v_smfmac_f32_16x16x64_bf16 v[116:119], v[80:83], a[96:103], v1
    s_waitcnt lgkmcnt(3)
    v_smfmac_f32_16x16x64_bf16 v[112:115], v[84:87], a[24:31], v1
    ds_read_b128 v[100:103], v2 offset:7168
    v_smfmac_f32_16x16x64_bf16 v[116:119], v[84:87], a[104:111], v1
    s_waitcnt lgkmcnt(3)
    v_smfmac_f32_16x16x64_bf16 v[112:115], v[88:91], a[32:39], v1
    ds_read_b128 v[104:107], v2 offset:8192
    v_smfmac_f32_16x16x64_bf16 v[116:119], v[88:91], a[112:119], v1
    s_waitcnt lgkmcnt(3)
    v_smfmac_f32_16x16x64_bf16 v[112:115], v[92:95], a[40:47], v1
    ds_read_b128 v[108:111], v2 offset:9216
    v_smfmac_f32_16x16x64_bf16 v[116:119], v[92:95], a[120:127], v1
    s_waitcnt lgkmcnt(3)
    v_smfmac_f32_16x16x64_bf16 v[112:115], v[96:99], a[48:55], v1
    ds_read_b128 v[140:143], v8 offset:0
    ds_read_b128 v[144:147], v8 offset:1024
    v_smfmac_f32_16x16x64_bf16 v[116:119], v[96:99], a[128:135], v1
    s_waitcnt lgkmcnt(4)
    v_smfmac_f32_16x16x64_bf16 v[112:115], v[100:103], a[56:63], v1
    ds_read_b128 v[148:151], v8 offset:2048
    ds_read_b128 v[152:155], v8 offset:3072
    v_smfmac_f32_16x16x64_bf16 v[116:119], v[100:103], a[136:143], v1
    s_waitcnt lgkmcnt(5)
    v_smfmac_f32_16x16x64_bf16 v[112:115], v[104:107], a[64:71], v1
    v_smfmac_f32_16x16x64_bf16 v[116:119], v[104:107], a[144:151], v1
    s_waitcnt lgkmcnt(4)
    v_smfmac_f32_16x16x64_bf16 v[112:115], v[108:111], a[72:79], v1
    v_smfmac_f32_16x16x64_bf16 v[116:119], v[108:111], a[152:159], v1
    s_branch phaseB_9
.p2align 6
    s_nop 0
    s_nop 0
step_10:
    s_waitcnt vmcnt(0) lgkmcnt(0)
    s_barrier
    s_add_u32 s64, s64, 1
    s_xor_b32 s65, s65, 1
    s_add_u32 s71, s71, 65536
    s_add_u32 s72, s72, 65536
    s_cmp_eq_u32 s64, 3
    s_cbranch_scc0 nofb_11
    v_mov_b32 v16, 24576
    ds_read_b32 v17, v16
    s_waitcnt lgkmcnt(0)
    v_readfirstlane_b32 s91, v17
    s_lshr_b32 s91, s91, 1
    s_lshr_b32 s18, s40, 21
    s_xor_b32 s18, s18, s91
nofb_11:
    s_add_u32 s91, s40, s72
    s_lshr_b32 s91, s91, 21
    s_xor_b32 s91, s91, s18
    s_and_b32 s91, s91, 1
    s_lshl_b32 s19, s91, 13
    v_xor_b32 v8, 0x2000, v8
ag_12:
    buffer_load_dwordx4 v[124:127], v14, s[40:43], s97 offen sc1
    buffer_load_dwordx4 v[128:131], v188, s[40:43], s97 offen sc1
    buffer_load_dwordx2 v[132:133], v189, s[40:43], s97 offen sc1
    buffer_load_dwordx4 v[134:137], v14, s[40:43], s98 offen sc1
    buffer_load_dwordx4 v[138:141], v188, s[40:43], s98 offen sc1
    buffer_load_dwordx2 v[142:143], v189, s[40:43], s98 offen sc1
.p2align 5
    s_waitcnt vmcnt(0)
    v_max3_u32 v16, v124, v126, v128
    v_max3_u32 v17, v130, v132, v134
    v_max3_u32 v16, v136, v138, v16
    v_max3_u32 v17, v140, v142, v17
    v_max_u32 v16, v16, v17
    v_cmp_eq_u32 vcc, -1, v16
    s_cbranch_vccnz ag_retry_13
    v_lshlrev_b32 v156, 16, v124
    v_and_b32 v157, s86, v124
    v_lshlrev_b32 v158, 16, v125
    v_and_b32 v159, s86, v125
    v_lshlrev_b32 v160, 16, v126
    v_and_b32 v161, s86, v126
    v_lshlrev_b32 v162, 16, v127
    v_and_b32 v163, s86, v127
    v_dot2c_f32_bf16 v156, s77, v134
    v_dot2c_f32_bf16 v157, s70, v134
    v_dot2c_f32_bf16 v158, s77, v135
    v_dot2c_f32_bf16 v159, s70, v135
    v_dot2c_f32_bf16 v160, s77, v136
    v_dot2c_f32_bf16 v161, s70, v136
    v_dot2c_f32_bf16 v162, s77, v137
    v_dot2c_f32_bf16 v163, s70, v137
    v_cvt_pk_bf16_f32 v124, v156, v157
    v_cvt_pk_bf16_f32 v125, v158, v159
    v_cvt_pk_bf16_f32 v126, v160, v161
    v_cvt_pk_bf16_f32 v127, v162, v163
    ds_write_b128 v15, v[124:127]
    v_lshlrev_b32 v164, 16, v128
    v_and_b32 v165, s86, v128
    v_lshlrev_b32 v166, 16, v129
    v_and_b32 v167, s86, v129
    v_lshlrev_b32 v168, 16, v130
    v_and_b32 v169, s86, v130
    v_lshlrev_b32 v170, 16, v131
    v_and_b32 v171, s86, v131
    v_dot2c_f32_bf16 v164, s77, v138
    v_dot2c_f32_bf16 v165, s70, v138
    v_dot2c_f32_bf16 v166, s77, v139
    v_dot2c_f32_bf16 v167, s70, v139
    v_dot2c_f32_bf16 v168, s77, v140
    v_dot2c_f32_bf16 v169, s70, v140
    v_dot2c_f32_bf16 v170, s77, v141
    v_dot2c_f32_bf16 v171, s70, v141
    v_cvt_pk_bf16_f32 v128, v164, v165
    v_cvt_pk_bf16_f32 v129, v166, v167
    v_cvt_pk_bf16_f32 v130, v168, v169
    v_cvt_pk_bf16_f32 v131, v170, v171
    ds_write_b128 v15, v[128:131] offset:1024
    v_lshlrev_b32 v172, 16, v132
    v_and_b32 v173, s86, v132
    v_lshlrev_b32_e64 v174, 16, v133
    v_and_b32 v175, s86, v133
    v_dot2c_f32_bf16 v172, s77, v142
    v_dot2c_f32_bf16 v173, s70, v142
    v_dot2c_f32_bf16 v174, s77, v143
    v_dot2c_f32_bf16 v175, s70, v143
    s_nop 0
    v_cvt_pk_bf16_f32 v132, v172, v173
    s_nop 0
    v_cvt_pk_bf16_f32 v133, v174, v175
    ds_write_b64 v190, v[132:133]
    v_mov_b32 v20, s10
    buffer_store_dword v20, v23, s[60:63], s29 offen sc1
    buffer_store_dwordx4 v[176:179], v21, s[44:47], s100 offen sc1
    s_add_u32 s100, s100, s74
    buffer_load_dwordx4 v2, s[52:55], s17 offen offset:0 sc1 lds
    buffer_load_dwordx4 v2, s[52:55], s17 offen offset:1024 sc1 lds
.p2align 5
    s_waitcnt lgkmcnt(0)
    s_barrier
    ds_read_b128 v[72:75], v2 offset:0
    ds_read_b128 v[76:79], v2 offset:1024
    ds_read_b128 v[80:83], v2 offset:2048
    ds_read_b128 v[84:87], v2 offset:3072
    s_waitcnt lgkmcnt(3)
    v_smfmac_f32_16x16x64_bf16 v[112:115], v[72:75], a[0:7], v1
    ds_read_b128 v[88:91], v2 offset:4096
    v_smfmac_f32_16x16x64_bf16 v[116:119], v[72:75], a[80:87], v1
    s_waitcnt lgkmcnt(3)
    v_smfmac_f32_16x16x64_bf16 v[112:115], v[76:79], a[8:15], v1
    ds_read_b128 v[92:95], v2 offset:5120
    v_smfmac_f32_16x16x64_bf16 v[116:119], v[76:79], a[88:95], v1
    s_waitcnt lgkmcnt(3)
    v_smfmac_f32_16x16x64_bf16 v[112:115], v[80:83], a[16:23], v1
    ds_read_b128 v[96:99], v2 offset:6144
    v_smfmac_f32_16x16x64_bf16 v[116:119], v[80:83], a[96:103], v1
    s_waitcnt lgkmcnt(3)
    v_smfmac_f32_16x16x64_bf16 v[112:115], v[84:87], a[24:31], v1
    ds_read_b128 v[100:103], v2 offset:7168
    v_smfmac_f32_16x16x64_bf16 v[116:119], v[84:87], a[104:111], v1
    s_waitcnt lgkmcnt(3)
    v_smfmac_f32_16x16x64_bf16 v[112:115], v[88:91], a[32:39], v1
    ds_read_b128 v[104:107], v2 offset:8192
    v_smfmac_f32_16x16x64_bf16 v[116:119], v[88:91], a[112:119], v1
    s_waitcnt lgkmcnt(3)
    v_smfmac_f32_16x16x64_bf16 v[112:115], v[92:95], a[40:47], v1
    ds_read_b128 v[108:111], v2 offset:9216
    v_smfmac_f32_16x16x64_bf16 v[116:119], v[92:95], a[120:127], v1
    s_waitcnt lgkmcnt(3)
    v_smfmac_f32_16x16x64_bf16 v[112:115], v[96:99], a[48:55], v1
    ds_read_b128 v[140:143], v8 offset:0
    ds_read_b128 v[144:147], v8 offset:1024
    v_smfmac_f32_16x16x64_bf16 v[116:119], v[96:99], a[128:135], v1
    s_waitcnt lgkmcnt(4)
    v_smfmac_f32_16x16x64_bf16 v[112:115], v[100:103], a[56:63], v1
    ds_read_b128 v[148:151], v8 offset:2048
    ds_read_b128 v[152:155], v8 offset:3072
    v_smfmac_f32_16x16x64_bf16 v[116:119], v[100:103], a[136:143], v1
    s_waitcnt lgkmcnt(5)
    v_smfmac_f32_16x16x64_bf16 v[112:115], v[104:107], a[64:71], v1
    v_smfmac_f32_16x16x64_bf16 v[116:119], v[104:107], a[144:151], v1
    s_waitcnt lgkmcnt(4)
    v_smfmac_f32_16x16x64_bf16 v[112:115], v[108:111], a[72:79], v1
    v_smfmac_f32_16x16x64_bf16 v[116:119], v[108:111], a[152:159], v1
phaseB_9:
    v_smfmac_f32_16x16x64_bf16 v[120:123], v[72:75], a[160:167], v1
    s_nop 6
    v_permlane32_swap_b32 v112, v116
    v_permlane32_swap_b32 v113, v117
    v_permlane32_swap_b32 v114, v118
    v_permlane32_swap_b32 v115, v119
    v_add_f32 v112, v112, v116
    v_add_f32 v113, v113, v117
    v_add_f32 v114, v114, v118
    v_add_f32_e64 v115, v115, v119
    v_cvt_pk_bf16_f32 v116, v112, v113
    v_cvt_pk_bf16_f32 v117, v114, v115
    ds_write_b32 v3, v116
    ds_write_b32 v4, v117
    v_smfmac_f32_16x16x64_bf16 v[120:123], v[76:79], a[168:175], v1
    v_smfmac_f32_16x16x64_bf16 v[120:123], v[80:83], a[176:183], v1
.p2align 5
    s_waitcnt lgkmcnt(0)
    s_barrier
    ds_read_b64_tr_b16 v[124:125], v6 offset:0
    ds_read_b64_tr_b16 v[126:127], v6 offset:256
    ds_read_b64_tr_b16 v[132:133], v7 offset:0
    ds_read_b64_tr_b16 v[134:135], v7 offset:512
    ds_read_b64_tr_b16 v[128:129], v6 offset:512
    ds_read_b64_tr_b16 v[130:131], v6 offset:768
    ds_read_b64_tr_b16 v[136:137], v7 offset:1024
    ds_read_b64_tr_b16 v[138:139], v7 offset:1536
    v_smfmac_f32_16x16x64_bf16 v[120:123], v[84:87], a[184:191], v1
    v_smfmac_f32_16x16x64_bf16 v[120:123], v[88:91], a[192:199], v1
    s_waitcnt lgkmcnt(6)
    v_mfma_f32_16x16x32_bf16 v[160:163], v[140:143], v[124:127], 0
    v_mfma_f32_16x16x32_bf16 v[164:167], v[144:147], v[124:127], 0
    s_waitcnt lgkmcnt(4)
    v_mfma_f32_16x16x32_bf16 v[156:159], v[132:135], v[124:127], 0
    s_waitcnt lgkmcnt(2)
    v_mfma_f32_16x16x32_bf16 v[160:163], v[148:151], v[128:131], v[160:163]
    v_mfma_f32_16x16x32_bf16 v[164:167], v[152:155], v[128:131], v[164:167]
    s_waitcnt lgkmcnt(0)
    v_mfma_f32_16x16x32_bf16 v[156:159], v[136:139], v[128:131], v[156:159]
    v_smfmac_f32_16x16x64_bf16 v[120:123], v[92:95], a[200:207], v1
    v_smfmac_f32_16x16x64_bf16 v[120:123], v[96:99], a[208:215], v1
    s_cmp_eq_u32 s28, 0
    s_cbranch_scc0 pairskip_15
    s_nop 0
    v_and_or_b32 v160, v160, -2, s65
    v_and_or_b32 v164, v164, -2, s65
    s_nop 0
    v_and_or_b32 v156, v156, -2, s65
    buffer_store_dwordx4 v[160:163], v11, s[36:39], s67 offen
    buffer_store_dwordx4 v[164:167], v11, s[36:39], s67 offen offset:512
    buffer_store_dwordx2 v[156:157], v11, s[36:39], s67 offen offset:1024
pairskip_15:
    v_smfmac_f32_16x16x64_bf16 v[120:123], v[100:103], a[216:223], v1
    v_smfmac_f32_16x16x64_bf16 v[120:123], v[104:107], a[224:231], v1
    v_smfmac_f32_16x16x64_bf16 v[120:123], v[108:111], a[232:239], v1
    ds_read_b128 v[124:127], v8 offset:4096
    ds_read_b128 v[128:131], v8 offset:5120
    ds_read_b128 v[132:135], v8 offset:6144
    ds_read_b128 v[136:139], v8 offset:7168
    v_mov_b32 v141, 0
    v_mov_b32 v143, 0
    v_mov_b32 v145, 0
    v_mov_b32 v147, 0
    v_mov_b32_e64 v117, 0
    s_and_b32 s88, s64, 7
    s_cmp_eq_u32 s88, 0
    s_cselect_b32 s29, 0, 1073741824
    s_cmp_ge_u32 s64, 58
    s_cselect_b32 s29, 0, s29
    s_cmp_eq_u32 s95, 0
    s_cselect_b32 s29, s29, 1073741824
    s_add_u32 s88, s64, 2
    s_min_u32 s88, s88, 63
    s_and_b32 s89, s64, 1
    s_lshl_b32 s88, s88, 18
    s_lshl_b32 s89, s89, 13
    s_add_u32 s17, s88, s101
    s_add_u32 m0, s89, s85
    buffer_load_dwordx4 v[168:171], v10, s[36:39], s68 offen sc1
    buffer_load_dwordx4 v[172:175], v10, s[36:39], s68 offen offset:512 sc1
    buffer_load_dwordx2 v[176:177], v10, s[36:39], s68 offen offset:1024 sc1
    v_permlane32_swap_b32 v120, v122
    v_permlane32_swap_b32 v121, v123
    v_add_f32 v120, v120, v122
    v_add_f32 v121, v121, v123
    v_cvt_pk_bf16_f32 v120, v120, v121
    ds_write_b32 v5, v120
    s_waitcnt lgkmcnt(0)
    s_barrier
    s_cmp_eq_u32 s64, 63
    s_cbranch_scc1 laststep_14
    ds_read_b32 v140, v9 offset:0
    ds_read_b32 v142, v9 offset:256
    ds_read_b32 v144, v9 offset:512
    ds_read_b32 v146, v9 offset:768
    s_mov_b32 s66, 0
.p2align 5
    s_waitcnt vmcnt(0)
    v_bitop3_b32 v16, v168, v172, s65 bitop3:0x7e
    v_bitop3_b32 v16, v16, v176, s65 bitop3:0xf6
    v_and_b32 v16, 1, v16
    v_cmp_ne_u32 vcc, 0, v16
    s_cbranch_vccnz pair2_16
    v_pk_add_f32 v[160:161], v[160:161], v[168:169]
    v_pk_add_f32 v[162:163], v[162:163], v[170:171]
    v_pk_add_f32 v[164:165], v[164:165], v[172:173]
    v_pk_add_f32 v[166:167], v[166:167], v[174:175]
    v_pk_add_f32 v[156:157], v[156:157], v[176:177]
pairjoin_18:
    v_max3_f32 v16, v160, v161, v162
    v_max3_f32 v17, v163, v164, v165
    v_max3_f32 v16, v166, v167, v16
    v_max3_f32 v17, v156, v157, v17
    v_max_f32 v16, v16, v17
    v_mov_b32 v17, v16
    s_nop 1
    v_permlane16_swap_b32 v16, v17
    v_max_f32 v16, v16, v17
    v_mov_b32 v17, v16
    s_nop 1
    v_permlane32_swap_b32 v16, v17
    v_max_f32 v16, v16, v17
    v_mul_f32 v16, s78, v16
    v_pk_fma_f32 v[160:161], v[160:161], s[78:79], v[16:17] op_sel_hi:[1,1,0] neg_lo:[0,0,1] neg_hi:[0,0,1]
    v_pk_fma_f32 v[162:163], v[162:163], s[78:79], v[16:17] op_sel_hi:[1,1,0] neg_lo:[0,0,1] neg_hi:[0,0,1]
    v_pk_fma_f32 v[164:165], v[164:165], s[78:79], v[16:17] op_sel_hi:[1,1,0] neg_lo:[0,0,1] neg_hi:[0,0,1]
    v_pk_fma_f32 v[166:167], v[166:167], s[78:79], v[16:17] op_sel_hi:[1,1,0] neg_lo:[0,0,1] neg_hi:[0,0,1]
    v_pk_fma_f32 v[156:157], v[156:157], s[78:79], v[16:17] op_sel_hi:[1,1,0] neg_lo:[0,0,1] neg_hi:[0,0,1]
    v_exp_f32 v160, v160
    v_exp_f32 v161, v161
    v_exp_f32 v162, v162
    v_exp_f32 v163, v163
    v_exp_f32 v164, v164
    v_exp_f32 v165, v165
    v_exp_f32 v166, v166
    v_exp_f32 v167, v167
    v_exp_f32 v156, v156
    v_exp_f32 v157, v157
    v_cvt_pk_bf16_f32 v112, v160, v161
    v_cvt_pk_bf16_f32 v113, v162, v163
    v_cvt_pk_bf16_f32 v114, v164, v165
    v_cvt_pk_bf16_f32 v115, v166, v167
    v_cvt_pk_bf16_f32 v116, v156, v157
    s_waitcnt vmcnt(0) lgkmcnt(0)
    v_mfma_f32_16x16x32_bf16 v[184:187], v[24:27], v[112:115], 0
    v_mfma_f32_16x16x32_bf16 v[168:171], v[124:127], v[112:115], 0
    v_mfma_f32_16x16x16_bf16 v[184:187], v[24:25], v[116:117], v[184:187]
    v_mfma_f32_16x16x32_bf16 v[172:175], v[128:131], v[112:115], 0
    v_mfma_f32_16x16x16_bf16 v[168:171], v[140:141], v[116:117], v[168:171]
    v_mfma_f32_16x16x16_bf16 v[172:175], v[142:143], v[116:117], v[172:175]
    v_mfma_f32_16x16x32_bf16 v[176:179], v[132:135], v[112:115], 0
    v_mfma_f32_16x16x32_bf16 v[180:183], v[136:139], v[112:115], 0
    v_mfma_f32_16x16x16_bf16 v[176:179], v[144:145], v[116:117], v[176:179]
    s_nop 1
    v_rcp_f32_e64 v16, v184
    v_mfma_f32_16x16x16_bf16 v[180:183], v[146:147], v[116:117], v[180:183]
    v_pk_mul_f32 v[168:169], v[168:169], v[16:17] op_sel_hi:[1,0]
    v_pk_mul_f32 v[170:171], v[170:171], v[16:17] op_sel_hi:[1,0]
    v_pk_mul_f32 v[172:173], v[172:173], v[16:17] op_sel_hi:[1,0]
    v_pk_mul_f32 v[174:175], v[174:175], v[16:17] op_sel_hi:[1,0]
    v_cvt_pk_bf16_f32 v156, v168, v169
    v_cvt_pk_bf16_f32 v157, v170, v171
    v_cvt_pk_bf16_f32 v158, v172, v173
    v_cvt_pk_bf16_f32 v159, v174, v175
    v_pk_mul_f32 v[176:177], v[176:177], v[16:17] op_sel_hi:[1,0]
    v_pk_mul_f32 v[178:179], v[178:179], v[16:17] op_sel_hi:[1,0]
    v_pk_mul_f32 v[180:181], v[180:181], v[16:17] op_sel_hi:[1,0]
    v_pk_mul_f32 v[182:183], v[182:183], v[16:17] op_sel_hi:[1,0]
    v_cvt_pk_bf16_f32 v160, v176, v177
    v_cvt_pk_bf16_f32 v161, v178, v179
    v_cvt_pk_bf16_f32 v162, v180, v181
    v_cvt_pk_bf16_f32 v163, v182, v183
    v_mfma_f32_16x16x32_bf16 v[32:35], a[240:243], v[156:159], 0
    v_mfma_f32_16x16x32_bf16 v[36:39], a[248:251], v[156:159], 0
    v_mfma_f32_16x16x32_bf16 v[32:35], a[244:247], v[160:163], v[32:35]
    v_mfma_f32_16x16x32_bf16 v[36:39], a[252:255], v[160:163], v[36:39]
    v_mfma_f32_16x16x32_bf16 v[40:43], v[192:195], v[156:159], 0
    v_mfma_f32_16x16x32_bf16 v[44:47], v[200:203], v[156:159], 0
    v_mfma_f32_16x16x32_bf16 v[40:43], v[196:199], v[160:163], v[40:43]
    v_mfma_f32_16x16x32_bf16 v[44:47], v[204:207], v[160:163], v[44:47]
    v_mfma_f32_16x16x32_bf16 v[48:51], v[208:211], v[156:159], 0
    v_mfma_f32_16x16x32_bf16 v[52:55], v[216:219], v[156:159], 0
    v_mfma_f32_16x16x32_bf16 v[48:51], v[212:215], v[160:163], v[48:51]
    v_cvt_pk_bf16_f32 v168, v32, v33
    v_cvt_pk_bf16_f32 v169, v34, v35
    v_mfma_f32_16x16x32_bf16 v[52:55], v[220:223], v[160:163], v[52:55]
    v_cvt_pk_bf16_f32 v170, v36, v37
    v_cvt_pk_bf16_f32 v171, v38, v39
    v_mfma_f32_16x16x32_bf16 v[56:59], v[224:227], v[156:159], 0
    v_and_or_b32 v168, v168, -2, s65
    buffer_store_dwordx4 v[168:171], v12, s[32:35], 0 offen
    v_mfma_f32_16x16x32_bf16 v[60:63], v[232:235], v[156:159], 0
    v_mfma_f32_16x16x32_bf16 v[56:59], v[228:231], v[160:163], v[56:59]
    v_cvt_pk_bf16_f32 v172, v40, v41
    v_cvt_pk_bf16_f32 v173, v42, v43
    v_mfma_f32_16x16x32_bf16 v[60:63], v[236:239], v[160:163], v[60:63]
    v_cvt_pk_bf16_f32 v174, v44, v45
    v_cvt_pk_bf16_f32 v175, v46, v47
    v_mfma_f32_16x16x32_bf16 v[64:67], v[240:243], v[156:159], 0
    v_and_or_b32 v172, v172, -2, s65
    buffer_store_dwordx4 v[172:175], v12, s[32:35], s80 offen
    v_mfma_f32_16x16x32_bf16 v[68:71], v[248:251], v[156:159], 0
    v_mfma_f32_16x16x32_bf16 v[64:67], v[244:247], v[160:163], v[64:67]
    v_cvt_pk_bf16_f32 v168, v48, v49
    v_cvt_pk_bf16_f32 v169, v50, v51
    v_mfma_f32_16x16x32_bf16 v[68:71], v[252:255], v[160:163], v[68:71]
    v_cvt_pk_bf16_f32 v170, v52, v53
    v_cvt_pk_bf16_f32 v171, v54, v55
    v_and_or_b32 v168, v168, -2, s65
    buffer_store_dwordx4 v[168:171], v12, s[32:35], s81 offen
    v_cvt_pk_bf16_f32 v172, v56, v57
    v_cvt_pk_bf16_f32 v173, v58, v59
    v_cvt_pk_bf16_f32 v174, v60, v61
    v_cvt_pk_bf16_f32 v175, v62, v63
    v_and_or_b32 v172, v172, -2, s65
    buffer_store_dwordx4 v[172:175], v12, s[32:35], s82 offen
    v_cvt_pk_bf16_f32 v168, v64, v65
    v_cvt_pk_bf16_f32 v169, v66, v67
    v_cvt_pk_bf16_f32 v170, v68, v69
    v_cvt_pk_bf16_f32 v171, v70, v71
    v_and_or_b32 v168, v168, -2, s65
    buffer_store_dwordx4 v[168:171], v12, s[32:35], s83 offen
    ds_read_b128 v[176:179], v22
    s_cmp_eq_u32 s28, 3
    s_cbranch_scc1 w3_20
    s_cmp_eq_u32 s69, -1
    s_cbranch_scc1 nonowner_21
    s_mov_b32 s66, 0
.p2align 5
    s_waitcnt vmcnt(0)
    v_mov_b32 v112, 0
    v_mov_b32 v113, 0
    v_mov_b32 v114, 0
    v_mov_b32 v115, 0
    v_mov_b32 v116, 0
    v_mov_b32 v117, 0
    v_mov_b32 v118, 0
    v_mov_b32 v119, 0
    v_mov_b32 v120, 0
    v_mov_b32 v121, 0
    v_mov_b32 v122, 0
    v_mov_b32_e64 v123, 0
    buffer_load_dwordx4 v[124:127], v2, s[32:35], s69 offen offset:0 sc1
    buffer_load_dwordx4 v[128:131], v2, s[32:35], s69 offen offset:1024 sc1
    buffer_load_dwordx4 v[132:135], v2, s[32:35], s69 offen offset:2048 sc1
    buffer_load_dwordx4 v[136:139], v2, s[32:35], s69 offen offset:3072 sc1
.p2align 5
    s_waitcnt vmcnt(0)
    v_bitop3_b32 v16, v124, v128, s65 bitop3:0x7e
    v_bitop3_b32 v17, v132, v136, s65 bitop3:0x7e
    v_or_b32 v16, v16, v17
    v_and_b32_e64 v16, 1, v16
    v_cmp_ne_u32 vcc, 0, v16
    s_cbranch_vccnz rs2_22
    v_mfma_f32_16x16x32_bf16 v[184:187], v[28:31], v[124:127], 0
    v_mfma_f32_16x16x32_bf16 v[184:187], v[28:31], v[128:131], v[184:187]
    v_mfma_f32_16x16x32_bf16 v[184:187], v[28:31], v[132:135], v[184:187]
    v_mfma_f32_16x16x32_bf16 v[184:187], v[28:31], v[136:139], v[184:187]
rsjoin_24:
    s_nop 7
    s_nop 0
    v_add_f32_dpp v184, v184, v184 row_ror:8 row_mask:0xf bank_mask:0xf
    v_add_f32_dpp v185, v185, v185 row_ror:8 row_mask:0xf bank_mask:0xf
    v_add_f32_dpp v186, v186, v186 row_ror:8 row_mask:0xf bank_mask:0xf
    v_add_f32_dpp v187, v187, v187 row_ror:8 row_mask:0xf bank_mask:0xf
    v_cvt_pk_bf16_f32 v168, v184, v185
    v_cvt_pk_bf16_f32 v169, v186, v187
    s_add_u32 s88, s71, s19
    buffer_store_dwordx2 v[168:169], v13, s[40:43], s88 offen sc1
agbar_19:
    s_mov_b32 s10, s64
    s_mov_b32 s66, 0
    s_add_u32 s97, s72, s19
    s_add_u32 s98, s97, 32768
    s_branch step_10
w3_20:
    v_mov_b32 v112, 0
    v_mov_b32 v113, 0
    v_mov_b32 v114, 0
    v_mov_b32 v115, 0
    v_mov_b32 v116, 0
    v_mov_b32 v117, 0
    v_mov_b32 v118, 0
    v_mov_b32 v119, 0
    v_mov_b32 v120, 0
    v_mov_b32 v121, 0
    v_mov_b32 v122, 0
    v_mov_b32 v123, 0
    s_cmp_eq_u32 s64, 1
    s_cbranch_scc0 noprb_25
    s_mov_b32 s66, 0
    v_mov_b32_e64 v16, 8
prb_26:
    global_load_dword v17, v16, s[24:25] sc1
    s_waitcnt vmcnt(0)
    v_readfirstlane_b32 s88, v17
    s_add_u32 s66, s66, 1
    s_cmp_lt_u32 s66, 400000
    s_cbranch_scc0 k_fail
    s_cmp_eq_u32 s88, 0
    s_cbranch_scc1 prb_26
    v_mov_b32 v16, 24576
    ds_write_b32 v16, v17
    s_waitcnt lgkmcnt(0)
noprb_25:
    s_add_u32 s94, s64, 2
    s_min_u32 s94, s94, 63
    s_lshr_b32 s88, s94, 2
    s_add_u32 s88, s88, 1
    s_min_u32 s88, s88, 16
    s_cmp_ge_u32 s87, s88
    s_cbranch_scc1 w1ok_27
    v_mov_b32 v16, 0
    s_mov_b32 s66, 0
w1poll_28:
    buffer_load_dwordx4 v[144:147], v16, s[60:63], s8 offen sc1
    buffer_load_dwordx4 v[140:143], v16, s[60:63], s9 offen sc1
    s_waitcnt vmcnt(0)
    v_min3_u32 v17, v144, v145, v146
    v_min3_u32 v17, v147, v140, v17
    v_min3_u32 v17, v141, v142, v17
    v_min_u32 v17, v143, v17
    s_nop 0
    v_readfirstlane_b32 s87, v17
    s_cmp_ge_u32 s87, s88
    s_cbranch_scc1 w1ok_27
    s_add_u32 s66, s66, 1
    s_cmp_lt_u32 s66, 400000
    s_cbranch_scc1 w1poll_28
    s_branch k_fail
w1ok_27:
    s_branch agbar_19
laststep_14:
    s_waitcnt vmcnt(0)
    ds_read_b128 v[176:179], v22
    s_waitcnt lgkmcnt(0)
    buffer_store_dwordx4 v[176:179], v21, s[44:47], s100 offen sc1
    s_add_u32 s100, s100, s74
    s_waitcnt vmcnt(0)
    s_barrier
    s_cmp_eq_u32 s28, 0
    s_cbranch_scc0 lastflag_29
    v_mov_b32 v16, 64
    v_mov_b32 v17, s96
    s_mov_b64 exec, 1
    buffer_store_dword v16, v17, s[60:63], 0 offen sc1
    s_mov_b64 exec, -1
lastflag_29:
    s_waitcnt vmcnt(0)
    s_branch k_exit
ag_retry_13:
    s_add_u32 s66, s66, 1
    s_cmp_lt_u32 s66, 400000
    s_cbranch_scc0 k_fail
    s_branch ag_12
pair2_16:
    buffer_load_dwordx4 v[178:181], v10, s[36:39], s68 offen sc1
    buffer_load_dwordx4 v[182:185], v10, s[36:39], s68 offen offset:512 sc1
    buffer_load_dwordx2 v[186:187], v10, s[36:39], s68 offen offset:1024 sc1
    s_waitcnt vmcnt(0)
pair2chk_30:
    v_bitop3_b32 v16, v178, v182, s65 bitop3:0x7e
    v_bitop3_b32 v16, v16, v186, s65 bitop3:0xf6
    v_and_b32 v16, 1, v16
    v_cmp_ne_u32 vcc, 0, v16
    s_cbranch_vccnz pair3_17
    v_pk_add_f32 v[160:161], v[160:161], v[178:179]
    v_pk_add_f32 v[162:163], v[162:163], v[180:181]
    v_pk_add_f32 v[164:165], v[164:165], v[182:183]
    v_pk_add_f32 v[166:167], v[166:167], v[184:185]
    v_pk_add_f32 v[156:157], v[156:157], v[186:187]
    s_branch pairjoin_18
pair3_17:
    s_add_u32 s66, s66, 1
    s_cmp_lt_u32 s66, 400000
    s_cbranch_scc0 k_fail
    buffer_load_dwordx4 v[178:181], v10, s[36:39], s68 offen sc1
    buffer_load_dwordx4 v[182:185], v10, s[36:39], s68 offen offset:512 sc1
    buffer_load_dwordx2 v[186:187], v10, s[36:39], s68 offen offset:1024 sc1
    s_waitcnt vmcnt(0)
    s_branch pair2chk_30
nonowner_21:
    v_mov_b32 v112, 0
    v_mov_b32 v113, 0
    v_mov_b32 v114, 0
    v_mov_b32 v115, 0
    v_mov_b32 v116, 0
    v_mov_b32 v117, 0
    v_mov_b32 v118, 0
    v_mov_b32 v119, 0
    v_mov_b32 v120, 0
    v_mov_b32 v121, 0
    v_mov_b32 v122, 0
    v_mov_b32 v123, 0
    s_branch agbar_19
rs2_22:
    buffer_load_dwordx4 v[140:143], v2, s[32:35], s69 offen offset:0 sc1
    buffer_load_dwordx4 v[144:147], v2, s[32:35], s69 offen offset:1024 sc1
    buffer_load_dwordx4 v[148:151], v2, s[32:35], s69 offen offset:2048 sc1
    buffer_load_dwordx4 v[152:155], v2, s[32:35], s69 offen offset:3072 sc1
    s_waitcnt vmcnt(0)
rs2chk_31:
    v_bitop3_b32 v16, v140, v144, s65 bitop3:0x7e
    v_bitop3_b32 v17, v148, v152, s65 bitop3:0x7e
    v_or_b32 v16, v16, v17
    v_and_b32_e64 v16, 1, v16
    v_cmp_ne_u32 vcc, 0, v16
    s_cbranch_vccnz rs3_23
    v_mfma_f32_16x16x32_bf16 v[184:187], v[28:31], v[140:143], 0
    v_mfma_f32_16x16x32_bf16 v[184:187], v[28:31], v[144:147], v[184:187]
    v_mfma_f32_16x16x32_bf16 v[184:187], v[28:31], v[148:151], v[184:187]
    v_mfma_f32_16x16x32_bf16 v[184:187], v[28:31], v[152:155], v[184:187]
    s_branch rsjoin_24
rs3_23:
    s_add_u32 s66, s66, 1
    s_cmp_lt_u32 s66, 400000
    s_cbranch_scc0 k_fail
    buffer_load_dwordx4 v[140:143], v2, s[32:35], s69 offen offset:0 sc1
    buffer_load_dwordx4 v[144:147], v2, s[32:35], s69 offen offset:1024 sc1
    buffer_load_dwordx4 v[148:151], v2, s[32:35], s69 offen offset:2048 sc1
    buffer_load_dwordx4 v[152:155], v2, s[32:35], s69 offen offset:3072 sc1
    s_waitcnt vmcnt(0)
    s_branch rs2chk_31
k_worker_spec:
    s_add_u32 s29, s100, 2
    s_sub_u32 s40, s29, 6
    s_cmp_ge_u32 s29, 6
    s_cselect_b32 s29, s40, s29
    s_lshl_b32 s29, s29, 5
    s_add_u32 s29, s29, s101
    s_cmp_eq_u32 s29, 128
    s_cbranch_scc0 k_worker
    s_waitcnt vmcnt(0)
    s_barrier
    s_cmp_eq_u32 s98, 1
    s_cbranch_scc1 idone_32
    s_mov_b32 s98, 1
    s_cmp_eq_u32 s28, 0
    s_cbranch_scc0 idone_32
    s_lshl_b32 s90, s100, 5
    s_add_u32 s90, s90, 4
    v_mov_b32 v8, s90
    v_mov_b32 v9, 1
    s_mov_b64 exec, 1
    global_atomic_add v8, v9, s[24:25] sc1
    s_mov_b64 exec, -1
idone_32:
    s_add_u32 s32, s26, 0x5c0ffff
    s_addc_u32 s33, s27, 0
    s_and_b32 s32, s32, 0xffff0000
    s_and_b32 s33, s33, 0xffff
    s_mov_b32 s34, 0x400000
    s_mov_b32 s35, 0x20000
    s_cmp_eq_u32 s28, 0
    s_cbranch_scc0 probe_skip_33
    v_lshlrev_b32 v1, 4, v0
    v_mov_b32 v4, 0
    v_mov_b32 v5, 0
    v_mov_b32 v6, 0
    v_mov_b32 v7, 0
    s_mov_b32 s40, 20480
    buffer_store_dwordx4 v[4:7], v1, s[32:35], s40 offen sc1
    s_mov_b32 s40, 21504
    buffer_store_dwordx4 v[4:7], v1, s[32:35], s40 offen sc1
    s_mov_b32 s40, 22528
    buffer_store_dwordx4 v[4:7], v1, s[32:35], s40 offen sc1
    s_mov_b32 s40, 23552
    buffer_store_dwordx4 v[4:7], v1, s[32:35], s40 offen sc1
    s_mov_b32 s40, 28672
    buffer_store_dwordx4 v[4:7], v1, s[32:35], s40 offen sc1
    s_mov_b32 s40, 29696
    buffer_store_dwordx4 v[4:7], v1, s[32:35], s40 offen sc1
    s_mov_b32 s40, 30720
    buffer_store_dwordx4 v[4:7], v1, s[32:35], s40 offen sc1
    s_mov_b32 s40, 31744
    buffer_store_dwordx4 v[4:7], v1, s[32:35], s40 offen sc1
    s_mov_b32 s40, 53248
    buffer_store_dwordx4 v[4:7], v1, s[32:35], s40 offen sc1
    s_mov_b32 s40, 54272
    buffer_store_dwordx4 v[4:7], v1, s[32:35], s40 offen sc1
    s_mov_b32 s40, 55296
    buffer_store_dwordx4 v[4:7], v1, s[32:35], s40 offen sc1
    s_mov_b32 s40, 56320
    buffer_store_dwordx4 v[4:7], v1, s[32:35], s40 offen sc1
    s_mov_b32 s40, 61440
    buffer_store_dwordx4 v[4:7], v1, s[32:35], s40 offen sc1
    s_mov_b32 s40, 62464
    buffer_store_dwordx4 v[4:7], v1, s[32:35], s40 offen sc1
    s_mov_b32 s40, 63488
    buffer_store_dwordx4 v[4:7], v1, s[32:35], s40 offen sc1
    s_mov_b32 s40, 64512
    buffer_store_dwordx4 v[4:7], v1, s[32:35], s40 offen sc1
    s_mov_b32 s40, 86016
    buffer_store_dwordx4 v[4:7], v1, s[32:35], s40 offen sc1
    s_mov_b32 s40, 87040
    buffer_store_dwordx4 v[4:7], v1, s[32:35], s40 offen sc1
    s_mov_b32 s40, 88064
    buffer_store_dwordx4 v[4:7], v1, s[32:35], s40 offen sc1
    s_mov_b32 s40, 89088
    buffer_store_dwordx4 v[4:7], v1, s[32:35], s40 offen sc1
    s_mov_b32 s40, 94208
    buffer_store_dwordx4 v[4:7], v1, s[32:35], s40 offen sc1
    s_mov_b32 s40, 95232
    buffer_store_dwordx4 v[4:7], v1, s[32:35], s40 offen sc1
    s_mov_b32 s40, 96256
    buffer_store_dwordx4 v[4:7], v1, s[32:35], s40 offen sc1
    s_mov_b32 s40, 97280
    buffer_store_dwordx4 v[4:7], v1, s[32:35], s40 offen sc1
    s_mov_b32 s40, 118784
    buffer_store_dwordx4 v[4:7], v1, s[32:35], s40 offen sc1
    s_mov_b32 s40, 119808
    buffer_store_dwordx4 v[4:7], v1, s[32:35], s40 offen sc1
    s_mov_b32 s40, 120832
    buffer_store_dwordx4 v[4:7], v1, s[32:35], s40 offen sc1
    s_mov_b32 s40, 121856
    buffer_store_dwordx4 v[4:7], v1, s[32:35], s40 offen sc1
    s_mov_b32 s40, 126976
    buffer_store_dwordx4 v[4:7], v1, s[32:35], s40 offen sc1
    s_mov_b32 s40, 128000
    buffer_store_dwordx4 v[4:7], v1, s[32:35], s40 offen sc1
    s_mov_b32 s40, 129024
    buffer_store_dwordx4 v[4:7], v1, s[32:35], s40 offen sc1
    s_mov_b32 s40, 130048
    buffer_store_dwordx4 v[4:7], v1, s[32:35], s40 offen sc1
    s_waitcnt vmcnt(16)
    s_mov_b32 s40, 151552
    buffer_store_dwordx4 v[4:7], v1, s[32:35], s40 offen sc1
    s_mov_b32 s40, 152576
    buffer_store_dwordx4 v[4:7], v1, s[32:35], s40 offen sc1
    s_mov_b32 s40, 153600
    buffer_store_dwordx4 v[4:7], v1, s[32:35], s40 offen sc1
    s_mov_b32 s40, 154624
    buffer_store_dwordx4 v[4:7], v1, s[32:35], s40 offen sc1
    s_mov_b32 s40, 159744
    buffer_store_dwordx4 v[4:7], v1, s[32:35], s40 offen sc1
    s_mov_b32 s40, 160768
    buffer_store_dwordx4 v[4:7], v1, s[32:35], s40 offen sc1
    s_mov_b32 s40, 161792
    buffer_store_dwordx4 v[4:7], v1, s[32:35], s40 offen sc1
    s_mov_b32 s40, 162816
    buffer_store_dwordx4 v[4:7], v1, s[32:35], s40 offen sc1
    s_mov_b32 s40, 184320
    buffer_store_dwordx4 v[4:7], v1, s[32:35], s40 offen sc1
    s_mov_b32 s40, 185344
    buffer_store_dwordx4 v[4:7], v1, s[32:35], s40 offen sc1
    s_mov_b32 s40, 186368
    buffer_store_dwordx4 v[4:7], v1, s[32:35], s40 offen sc1
    s_mov_b32 s40, 187392
    buffer_store_dwordx4 v[4:7], v1, s[32:35], s40 offen sc1
    s_mov_b32 s40, 192512
    buffer_store_dwordx4 v[4:7], v1, s[32:35], s40 offen sc1
    s_mov_b32 s40, 193536
    buffer_store_dwordx4 v[4:7], v1, s[32:35], s40 offen sc1
    s_mov_b32 s40, 194560
    buffer_store_dwordx4 v[4:7], v1, s[32:35], s40 offen sc1
    s_mov_b32 s40, 195584
    buffer_store_dwordx4 v[4:7], v1, s[32:35], s40 offen sc1
    s_mov_b32 s40, 217088
    buffer_store_dwordx4 v[4:7], v1, s[32:35], s40 offen sc1
    s_mov_b32 s40, 218112
    buffer_store_dwordx4 v[4:7], v1, s[32:35], s40 offen sc1
    s_mov_b32 s40, 219136
    buffer_store_dwordx4 v[4:7], v1, s[32:35], s40 offen sc1
    s_mov_b32 s40, 220160
    buffer_store_dwordx4 v[4:7], v1, s[32:35], s40 offen sc1
    s_mov_b32 s40, 225280
    buffer_store_dwordx4 v[4:7], v1, s[32:35], s40 offen sc1
    s_mov_b32 s40, 226304
    buffer_store_dwordx4 v[4:7], v1, s[32:35], s40 offen sc1
    s_mov_b32 s40, 227328
    buffer_store_dwordx4 v[4:7], v1, s[32:35], s40 offen sc1
    s_mov_b32 s40, 228352
    buffer_store_dwordx4 v[4:7], v1, s[32:35], s40 offen sc1
    s_mov_b32 s40, 249856
    buffer_store_dwordx4 v[4:7], v1, s[32:35], s40 offen sc1
    s_mov_b32 s40, 250880
    buffer_store_dwordx4 v[4:7], v1, s[32:35], s40 offen sc1
    s_mov_b32 s40, 251904
    buffer_store_dwordx4 v[4:7], v1, s[32:35], s40 offen sc1
    s_mov_b32 s40, 252928
    buffer_store_dwordx4 v[4:7], v1, s[32:35], s40 offen sc1
    s_mov_b32 s40, 258048
    buffer_store_dwordx4 v[4:7], v1, s[32:35], s40 offen sc1
    s_mov_b32 s40, 259072
    buffer_store_dwordx4 v[4:7], v1, s[32:35], s40 offen sc1
    s_mov_b32 s40, 260096
    buffer_store_dwordx4 v[4:7], v1, s[32:35], s40 offen sc1
    s_mov_b32 s40, 261120
    buffer_store_dwordx4 v[4:7], v1, s[32:35], s40 offen sc1
    s_waitcnt vmcnt(16)
    s_mov_b32 s40, 282624
    buffer_store_dwordx4 v[4:7], v1, s[32:35], s40 offen sc1
    s_mov_b32 s40, 283648
    buffer_store_dwordx4 v[4:7], v1, s[32:35], s40 offen sc1
    s_mov_b32 s40, 284672
    buffer_store_dwordx4 v[4:7], v1, s[32:35], s40 offen sc1
    s_mov_b32 s40, 285696
    buffer_store_dwordx4 v[4:7], v1, s[32:35], s40 offen sc1
    s_mov_b32 s40, 290816
    buffer_store_dwordx4 v[4:7], v1, s[32:35], s40 offen sc1
    s_mov_b32 s40, 291840
    buffer_store_dwordx4 v[4:7], v1, s[32:35], s40 offen sc1
    s_mov_b32 s40, 292864
    buffer_store_dwordx4 v[4:7], v1, s[32:35], s40 offen sc1
    s_mov_b32 s40, 293888
    buffer_store_dwordx4 v[4:7], v1, s[32:35], s40 offen sc1
    s_mov_b32 s40, 315392
    buffer_store_dwordx4 v[4:7], v1, s[32:35], s40 offen sc1
    s_mov_b32 s40, 316416
    buffer_store_dwordx4 v[4:7], v1, s[32:35], s40 offen sc1
    s_mov_b32 s40, 317440
    buffer_store_dwordx4 v[4:7], v1, s[32:35], s40 offen sc1
    s_mov_b32 s40, 318464
    buffer_store_dwordx4 v[4:7], v1, s[32:35], s40 offen sc1
    s_mov_b32 s40, 323584
    buffer_store_dwordx4 v[4:7], v1, s[32:35], s40 offen sc1
    s_mov_b32 s40, 324608
    buffer_store_dwordx4 v[4:7], v1, s[32:35], s40 offen sc1
    s_mov_b32 s40, 325632
    buffer_store_dwordx4 v[4:7], v1, s[32:35], s40 offen sc1
    s_mov_b32 s40, 326656
    buffer_store_dwordx4 v[4:7], v1, s[32:35], s40 offen sc1
    s_mov_b32 s40, 348160
    buffer_store_dwordx4 v[4:7], v1, s[32:35], s40 offen sc1
    s_mov_b32 s40, 349184
    buffer_store_dwordx4 v[4:7], v1, s[32:35], s40 offen sc1
    s_mov_b32 s40, 350208
    buffer_store_dwordx4 v[4:7], v1, s[32:35], s40 offen sc1
    s_mov_b32 s40, 351232
    buffer_store_dwordx4 v[4:7], v1, s[32:35], s40 offen sc1
    s_mov_b32 s40, 356352
    buffer_store_dwordx4 v[4:7], v1, s[32:35], s40 offen sc1
    s_mov_b32 s40, 357376
    buffer_store_dwordx4 v[4:7], v1, s[32:35], s40 offen sc1
    s_mov_b32 s40, 358400
    buffer_store_dwordx4 v[4:7], v1, s[32:35], s40 offen sc1
    s_mov_b32 s40, 359424
    buffer_store_dwordx4 v[4:7], v1, s[32:35], s40 offen sc1
    s_mov_b32 s40, 380928
    buffer_store_dwordx4 v[4:7], v1, s[32:35], s40 offen sc1
    s_mov_b32 s40, 381952
    buffer_store_dwordx4 v[4:7], v1, s[32:35], s40 offen sc1
    s_mov_b32 s40, 382976
    buffer_store_dwordx4 v[4:7], v1, s[32:35], s40 offen sc1
    s_mov_b32 s40, 384000
    buffer_store_dwordx4 v[4:7], v1, s[32:35], s40 offen sc1
    s_mov_b32 s40, 389120
    buffer_store_dwordx4 v[4:7], v1, s[32:35], s40 offen sc1
    s_mov_b32 s40, 390144
    buffer_store_dwordx4 v[4:7], v1, s[32:35], s40 offen sc1
    s_mov_b32 s40, 391168
    buffer_store_dwordx4 v[4:7], v1, s[32:35], s40 offen sc1
    s_mov_b32 s40, 392192
    buffer_store_dwordx4 v[4:7], v1, s[32:35], s40 offen sc1
    s_waitcnt vmcnt(16)
    s_waitcnt vmcnt(0)
    v_lshlrev_b32 v1, 7, v0
    s_mov_b32 s94, 0
    s_mov_b32 s40, 20480
    s_mov_b32 exec_hi, 0
    s_memtime s[90:91]
    s_waitcnt lgkmcnt(0)
    buffer_load_dword v2, v1, s[32:35], s40 offen sc1
    s_waitcnt vmcnt(0)
    s_memtime s[92:93]
    s_waitcnt lgkmcnt(0)
    s_mov_b64 exec, -1
    s_sub_u32 s96, s92, s90
    s_mov_b32 s40, 28672
    s_mov_b32 exec_hi, 0
    s_memtime s[90:91]
    s_waitcnt lgkmcnt(0)
    buffer_load_dword v2, v1, s[32:35], s40 offen sc1
    s_waitcnt vmcnt(0)
    s_memtime s[92:93]
    s_waitcnt lgkmcnt(0)
    s_mov_b64 exec, -1
    s_sub_u32 s97, s92, s90
    s_cmp_lt_u32 s97, s96
    s_addc_u32 s94, s94, 0
    s_mov_b32 s40, 61440
    s_mov_b32 exec_hi, 0
    s_memtime s[90:91]
    s_waitcnt lgkmcnt(0)
    buffer_load_dword v2, v1, s[32:35], s40 offen sc1
    s_waitcnt vmcnt(0)
    s_memtime s[92:93]
    s_waitcnt lgkmcnt(0)
    s_mov_b64 exec, -1
    s_sub_u32 s97, s92, s90
    s_mov_b32 s40, 53248
    s_mov_b32 exec_hi, 0
    s_memtime s[90:91]
    s_waitcnt lgkmcnt(0)
    buffer_load_dword v2, v1, s[32:35], s40 offen sc1
    s_waitcnt vmcnt(0)
    s_memtime s[92:93]
    s_waitcnt lgkmcnt(0)
    s_mov_b64 exec, -1
    s_sub_u32 s96, s92, s90
    s_cmp_lt_u32 s97, s96
    s_addc_u32 s94, s94, 0
    s_mov_b32 s40, 86016
    s_mov_b32 exec_hi, 0
    s_memtime s[90:91]
    s_waitcnt lgkmcnt(0)
    buffer_load_dword v2, v1, s[32:35], s40 offen sc1
    s_waitcnt vmcnt(0)
    s_memtime s[92:93]
    s_waitcnt lgkmcnt(0)
    s_mov_b64 exec, -1
    s_sub_u32 s96, s92, s90
    s_mov_b32 s40, 94208
    s_mov_b32 exec_hi, 0
    s_memtime s[90:91]
    s_waitcnt lgkmcnt(0)
    buffer_load_dword v2, v1, s[32:35], s40 offen sc1
    s_waitcnt vmcnt(0)
    s_memtime s[92:93]
    s_waitcnt lgkmcnt(0)
    s_mov_b64 exec, -1
    s_sub_u32 s97, s92, s90
    s_cmp_lt_u32 s97, s96
    s_addc_u32 s94, s94, 0
    s_mov_b32 s40, 126976
    s_mov_b32 exec_hi, 0
    s_memtime s[90:91]
    s_waitcnt lgkmcnt(0)
    buffer_load_dword v2, v1, s[32:35], s40 offen sc1
    s_waitcnt vmcnt(0)
    s_memtime s[92:93]
    s_waitcnt lgkmcnt(0)
    s_mov_b64 exec, -1
    s_sub_u32 s97, s92, s90
    s_mov_b32 s40, 118784
    s_mov_b32 exec_hi, 0
    s_memtime s[90:91]
    s_waitcnt lgkmcnt(0)
    buffer_load_dword v2, v1, s[32:35], s40 offen sc1
    s_waitcnt vmcnt(0)
    s_memtime s[92:93]
    s_waitcnt lgkmcnt(0)
    s_mov_b64 exec, -1
    s_sub_u32 s96, s92, s90
    s_cmp_lt_u32 s97, s96
    s_addc_u32 s94, s94, 0
    s_mov_b32 s40, 151552
    s_mov_b32 exec_hi, 0
    s_memtime s[90:91]
    s_waitcnt lgkmcnt(0)
    buffer_load_dword v2, v1, s[32:35], s40 offen sc1
    s_waitcnt vmcnt(0)
    s_memtime s[92:93]
    s_waitcnt lgkmcnt(0)
    s_mov_b64 exec, -1
    s_sub_u32 s96, s92, s90
    s_mov_b32 s40, 159744
    s_mov_b32 exec_hi, 0
    s_memtime s[90:91]
    s_waitcnt lgkmcnt(0)
    buffer_load_dword v2, v1, s[32:35], s40 offen sc1
    s_waitcnt vmcnt(0)
    s_memtime s[92:93]
    s_waitcnt lgkmcnt(0)
    s_mov_b64 exec, -1
    s_sub_u32 s97, s92, s90
    s_cmp_lt_u32 s97, s96
    s_addc_u32 s94, s94, 0
    s_mov_b32 s40, 192512
    s_mov_b32 exec_hi, 0
    s_memtime s[90:91]
    s_waitcnt lgkmcnt(0)
    buffer_load_dword v2, v1, s[32:35], s40 offen sc1
    s_waitcnt vmcnt(0)
    s_memtime s[92:93]
    s_waitcnt lgkmcnt(0)
    s_mov_b64 exec, -1
    s_sub_u32 s97, s92, s90
    s_mov_b32 s40, 184320
    s_mov_b32 exec_hi, 0
    s_memtime s[90:91]
    s_waitcnt lgkmcnt(0)
    buffer_load_dword v2, v1, s[32:35], s40 offen sc1
    s_waitcnt vmcnt(0)
    s_memtime s[92:93]
    s_waitcnt lgkmcnt(0)
    s_mov_b64 exec, -1
    s_sub_u32 s96, s92, s90
    s_cmp_lt_u32 s97, s96
    s_addc_u32 s94, s94, 0
    s_mov_b32 s40, 217088
    s_mov_b32 exec_hi, 0
    s_memtime s[90:91]
    s_waitcnt lgkmcnt(0)
    buffer_load_dword v2, v1, s[32:35], s40 offen sc1
    s_waitcnt vmcnt(0)
    s_memtime s[92:93]
    s_waitcnt lgkmcnt(0)
    s_mov_b64 exec, -1
    s_sub_u32 s96, s92, s90
    s_mov_b32 s40, 225280
    s_mov_b32 exec_hi, 0
    s_memtime s[90:91]
    s_waitcnt lgkmcnt(0)
    buffer_load_dword v2, v1, s[32:35], s40 offen sc1
    s_waitcnt vmcnt(0)
    s_memtime s[92:93]
    s_waitcnt lgkmcnt(0)
    s_mov_b64 exec, -1
    s_sub_u32 s97, s92, s90
    s_cmp_lt_u32 s97, s96
    s_addc_u32 s94, s94, 0
    s_mov_b32 s40, 258048
    s_mov_b32 exec_hi, 0
    s_memtime s[90:91]
    s_waitcnt lgkmcnt(0)
    buffer_load_dword v2, v1, s[32:35], s40 offen sc1
    s_waitcnt vmcnt(0)
    s_memtime s[92:93]
    s_waitcnt lgkmcnt(0)
    s_mov_b64 exec, -1
    s_sub_u32 s97, s92, s90
    s_mov_b32 s40, 249856
    s_mov_b32 exec_hi, 0
    s_memtime s[90:91]
    s_waitcnt lgkmcnt(0)
    buffer_load_dword v2, v1, s[32:35], s40 offen sc1
    s_waitcnt vmcnt(0)
    s_memtime s[92:93]
    s_waitcnt lgkmcnt(0)
    s_mov_b64 exec, -1
    s_sub_u32 s96, s92, s90
    s_cmp_lt_u32 s97, s96
    s_addc_u32 s94, s94, 0
    s_mov_b32 s40, 282624
    s_mov_b32 exec_hi, 0
    s_memtime s[90:91]
    s_waitcnt lgkmcnt(0)
    buffer_load_dword v2, v1, s[32:35], s40 offen sc1
    s_waitcnt vmcnt(0)
    s_memtime s[92:93]
    s_waitcnt lgkmcnt(0)
    s_mov_b64 exec, -1
    s_sub_u32 s96, s92, s90
    s_mov_b32 s40, 290816
    s_mov_b32 exec_hi, 0
    s_memtime s[90:91]
    s_waitcnt lgkmcnt(0)
    buffer_load_dword v2, v1, s[32:35], s40 offen sc1
    s_waitcnt vmcnt(0)
    s_memtime s[92:93]
    s_waitcnt lgkmcnt(0)
    s_mov_b64 exec, -1
    s_sub_u32 s97, s92, s90
    s_cmp_lt_u32 s97, s96
    s_addc_u32 s94, s94, 0
    s_mov_b32 s40, 323584
    s_mov_b32 exec_hi, 0
    s_memtime s[90:91]
    s_waitcnt lgkmcnt(0)
    buffer_load_dword v2, v1, s[32:35], s40 offen sc1
    s_waitcnt vmcnt(0)
    s_memtime s[92:93]
    s_waitcnt lgkmcnt(0)
    s_mov_b64 exec, -1
    s_sub_u32 s97, s92, s90
    s_mov_b32 s40, 315392
    s_mov_b32 exec_hi, 0
    s_memtime s[90:91]
    s_waitcnt lgkmcnt(0)
    buffer_load_dword v2, v1, s[32:35], s40 offen sc1
    s_waitcnt vmcnt(0)
    s_memtime s[92:93]
    s_waitcnt lgkmcnt(0)
    s_mov_b64 exec, -1
    s_sub_u32 s96, s92, s90
    s_cmp_lt_u32 s97, s96
    s_addc_u32 s94, s94, 0
    s_mov_b32 s40, 348160
    s_mov_b32 exec_hi, 0
    s_memtime s[90:91]
    s_waitcnt lgkmcnt(0)
    buffer_load_dword v2, v1, s[32:35], s40 offen sc1
    s_waitcnt vmcnt(0)
    s_memtime s[92:93]
    s_waitcnt lgkmcnt(0)
    s_mov_b64 exec, -1
    s_sub_u32 s96, s92, s90
    s_mov_b32 s40, 356352
    s_mov_b32 exec_hi, 0
    s_memtime s[90:91]
    s_waitcnt lgkmcnt(0)
    buffer_load_dword v2, v1, s[32:35], s40 offen sc1
    s_waitcnt vmcnt(0)
    s_memtime s[92:93]
    s_waitcnt lgkmcnt(0)
    s_mov_b64 exec, -1
    s_sub_u32 s97, s92, s90
    s_cmp_lt_u32 s97, s96
    s_addc_u32 s94, s94, 0
    s_mov_b32 s40, 389120
    s_mov_b32 exec_hi, 0
    s_memtime s[90:91]
    s_waitcnt lgkmcnt(0)
    buffer_load_dword v2, v1, s[32:35], s40 offen sc1
    s_waitcnt vmcnt(0)
    s_memtime s[92:93]
    s_waitcnt lgkmcnt(0)
    s_mov_b64 exec, -1
    s_sub_u32 s97, s92, s90
    s_mov_b32 s40, 380928
    s_mov_b32 exec_hi, 0
    s_memtime s[90:91]
    s_waitcnt lgkmcnt(0)
    buffer_load_dword v2, v1, s[32:35], s40 offen sc1
    s_waitcnt vmcnt(0)
    s_memtime s[92:93]
    s_waitcnt lgkmcnt(0)
    s_mov_b64 exec, -1
    s_sub_u32 s96, s92, s90
    s_cmp_lt_u32 s97, s96
    s_addc_u32 s94, s94, 0
    s_cmp_gt_u32 s94, 6
    s_cselect_b32 s94, 2, 1
    v_mov_b32 v1, 8
    v_mov_b32 v2, s94
    s_mov_b64 exec, 1
    global_store_dword v1, v2, s[24:25] sc1
    s_mov_b64 exec, -1
    s_waitcnt vmcnt(0)
probe_skip_33:
    s_barrier
k_worker:
    s_lshr_b32 s48, s29, 6
    s_and_b32 s49, s29, 63
    s_lshl_b32 s57, s49, 7
    s_lshl_b32 s58, s49, 12
    s_cmp_eq_u32 s48, 1
    s_cbranch_scc1 w1_v_34
    s_cmp_eq_u32 s48, 2
    s_cbranch_scc1 w1_q_35
    s_mov_b32 s32, s10
    s_mov_b32 s33, s11
    s_and_b32 s33, s33, 0xffff
    s_mov_b32 s34, 0x500000
    s_mov_b32 s35, 0x20000
    s_mov_b32 s40, s26
    s_mov_b32 s41, s27
    s_and_b32 s41, s41, 0xffff
    s_mov_b32 s42, 0x1000000
    s_mov_b32 s43, 0x20000
    s_mov_b32 s62, 0
    s_branch w1_go_36
w1_v_34:
    s_mov_b32 s32, s12
    s_mov_b32 s33, s13
    s_and_b32 s33, s33, 0xffff
    s_mov_b32 s34, 0x500000
    s_mov_b32 s35, 0x20000
    s_add_u32 s40, s26, 0x2000000
    s_addc_u32 s41, s27, 0
    s_and_b32 s41, s41, 0xffff
    s_mov_b32 s42, 0x1000000
    s_mov_b32 s43, 0x20000
    s_mov_b32 s62, 1
    s_branch w1_go_36
w1_q_35:
    s_mov_b32 s32, s8
    s_mov_b32 s33, s9
    s_and_b32 s33, s33, 0xffff
    s_mov_b32 s34, 0x500000
    s_mov_b32 s35, 0x20000
    s_add_u32 s40, s26, 0x1000000
    s_addc_u32 s41, s27, 0
    s_and_b32 s41, s41, 0xffff
    s_mov_b32 s42, 0x1000000
    s_mov_b32 s43, 0x20000
    s_mov_b32 s62, 0
w1_go_36:
    s_add_u32 s44, s26, 0x5500000
    s_addc_u32 s45, s27, 0
    s_and_b32 s45, s45, 0xffff
    s_mov_b32 s46, 0x8000
    s_mov_b32 s47, 0x20000
    s_lshl_b32 s61, s29, 2
    s_add_u32 s61, s61, s28
    s_lshl_b32 s61, s61, 2
    s_add_u32 s61, s61, 0
    s_mov_b32 s36, s14
    s_mov_b32 s37, s15
    s_and_b32 s37, s37, 0xffff
    s_mov_b32 s38, 0x500000
    s_mov_b32 s39, 0x20000
    s_mul_i32 s48, s29, 28672
    s_lshl_b32 s49, s28, 10
    s_add_u32 s48, s48, s49
    v_lshlrev_b32 v1, 4, v0
    buffer_load_dwordx4 v[120:123], v1, s[36:39], s48 offen
    s_add_u32 s48, s48, 4096
    buffer_load_dwordx4 v[124:127], v1, s[36:39], s48 offen
    s_add_u32 s48, s48, 4096
    buffer_load_dwordx4 v[128:131], v1, s[36:39], s48 offen
    s_add_u32 s48, s48, 4096
    buffer_load_dwordx4 v[132:135], v1, s[36:39], s48 offen
    s_add_u32 s48, s48, 4096
    buffer_load_dwordx4 v[136:139], v1, s[36:39], s48 offen
    s_add_u32 s48, s48, 4096
    buffer_load_dwordx4 v[140:143], v1, s[36:39], s48 offen
    s_add_u32 s48, s48, 4096
    buffer_load_dwordx4 v[144:147], v1, s[36:39], s48 offen
    s_add_u32 s48, s48, 4096
    v_lshrrev_b32 v1, 4, v0
    v_and_b32 v1, 1, v1
    s_and_b32 s48, s28, 1
    s_lshl_b32 s48, s48, 1
    v_or_b32 v1, s48, v1
    v_lshlrev_b32 v1, 1, v1
    v_and_b32 v2, 7, v0
    v_xor_b32 v1, v1, v2
    v_lshlrev_b32 v1, 4, v1
    v_lshrrev_b32 v2, 3, v0
    s_mov_b32 s48, 8192
    v_mul_lo_u32 v2, v2, s48
    v_add_u32 v1, v1, v2
    s_mul_i32 s48, s28, 65536
    s_add_u32 s48, s48, s57
    s_lshl_b32 s49, s28, 10
    s_mov_b32 m0, s49
    s_add_u32 s49, s49, 4096
    buffer_load_dwordx4 v1, s[32:35], s48 offen lds
    s_add_u32 s48, s48, 262144
    s_mov_b32 m0, s49
    s_add_u32 s49, s49, 4096
    buffer_load_dwordx4 v1, s[32:35], s48 offen lds
    s_add_u32 s48, s48, 262144
    s_mov_b32 m0, s49
    s_add_u32 s49, s49, 4096
    buffer_load_dwordx4 v1, s[32:35], s48 offen lds
    s_add_u32 s48, s48, 262144
    s_mov_b32 m0, s49
    s_add_u32 s49, s49, 4096
    buffer_load_dwordx4 v1, s[32:35], s48 offen lds
    s_add_u32 s48, s48, 262144
    s_mov_b32 m0, s49
    s_add_u32 s49, s49, 4096
    buffer_load_dwordx4 v1, s[32:35], s48 offen lds
    s_add_u32 s48, s48, 262144
    s_mov_b32 m0, s49
    s_add_u32 s49, s49, 4096
    buffer_load_dwordx4 v1, s[32:35], s48 offen lds
    s_add_u32 s48, s48, 262144
    s_mov_b32 m0, s49
    s_add_u32 s49, s49, 4096
    buffer_load_dwordx4 v1, s[32:35], s48 offen lds
    s_add_u32 s48, s48, 262144
    s_mov_b32 m0, s49
    s_add_u32 s49, s49, 4096
    buffer_load_dwordx4 v1, s[32:35], s48 offen lds
    s_add_u32 s48, s48, 262144
    s_mov_b32 m0, s49
    s_add_u32 s49, s49, 4096
    buffer_load_dwordx4 v1, s[32:35], s48 offen lds
    s_add_u32 s48, s48, 262144
    s_mov_b32 m0, s49
    s_add_u32 s49, s49, 4096
    buffer_load_dwordx4 v1, s[32:35], s48 offen lds
    s_add_u32 s48, s48, 262144
    s_mov_b32 m0, s49
    s_add_u32 s49, s49, 4096
    buffer_load_dwordx4 v1, s[32:35], s48 offen lds
    s_add_u32 s48, s48, 262144
    s_mov_b32 m0, s49
    s_add_u32 s49, s49, 4096
    buffer_load_dwordx4 v1, s[32:35], s48 offen lds
    s_add_u32 s48, s48, 262144
    s_mov_b32 m0, s49
    s_add_u32 s49, s49, 4096
    buffer_load_dwordx4 v1, s[32:35], s48 offen lds
    s_add_u32 s48, s48, 262144
    s_mov_b32 m0, s49
    s_add_u32 s49, s49, 4096
    buffer_load_dwordx4 v1, s[32:35], s48 offen lds
    s_add_u32 s48, s48, 262144
    s_mov_b32 m0, s49
    s_add_u32 s49, s49, 4096
    buffer_load_dwordx4 v1, s[32:35], s48 offen lds
    s_add_u32 s48, s48, 262144
    s_mov_b32 m0, s49
    s_add_u32 s49, s49, 4096
    buffer_load_dwordx4 v1, s[32:35], s48 offen lds
    s_add_u32 s48, s48, 262144
    s_mov_b32 m0, s49
    s_add_u32 s49, s49, 4096
    buffer_load_dwordx4 v1, s[32:35], s48 offen lds
    s_add_u32 s48, s48, 262144
    s_mov_b32 m0, s49
    s_add_u32 s49, s49, 4096
    buffer_load_dwordx4 v1, s[32:35], s48 offen lds
    s_add_u32 s48, s48, 262144
    s_mov_b32 m0, s49
    s_add_u32 s49, s49, 4096
    buffer_load_dwordx4 v1, s[32:35], s48 offen lds
    s_add_u32 s48, s48, 262144
    s_mov_b32 m0, s49
    s_add_u32 s49, s49, 4096
    buffer_load_dwordx4 v1, s[32:35], s48 offen lds
    s_add_u32 s48, s48, 262144
    s_mov_b32 s36, s4
    s_mov_b32 s37, s5
    s_and_b32 s37, s37, 0xffff
    s_mov_b32 s38, 0x280000
    s_mov_b32 s39, 0x20000
    v_lshrrev_b32 v73, 4, v0
    v_add_u32 v74, 0, v73
    v_and_b32 v75, 15, v0
    v_xor_b32 v75, v75, v74
    v_lshlrev_b32 v75, 4, v75
    v_mul_u32_u24 v74, 1280, v74
    v_add_u32 v74, v74, v75
    v_subrev_u32 v64, 0, v74
    v_add_u32 v74, 4, v73
    v_and_b32 v75, 15, v0
    v_xor_b32 v75, v75, v74
    v_lshlrev_b32 v75, 4, v75
    v_mul_u32_u24 v74, 1280, v74
    v_add_u32_e64 v74, v74, v75
    v_subrev_u32 v65, 1024, v74
    v_add_u32 v74, 8, v73
    v_and_b32 v75, 15, v0
    v_xor_b32 v75, v75, v74
    v_lshlrev_b32 v75, 4, v75
    v_mul_u32_u24 v74, 1280, v74
    v_add_u32_e64 v74, v74, v75
    v_subrev_u32 v66, 2048, v74
    v_add_u32 v74, 12, v73
    v_and_b32 v75, 15, v0
    v_xor_b32 v75, v75, v74
    v_lshlrev_b32 v75, 4, v75
    v_mul_u32_u24 v74, 1280, v74
    v_add_u32_e64 v74, v74, v75
    v_subrev_u32 v67, 3072, v74
    v_and_b32 v74, 15, v0
    v_xor_b32 v75, v73, v74
    v_lshlrev_b32 v74, 8, v74
    s_lshl_b32 s48, s28, 13
    v_add_u32 v74, s48, v74
    v_xor_b32 v76, 0, v75
    v_lshlrev_b32 v76, 4, v76
    v_add_u32 v100, v74, v76
    v_add_u32 v104, 0x10000, v100
    v_add_u32 v108, 0x20000, v100
    v_xor_b32 v76, 4, v75
    v_lshlrev_b32 v76, 4, v76
    v_add_u32_e64 v101, v74, v76
    v_add_u32 v105, 0x10000, v101
    v_add_u32 v109, 0x20000, v101
    v_xor_b32 v76, 8, v75
    v_lshlrev_b32 v76, 4, v76
    v_add_u32_e64 v102, v74, v76
    v_add_u32 v106, 0x10000, v102
    v_add_u32 v110, 0x20000, v102
    v_xor_b32 v76, 12, v75
    v_lshlrev_b32 v76, 4, v76
    v_add_u32_e64 v103, v74, v76
    v_add_u32 v107, 0x10000, v103
    v_add_u32 v111, 0x20000, v103
    v_lshlrev_b32 v72, 4, v0
    s_mul_i32 s59, s28, 40960
    s_mov_b32 s63, 15
    s_lshl_b32 s48, s28, 13
    s_add_u32 m0, s48, 98304
    s_add_u32 s49, s59, 0
    buffer_load_dwordx4 v64, s[36:39], s49 offen offset:0 lds
    buffer_load_dwordx4 v65, s[36:39], s49 offen offset:1024 lds
    buffer_load_dwordx4 v66, s[36:39], s49 offen offset:2048 lds
    buffer_load_dwordx4 v67, s[36:39], s49 offen offset:3072 lds
    s_lshl_b32 s48, s28, 13
    s_add_u32 m0, s48, 102400
    s_add_u32 s49, s59, 20480
    buffer_load_dwordx4 v64, s[36:39], s49 offen offset:0 lds
    buffer_load_dwordx4 v65, s[36:39], s49 offen offset:1024 lds
    buffer_load_dwordx4 v66, s[36:39], s49 offen offset:2048 lds
    buffer_load_dwordx4 v67, s[36:39], s49 offen offset:3072 lds
    s_lshl_b32 s48, s28, 13
    s_add_u32 m0, s48, 131072
    s_add_u32 s49, s59, 256
    buffer_load_dwordx4 v64, s[36:39], s49 offen offset:0 lds
    buffer_load_dwordx4 v65, s[36:39], s49 offen offset:1024 lds
    buffer_load_dwordx4 v66, s[36:39], s49 offen offset:2048 lds
    buffer_load_dwordx4 v67, s[36:39], s49 offen offset:3072 lds
    s_lshl_b32 s48, s28, 13
    s_add_u32 m0, s48, 135168
    s_add_u32 s49, s59, 20736
    buffer_load_dwordx4 v64, s[36:39], s49 offen offset:0 lds
    buffer_load_dwordx4 v65, s[36:39], s49 offen offset:1024 lds
    buffer_load_dwordx4 v66, s[36:39], s49 offen offset:2048 lds
    buffer_load_dwordx4 v67, s[36:39], s49 offen offset:3072 lds
    s_waitcnt vmcnt(16)
    s_barrier
    s_cmp_eq_u32 s98, 1
    s_cbranch_scc1 idone_38
    s_mov_b32 s98, 1
    s_cmp_eq_u32 s28, 0
    s_cbranch_scc0 idone_38
    s_lshl_b32 s90, s100, 5
    s_add_u32 s90, s90, 4
    v_mov_b32_e64 v73, s90
    v_mov_b32 v74, 1
    s_mov_b64 exec, 1
    global_atomic_add v73, v74, s[24:25] sc1
    s_mov_b64 exec, -1
idone_38:
    v_bfe_u32 v80, v0, 3, 2
    v_xor_b32 v76, 0, v80
    v_lshlrev_b32 v76, 5, v76
    v_xor_b32 v77, 1, v80
    v_lshlrev_b32 v77, 5, v77
    v_xor_b32 v78, 2, v80
    v_lshlrev_b32 v78, 5, v78
    v_xor_b32 v79, 3, v80
    v_lshlrev_b32 v79, 5, v79
    v_lshrrev_b32 v80, 4, v0
    v_lshlrev_b32_e64 v80, 3, v80
    v_bfe_u32 v81, v0, 2, 2
    v_add_u32 v80, v80, v81
    v_lshlrev_b32 v80, 7, v80
    v_and_b32_e64 v81, 3, v0
    v_lshl_add_u32 v80, v81, 3, v80
    v_add_u32 v76, v76, v80
    v_add_u32 v77, v77, v80
    v_add_u32 v78, v78, v80
    v_add_u32 v79, v79, v80
    ds_read_b64_tr_b16 a[0:1], v76 offset:0
    ds_read_b64_tr_b16 a[2:3], v76 offset:512
    ds_read_b64_tr_b16 a[80:81], v77 offset:0
    ds_read_b64_tr_b16 a[82:83], v77 offset:512
    ds_read_b64_tr_b16 a[160:161], v78 offset:0
    ds_read_b64_tr_b16 a[162:163], v78 offset:512
    ds_read_b64_tr_b16 a[240:241], v79 offset:0
    ds_read_b64_tr_b16 a[242:243], v79 offset:512
    ds_read_b64_tr_b16 a[4:5], v76 offset:4096
    ds_read_b64_tr_b16 a[6:7], v76 offset:4608
    ds_read_b64_tr_b16 a[84:85], v77 offset:4096
    ds_read_b64_tr_b16 a[86:87], v77 offset:4608
    ds_read_b64_tr_b16 a[164:165], v78 offset:4096
    ds_read_b64_tr_b16 a[166:167], v78 offset:4608
    ds_read_b64_tr_b16 a[244:245], v79 offset:4096
    ds_read_b64_tr_b16 a[246:247], v79 offset:4608
    s_waitcnt lgkmcnt(0)
    ds_read_b64_tr_b16 a[8:9], v76 offset:8192
    ds_read_b64_tr_b16 a[10:11], v76 offset:8704
    ds_read_b64_tr_b16 a[88:89], v77 offset:8192
    ds_read_b64_tr_b16 a[90:91], v77 offset:8704
    ds_read_b64_tr_b16 a[168:169], v78 offset:8192
    ds_read_b64_tr_b16 a[170:171], v78 offset:8704
    ds_read_b64_tr_b16 a[248:249], v79 offset:8192
    ds_read_b64_tr_b16 a[250:251], v79 offset:8704
    ds_read_b64_tr_b16 a[12:13], v76 offset:12288
    ds_read_b64_tr_b16 a[14:15], v76 offset:12800
    ds_read_b64_tr_b16 a[92:93], v77 offset:12288
    ds_read_b64_tr_b16 a[94:95], v77 offset:12800
    ds_read_b64_tr_b16 a[172:173], v78 offset:12288
    ds_read_b64_tr_b16 a[174:175], v78 offset:12800
    ds_read_b64_tr_b16 a[252:253], v79 offset:12288
    ds_read_b64_tr_b16 a[254:255], v79 offset:12800
    s_waitcnt lgkmcnt(0)
    ds_read_b64_tr_b16 a[16:17], v76 offset:16384
    ds_read_b64_tr_b16 a[18:19], v76 offset:16896
    ds_read_b64_tr_b16 a[96:97], v77 offset:16384
    ds_read_b64_tr_b16 a[98:99], v77 offset:16896
    ds_read_b64_tr_b16 a[176:177], v78 offset:16384
    ds_read_b64_tr_b16 a[178:179], v78 offset:16896
    ds_read_b64_tr_b16 v[192:193], v79 offset:16384
    ds_read_b64_tr_b16 v[194:195], v79 offset:16896
    ds_read_b64_tr_b16 a[20:21], v76 offset:20480
    ds_read_b64_tr_b16 a[22:23], v76 offset:20992
    ds_read_b64_tr_b16 a[100:101], v77 offset:20480
    ds_read_b64_tr_b16 a[102:103], v77 offset:20992
    ds_read_b64_tr_b16 a[180:181], v78 offset:20480
    ds_read_b64_tr_b16 a[182:183], v78 offset:20992
    ds_read_b64_tr_b16 v[196:197], v79 offset:20480
    ds_read_b64_tr_b16 v[198:199], v79 offset:20992
    s_waitcnt lgkmcnt(0)
    ds_read_b64_tr_b16 a[24:25], v76 offset:24576
    ds_read_b64_tr_b16 a[26:27], v76 offset:25088
    ds_read_b64_tr_b16 a[104:105], v77 offset:24576
    ds_read_b64_tr_b16 a[106:107], v77 offset:25088
    ds_read_b64_tr_b16 a[184:185], v78 offset:24576
    ds_read_b64_tr_b16 a[186:187], v78 offset:25088
    ds_read_b64_tr_b16 v[200:201], v79 offset:24576
    ds_read_b64_tr_b16 v[202:203], v79 offset:25088
    ds_read_b64_tr_b16 a[28:29], v76 offset:28672
    ds_read_b64_tr_b16 a[30:31], v76 offset:29184
    ds_read_b64_tr_b16 a[108:109], v77 offset:28672
    ds_read_b64_tr_b16 a[110:111], v77 offset:29184
    ds_read_b64_tr_b16 a[188:189], v78 offset:28672
    ds_read_b64_tr_b16 a[190:191], v78 offset:29184
    ds_read_b64_tr_b16 v[204:205], v79 offset:28672
    ds_read_b64_tr_b16 v[206:207], v79 offset:29184
    s_waitcnt lgkmcnt(0)
    ds_read_b64_tr_b16 a[32:33], v76 offset:32768
    ds_read_b64_tr_b16 a[34:35], v76 offset:33280
    ds_read_b64_tr_b16 a[112:113], v77 offset:32768
    ds_read_b64_tr_b16 a[114:115], v77 offset:33280
    ds_read_b64_tr_b16 a[192:193], v78 offset:32768
    ds_read_b64_tr_b16 a[194:195], v78 offset:33280
    ds_read_b64_tr_b16 v[208:209], v79 offset:32768
    ds_read_b64_tr_b16 v[210:211], v79 offset:33280
    ds_read_b64_tr_b16 a[36:37], v76 offset:36864
    ds_read_b64_tr_b16 a[38:39], v76 offset:37376
    ds_read_b64_tr_b16 a[116:117], v77 offset:36864
    ds_read_b64_tr_b16 a[118:119], v77 offset:37376
    ds_read_b64_tr_b16 a[196:197], v78 offset:36864
    ds_read_b64_tr_b16 a[198:199], v78 offset:37376
    ds_read_b64_tr_b16 v[212:213], v79 offset:36864
    ds_read_b64_tr_b16 v[214:215], v79 offset:37376
    s_waitcnt lgkmcnt(0)
    v_add_u32 v76, 40960, v76
    v_add_u32 v77, 40960, v77
    v_add_u32 v78, 40960, v78
    v_add_u32 v79, 40960, v79
    ds_read_b64_tr_b16 a[40:41], v76 offset:0
    ds_read_b64_tr_b16 a[42:43], v76 offset:512
    ds_read_b64_tr_b16 a[120:121], v77 offset:0
    ds_read_b64_tr_b16 a[122:123], v77 offset:512
    ds_read_b64_tr_b16 a[200:201], v78 offset:0
    ds_read_b64_tr_b16 a[202:203], v78 offset:512
    ds_read_b64_tr_b16 v[216:217], v79 offset:0
    ds_read_b64_tr_b16 v[218:219], v79 offset:512
    ds_read_b64_tr_b16 a[44:45], v76 offset:4096
    ds_read_b64_tr_b16 a[46:47], v76 offset:4608
    ds_read_b64_tr_b16 a[124:125], v77 offset:4096
    ds_read_b64_tr_b16 a[126:127], v77 offset:4608
    ds_read_b64_tr_b16 a[204:205], v78 offset:4096
    ds_read_b64_tr_b16 a[206:207], v78 offset:4608
    ds_read_b64_tr_b16 v[220:221], v79 offset:4096
    ds_read_b64_tr_b16 v[222:223], v79 offset:4608
    s_waitcnt lgkmcnt(0)
    ds_read_b64_tr_b16 a[48:49], v76 offset:8192
    ds_read_b64_tr_b16 a[50:51], v76 offset:8704
    ds_read_b64_tr_b16 a[128:129], v77 offset:8192
    ds_read_b64_tr_b16 a[130:131], v77 offset:8704
    ds_read_b64_tr_b16 a[208:209], v78 offset:8192
    ds_read_b64_tr_b16 a[210:211], v78 offset:8704
    ds_read_b64_tr_b16 v[224:225], v79 offset:8192
    ds_read_b64_tr_b16 v[226:227], v79 offset:8704
    ds_read_b64_tr_b16 a[52:53], v76 offset:12288
    ds_read_b64_tr_b16 a[54:55], v76 offset:12800
    ds_read_b64_tr_b16 a[132:133], v77 offset:12288
    ds_read_b64_tr_b16 a[134:135], v77 offset:12800
    ds_read_b64_tr_b16 a[212:213], v78 offset:12288
    ds_read_b64_tr_b16 a[214:215], v78 offset:12800
    ds_read_b64_tr_b16 v[228:229], v79 offset:12288
    ds_read_b64_tr_b16 v[230:231], v79 offset:12800
    s_waitcnt lgkmcnt(0)
    ds_read_b64_tr_b16 a[56:57], v76 offset:16384
    ds_read_b64_tr_b16 a[58:59], v76 offset:16896
    ds_read_b64_tr_b16 a[136:137], v77 offset:16384
    ds_read_b64_tr_b16 a[138:139], v77 offset:16896
    ds_read_b64_tr_b16 a[216:217], v78 offset:16384
    ds_read_b64_tr_b16 a[218:219], v78 offset:16896
    ds_read_b64_tr_b16 v[232:233], v79 offset:16384
    ds_read_b64_tr_b16 v[234:235], v79 offset:16896
    ds_read_b64_tr_b16 a[60:61], v76 offset:20480
    ds_read_b64_tr_b16 a[62:63], v76 offset:20992
    ds_read_b64_tr_b16 a[140:141], v77 offset:20480
    ds_read_b64_tr_b16 a[142:143], v77 offset:20992
    ds_read_b64_tr_b16 a[220:221], v78 offset:20480
    ds_read_b64_tr_b16 a[222:223], v78 offset:20992
    ds_read_b64_tr_b16 v[236:237], v79 offset:20480
    ds_read_b64_tr_b16 v[238:239], v79 offset:20992
    s_waitcnt lgkmcnt(0)
    ds_read_b64_tr_b16 a[64:65], v76 offset:24576
    ds_read_b64_tr_b16 a[66:67], v76 offset:25088
    ds_read_b64_tr_b16 a[144:145], v77 offset:24576
    ds_read_b64_tr_b16 a[146:147], v77 offset:25088
    ds_read_b64_tr_b16 a[224:225], v78 offset:24576
    ds_read_b64_tr_b16 a[226:227], v78 offset:25088
    ds_read_b64_tr_b16 v[240:241], v79 offset:24576
    ds_read_b64_tr_b16 v[242:243], v79 offset:25088
    ds_read_b64_tr_b16 a[68:69], v76 offset:28672
    ds_read_b64_tr_b16 a[70:71], v76 offset:29184
    ds_read_b64_tr_b16 a[148:149], v77 offset:28672
    ds_read_b64_tr_b16 a[150:151], v77 offset:29184
    ds_read_b64_tr_b16 a[228:229], v78 offset:28672
    ds_read_b64_tr_b16 a[230:231], v78 offset:29184
    ds_read_b64_tr_b16 v[244:245], v79 offset:28672
    ds_read_b64_tr_b16 v[246:247], v79 offset:29184
    s_waitcnt lgkmcnt(0)
    ds_read_b64_tr_b16 a[72:73], v76 offset:32768
    ds_read_b64_tr_b16 a[74:75], v76 offset:33280
    ds_read_b64_tr_b16 a[152:153], v77 offset:32768
    ds_read_b64_tr_b16 a[154:155], v77 offset:33280
    ds_read_b64_tr_b16 a[232:233], v78 offset:32768
    ds_read_b64_tr_b16 a[234:235], v78 offset:33280
    ds_read_b64_tr_b16 v[248:249], v79 offset:32768
    ds_read_b64_tr_b16 v[250:251], v79 offset:33280
    ds_read_b64_tr_b16 a[76:77], v76 offset:36864
    ds_read_b64_tr_b16 a[78:79], v76 offset:37376
    ds_read_b64_tr_b16 a[156:157], v77 offset:36864
    ds_read_b64_tr_b16 a[158:159], v77 offset:37376
    ds_read_b64_tr_b16 a[236:237], v78 offset:36864
    ds_read_b64_tr_b16 a[238:239], v78 offset:37376
    ds_read_b64_tr_b16 v[252:253], v79 offset:36864
    ds_read_b64_tr_b16 v[254:255], v79 offset:37376
    s_waitcnt lgkmcnt(0)
    s_waitcnt lgkmcnt(0)
    s_barrier
    s_lshl_b32 s48, s28, 13
    s_add_u32 m0, s48, 0
    s_add_u32 s49, s59, 512
    buffer_load_dwordx4 v64, s[36:39], s49 offen offset:0 lds
    buffer_load_dwordx4 v65, s[36:39], s49 offen offset:1024 lds
    buffer_load_dwordx4 v66, s[36:39], s49 offen offset:2048 lds
    buffer_load_dwordx4 v67, s[36:39], s49 offen offset:3072 lds
    s_lshl_b32 s48, s28, 13
    s_add_u32 m0, s48, 4096
    s_add_u32 s49, s59, 20992
    buffer_load_dwordx4 v64, s[36:39], s49 offen offset:0 lds
    buffer_load_dwordx4 v65, s[36:39], s49 offen offset:1024 lds
    buffer_load_dwordx4 v66, s[36:39], s49 offen offset:2048 lds
    buffer_load_dwordx4 v67, s[36:39], s49 offen offset:3072 lds
    s_lshl_b32 s48, s28, 13
    s_add_u32 m0, s48, 32768
    s_add_u32 s49, s59, 768
    buffer_load_dwordx4 v64, s[36:39], s49 offen offset:0 lds
    buffer_load_dwordx4 v65, s[36:39], s49 offen offset:1024 lds
    buffer_load_dwordx4 v66, s[36:39], s49 offen offset:2048 lds
    buffer_load_dwordx4 v67, s[36:39], s49 offen offset:3072 lds
    s_lshl_b32 s48, s28, 13
    s_add_u32 m0, s48, 36864
    s_add_u32 s49, s59, 21248
    buffer_load_dwordx4 v64, s[36:39], s49 offen offset:0 lds
    buffer_load_dwordx4 v65, s[36:39], s49 offen offset:1024 lds
    buffer_load_dwordx4 v66, s[36:39], s49 offen offset:2048 lds
    buffer_load_dwordx4 v67, s[36:39], s49 offen offset:3072 lds
    s_lshl_b32 s48, s28, 13
    s_add_u32 m0, s48, 65536
    s_add_u32 s49, s59, 1024
    buffer_load_dwordx4 v64, s[36:39], s49 offen offset:0 lds
    buffer_load_dwordx4 v65, s[36:39], s49 offen offset:1024 lds
    buffer_load_dwordx4 v66, s[36:39], s49 offen offset:2048 lds
    buffer_load_dwordx4 v67, s[36:39], s49 offen offset:3072 lds
    s_lshl_b32 s48, s28, 13
    s_add_u32 m0, s48, 69632
    s_add_u32 s49, s59, 21504
    buffer_load_dwordx4 v64, s[36:39], s49 offen offset:0 lds
    buffer_load_dwordx4 v65, s[36:39], s49 offen offset:1024 lds
    buffer_load_dwordx4 v66, s[36:39], s49 offen offset:2048 lds
    buffer_load_dwordx4 v67, s[36:39], s49 offen offset:3072 lds
    s_mov_b32 s60, 0
    s_waitcnt vmcnt(0)
    s_lshl_b32 s48, s28, 18
    s_add_u32 s58, s58, s48
    s_cmp_eq_u32 s62, 1
    s_cbranch_scc1 w1_loop_v_39
wsg_loop_41:
    s_add_u32 s52, s59, 163840
    s_cmp_eq_u32 s60, s63
    s_cselect_b32 s52, s59, s52
    s_waitcnt vmcnt(36)
    ds_read_b128 v[36:39], v104 offset:32768
    ds_read_b128 v[40:43], v104 offset:36864
    ds_read_b128 v[44:47], v105 offset:32768
    ds_read_b128 v[48:51], v105 offset:36864
    s_waitcnt lgkmcnt(2)
    v_mfma_f32_16x16x32_bf16 v[4:7], a[0:3], v[36:39], 0
    v_mfma_f32_16x16x32_bf16 v[8:11], a[80:83], v[36:39], 0
    v_mfma_f32_16x16x32_bf16 v[12:15], a[160:163], v[36:39], 0
    v_mfma_f32_16x16x32_bf16 v[16:19], a[240:243], v[36:39], 0
    v_mfma_f32_16x16x32_bf16 v[20:23], a[0:3], v[40:43], 0
    v_mfma_f32_16x16x32_bf16 v[24:27], a[80:83], v[40:43], 0
    v_mfma_f32_16x16x32_bf16 v[28:31], a[160:163], v[40:43], 0
    v_mfma_f32_16x16x32_bf16 v[32:35], a[240:243], v[40:43], 0
    ds_read_b128 v[36:39], v106 offset:32768
    ds_read_b128 v[40:43], v106 offset:36864
    s_waitcnt lgkmcnt(2)
    v_mfma_f32_16x16x32_bf16 v[4:7], a[4:7], v[44:47], v[4:7]
    v_mfma_f32_16x16x32_bf16 v[8:11], a[84:87], v[44:47], v[8:11]
    v_mfma_f32_16x16x32_bf16 v[12:15], a[164:167], v[44:47], v[12:15]
    v_mfma_f32_16x16x32_bf16 v[16:19], a[244:247], v[44:47], v[16:19]
    v_mfma_f32_16x16x32_bf16 v[20:23], a[4:7], v[48:51], v[20:23]
    v_mfma_f32_16x16x32_bf16 v[24:27], a[84:87], v[48:51], v[24:27]
    v_mfma_f32_16x16x32_bf16 v[28:31], a[164:167], v[48:51], v[28:31]
    v_mfma_f32_16x16x32_bf16 v[32:35], a[244:247], v[48:51], v[32:35]
    ds_read_b128 v[44:47], v107 offset:32768
    ds_read_b128 v[48:51], v107 offset:36864
    s_waitcnt lgkmcnt(2)
    v_mfma_f32_16x16x32_bf16 v[4:7], a[8:11], v[36:39], v[4:7]
    v_mfma_f32_16x16x32_bf16 v[8:11], a[88:91], v[36:39], v[8:11]
    v_mfma_f32_16x16x32_bf16 v[12:15], a[168:171], v[36:39], v[12:15]
    v_mfma_f32_16x16x32_bf16 v[16:19], a[248:251], v[36:39], v[16:19]
    v_mfma_f32_16x16x32_bf16 v[20:23], a[8:11], v[40:43], v[20:23]
    v_mfma_f32_16x16x32_bf16 v[24:27], a[88:91], v[40:43], v[24:27]
    v_mfma_f32_16x16x32_bf16 v[28:31], a[168:171], v[40:43], v[28:31]
    v_mfma_f32_16x16x32_bf16 v[32:35], a[248:251], v[40:43], v[32:35]
    s_waitcnt lgkmcnt(0)
    v_mfma_f32_16x16x32_bf16 v[4:7], a[12:15], v[44:47], v[4:7]
    v_mfma_f32_16x16x32_bf16 v[8:11], a[92:95], v[44:47], v[8:11]
    v_mfma_f32_16x16x32_bf16 v[12:15], a[172:175], v[44:47], v[12:15]
    v_mfma_f32_16x16x32_bf16 v[16:19], a[252:255], v[44:47], v[16:19]
    v_mfma_f32_16x16x32_bf16 v[20:23], a[12:15], v[48:51], v[20:23]
    v_mfma_f32_16x16x32_bf16 v[24:27], a[92:95], v[48:51], v[24:27]
    v_mfma_f32_16x16x32_bf16 v[28:31], a[172:175], v[48:51], v[28:31]
    v_mfma_f32_16x16x32_bf16 v[32:35], a[252:255], v[48:51], v[32:35]
    s_lshl_b32 s48, s28, 13
    s_add_u32 m0, s48, 98304
    s_add_u32 s49, s52, 0
    buffer_load_dwordx4 v64, s[36:39], s49 offen offset:0 lds
    buffer_load_dwordx4 v65, s[36:39], s49 offen offset:1024 lds
    buffer_load_dwordx4 v66, s[36:39], s49 offen offset:2048 lds
    buffer_load_dwordx4 v67, s[36:39], s49 offen offset:3072 lds
    s_lshl_b32 s48, s28, 13
    s_add_u32 m0, s48, 102400
    s_add_u32 s49, s52, 20480
    buffer_load_dwordx4 v64, s[36:39], s49 offen offset:0 lds
    buffer_load_dwordx4 v65, s[36:39], s49 offen offset:1024 lds
    buffer_load_dwordx4 v66, s[36:39], s49 offen offset:2048 lds
    buffer_load_dwordx4 v67, s[36:39], s49 offen offset:3072 lds
    s_waitcnt vmcnt(36)
    ds_read_b128 v[36:39], v108 offset:0
    ds_read_b128 v[40:43], v108 offset:4096
    ds_read_b128 v[44:47], v109 offset:0
    ds_read_b128 v[48:51], v109 offset:4096
    s_waitcnt lgkmcnt(2)
    v_mfma_f32_16x16x32_bf16 v[4:7], a[16:19], v[36:39], v[4:7]
    v_mfma_f32_16x16x32_bf16 v[8:11], a[96:99], v[36:39], v[8:11]
    v_mfma_f32_16x16x32_bf16 v[12:15], a[176:179], v[36:39], v[12:15]
    v_mfma_f32_16x16x32_bf16 v[16:19], v[192:195], v[36:39], v[16:19]
    v_mfma_f32_16x16x32_bf16 v[20:23], a[16:19], v[40:43], v[20:23]
    v_mfma_f32_16x16x32_bf16 v[24:27], a[96:99], v[40:43], v[24:27]
    v_mfma_f32_16x16x32_bf16 v[28:31], a[176:179], v[40:43], v[28:31]
    v_mfma_f32_16x16x32_bf16 v[32:35], v[192:195], v[40:43], v[32:35]
    ds_read_b128 v[36:39], v110 offset:0
    ds_read_b128 v[40:43], v110 offset:4096
    s_waitcnt lgkmcnt(2)
    v_mfma_f32_16x16x32_bf16 v[4:7], a[20:23], v[44:47], v[4:7]
    v_mfma_f32_16x16x32_bf16 v[8:11], a[100:103], v[44:47], v[8:11]
    v_mfma_f32_16x16x32_bf16 v[12:15], a[180:183], v[44:47], v[12:15]
    v_mfma_f32_16x16x32_bf16 v[16:19], v[196:199], v[44:47], v[16:19]
    v_mfma_f32_16x16x32_bf16 v[20:23], a[20:23], v[48:51], v[20:23]
    v_mfma_f32_16x16x32_bf16 v[24:27], a[100:103], v[48:51], v[24:27]
    v_mfma_f32_16x16x32_bf16 v[28:31], a[180:183], v[48:51], v[28:31]
    v_mfma_f32_16x16x32_bf16 v[32:35], v[196:199], v[48:51], v[32:35]
    ds_read_b128 v[44:47], v111 offset:0
    ds_read_b128 v[48:51], v111 offset:4096
    s_waitcnt lgkmcnt(2)
    v_mfma_f32_16x16x32_bf16 v[4:7], a[24:27], v[36:39], v[4:7]
    v_mfma_f32_16x16x32_bf16 v[8:11], a[104:107], v[36:39], v[8:11]
    v_mfma_f32_16x16x32_bf16 v[12:15], a[184:187], v[36:39], v[12:15]
    v_mfma_f32_16x16x32_bf16 v[16:19], v[200:203], v[36:39], v[16:19]
    v_mfma_f32_16x16x32_bf16 v[20:23], a[24:27], v[40:43], v[20:23]
    v_mfma_f32_16x16x32_bf16 v[24:27], a[104:107], v[40:43], v[24:27]
    v_mfma_f32_16x16x32_bf16 v[28:31], a[184:187], v[40:43], v[28:31]
    v_mfma_f32_16x16x32_bf16 v[32:35], v[200:203], v[40:43], v[32:35]
    s_waitcnt lgkmcnt(0)
    v_mfma_f32_16x16x32_bf16 v[4:7], a[28:31], v[44:47], v[4:7]
    v_mfma_f32_16x16x32_bf16 v[8:11], a[108:111], v[44:47], v[8:11]
    v_mfma_f32_16x16x32_bf16 v[12:15], a[188:191], v[44:47], v[12:15]
    v_mfma_f32_16x16x32_bf16 v[16:19], v[204:207], v[44:47], v[16:19]
    v_mfma_f32_16x16x32_bf16 v[20:23], a[28:31], v[48:51], v[20:23]
    v_mfma_f32_16x16x32_bf16 v[24:27], a[108:111], v[48:51], v[24:27]
    v_mfma_f32_16x16x32_bf16 v[28:31], a[188:191], v[48:51], v[28:31]
    v_mfma_f32_16x16x32_bf16 v[32:35], v[204:207], v[48:51], v[32:35]
    s_lshl_b32 s48, s28, 13
    s_add_u32 m0, s48, 131072
    s_add_u32 s49, s52, 256
    buffer_load_dwordx4 v64, s[36:39], s49 offen offset:0 lds
    buffer_load_dwordx4 v65, s[36:39], s49 offen offset:1024 lds
    buffer_load_dwordx4 v66, s[36:39], s49 offen offset:2048 lds
    buffer_load_dwordx4 v67, s[36:39], s49 offen offset:3072 lds
    s_lshl_b32 s48, s28, 13
    s_add_u32 m0, s48, 135168
    s_add_u32 s49, s52, 20736
    buffer_load_dwordx4 v64, s[36:39], s49 offen offset:0 lds
    buffer_load_dwordx4 v65, s[36:39], s49 offen offset:1024 lds
    buffer_load_dwordx4 v66, s[36:39], s49 offen offset:2048 lds
    buffer_load_dwordx4 v67, s[36:39], s49 offen offset:3072 lds
    s_waitcnt vmcnt(36)
    ds_read_b128 v[36:39], v100 offset:0
    ds_read_b128 v[40:43], v100 offset:4096
    ds_read_b128 v[44:47], v101 offset:0
    ds_read_b128 v[48:51], v101 offset:4096
    s_waitcnt lgkmcnt(2)
    v_mfma_f32_16x16x32_bf16 v[4:7], a[32:35], v[36:39], v[4:7]
    v_mfma_f32_16x16x32_bf16 v[8:11], a[112:115], v[36:39], v[8:11]
    v_mfma_f32_16x16x32_bf16 v[12:15], a[192:195], v[36:39], v[12:15]
    v_mfma_f32_16x16x32_bf16 v[16:19], v[208:211], v[36:39], v[16:19]
    v_mfma_f32_16x16x32_bf16 v[20:23], a[32:35], v[40:43], v[20:23]
    v_mfma_f32_16x16x32_bf16 v[24:27], a[112:115], v[40:43], v[24:27]
    v_mfma_f32_16x16x32_bf16 v[28:31], a[192:195], v[40:43], v[28:31]
    v_mfma_f32_16x16x32_bf16 v[32:35], v[208:211], v[40:43], v[32:35]
    ds_read_b128 v[36:39], v102 offset:0
    ds_read_b128 v[40:43], v102 offset:4096
    s_waitcnt lgkmcnt(2)
    v_mfma_f32_16x16x32_bf16 v[4:7], a[36:39], v[44:47], v[4:7]
    v_mfma_f32_16x16x32_bf16 v[8:11], a[116:119], v[44:47], v[8:11]
    v_mfma_f32_16x16x32_bf16 v[12:15], a[196:199], v[44:47], v[12:15]
    v_mfma_f32_16x16x32_bf16 v[16:19], v[212:215], v[44:47], v[16:19]
    v_mfma_f32_16x16x32_bf16 v[20:23], a[36:39], v[48:51], v[20:23]
    v_mfma_f32_16x16x32_bf16 v[24:27], a[116:119], v[48:51], v[24:27]
    v_mfma_f32_16x16x32_bf16 v[28:31], a[196:199], v[48:51], v[28:31]
    v_mfma_f32_16x16x32_bf16 v[32:35], v[212:215], v[48:51], v[32:35]
    ds_read_b128 v[44:47], v103 offset:0
    ds_read_b128 v[48:51], v103 offset:4096
    s_waitcnt lgkmcnt(2)
    v_mfma_f32_16x16x32_bf16 v[4:7], a[40:43], v[36:39], v[4:7]
    v_mfma_f32_16x16x32_bf16 v[8:11], a[120:123], v[36:39], v[8:11]
    v_mfma_f32_16x16x32_bf16 v[12:15], a[200:203], v[36:39], v[12:15]
    v_mfma_f32_16x16x32_bf16 v[16:19], v[216:219], v[36:39], v[16:19]
    v_mfma_f32_16x16x32_bf16 v[20:23], a[40:43], v[40:43], v[20:23]
    v_mfma_f32_16x16x32_bf16 v[24:27], a[120:123], v[40:43], v[24:27]
    v_mfma_f32_16x16x32_bf16 v[28:31], a[200:203], v[40:43], v[28:31]
    v_mfma_f32_16x16x32_bf16 v[32:35], v[216:219], v[40:43], v[32:35]
    s_waitcnt lgkmcnt(0)
    v_mfma_f32_16x16x32_bf16 v[4:7], a[44:47], v[44:47], v[4:7]
    v_mfma_f32_16x16x32_bf16 v[8:11], a[124:127], v[44:47], v[8:11]
    v_mfma_f32_16x16x32_bf16 v[12:15], a[204:207], v[44:47], v[12:15]
    v_mfma_f32_16x16x32_bf16 v[16:19], v[220:223], v[44:47], v[16:19]
    v_mfma_f32_16x16x32_bf16 v[20:23], a[44:47], v[48:51], v[20:23]
    v_mfma_f32_16x16x32_bf16 v[24:27], a[124:127], v[48:51], v[24:27]
    v_mfma_f32_16x16x32_bf16 v[28:31], a[204:207], v[48:51], v[28:31]
    v_mfma_f32_16x16x32_bf16 v[32:35], v[220:223], v[48:51], v[32:35]
    s_lshl_b32 s48, s28, 13
    s_add_u32 m0, s48, 0
    s_add_u32 s49, s52, 512
    buffer_load_dwordx4 v64, s[36:39], s49 offen offset:0 lds
    buffer_load_dwordx4 v65, s[36:39], s49 offen offset:1024 lds
    buffer_load_dwordx4 v66, s[36:39], s49 offen offset:2048 lds
    buffer_load_dwordx4 v67, s[36:39], s49 offen offset:3072 lds
    s_lshl_b32 s48, s28, 13
    s_add_u32 m0, s48, 4096
    s_add_u32 s49, s52, 20992
    buffer_load_dwordx4 v64, s[36:39], s49 offen offset:0 lds
    buffer_load_dwordx4 v65, s[36:39], s49 offen offset:1024 lds
    buffer_load_dwordx4 v66, s[36:39], s49 offen offset:2048 lds
    buffer_load_dwordx4 v67, s[36:39], s49 offen offset:3072 lds
    s_waitcnt vmcnt(36)
    ds_read_b128 v[36:39], v100 offset:32768
    ds_read_b128 v[40:43], v100 offset:36864
    ds_read_b128 v[44:47], v101 offset:32768
    ds_read_b128 v[48:51], v101 offset:36864
    s_waitcnt lgkmcnt(2)
    v_mfma_f32_16x16x32_bf16 v[4:7], a[48:51], v[36:39], v[4:7]
    v_mfma_f32_16x16x32_bf16 v[8:11], a[128:131], v[36:39], v[8:11]
    v_mfma_f32_16x16x32_bf16 v[12:15], a[208:211], v[36:39], v[12:15]
    v_mfma_f32_16x16x32_bf16 v[16:19], v[224:227], v[36:39], v[16:19]
    v_mfma_f32_16x16x32_bf16 v[20:23], a[48:51], v[40:43], v[20:23]
    v_mfma_f32_16x16x32_bf16 v[24:27], a[128:131], v[40:43], v[24:27]
    v_mfma_f32_16x16x32_bf16 v[28:31], a[208:211], v[40:43], v[28:31]
    v_mfma_f32_16x16x32_bf16 v[32:35], v[224:227], v[40:43], v[32:35]
    ds_read_b128 v[36:39], v102 offset:32768
    ds_read_b128 v[40:43], v102 offset:36864
    s_waitcnt lgkmcnt(2)
    v_mfma_f32_16x16x32_bf16 v[4:7], a[52:55], v[44:47], v[4:7]
    v_mfma_f32_16x16x32_bf16 v[8:11], a[132:135], v[44:47], v[8:11]
    v_mfma_f32_16x16x32_bf16 v[12:15], a[212:215], v[44:47], v[12:15]
    v_mfma_f32_16x16x32_bf16 v[16:19], v[228:231], v[44:47], v[16:19]
    v_mfma_f32_16x16x32_bf16 v[20:23], a[52:55], v[48:51], v[20:23]
    v_mfma_f32_16x16x32_bf16 v[24:27], a[132:135], v[48:51], v[24:27]
    v_mfma_f32_16x16x32_bf16 v[28:31], a[212:215], v[48:51], v[28:31]
    v_mfma_f32_16x16x32_bf16 v[32:35], v[228:231], v[48:51], v[32:35]
    ds_read_b128 v[44:47], v103 offset:32768
    ds_read_b128 v[48:51], v103 offset:36864
    s_waitcnt lgkmcnt(2)
    v_mfma_f32_16x16x32_bf16 v[4:7], a[56:59], v[36:39], v[4:7]
    v_mfma_f32_16x16x32_bf16 v[8:11], a[136:139], v[36:39], v[8:11]
    v_mfma_f32_16x16x32_bf16 v[12:15], a[216:219], v[36:39], v[12:15]
    v_mfma_f32_16x16x32_bf16 v[16:19], v[232:235], v[36:39], v[16:19]
    v_mfma_f32_16x16x32_bf16 v[20:23], a[56:59], v[40:43], v[20:23]
    v_mfma_f32_16x16x32_bf16 v[24:27], a[136:139], v[40:43], v[24:27]
    v_mfma_f32_16x16x32_bf16 v[28:31], a[216:219], v[40:43], v[28:31]
    v_mfma_f32_16x16x32_bf16 v[32:35], v[232:235], v[40:43], v[32:35]
    s_waitcnt lgkmcnt(0)
    v_mfma_f32_16x16x32_bf16 v[4:7], a[60:63], v[44:47], v[4:7]
    v_mfma_f32_16x16x32_bf16 v[8:11], a[140:143], v[44:47], v[8:11]
    v_mfma_f32_16x16x32_bf16 v[12:15], a[220:223], v[44:47], v[12:15]
    v_mfma_f32_16x16x32_bf16 v[16:19], v[236:239], v[44:47], v[16:19]
    v_mfma_f32_16x16x32_bf16 v[20:23], a[60:63], v[48:51], v[20:23]
    v_mfma_f32_16x16x32_bf16 v[24:27], a[140:143], v[48:51], v[24:27]
    v_mfma_f32_16x16x32_bf16 v[28:31], a[220:223], v[48:51], v[28:31]
    v_mfma_f32_16x16x32_bf16 v[32:35], v[236:239], v[48:51], v[32:35]
    s_lshl_b32 s48, s28, 13
    s_add_u32 m0, s48, 32768
    s_add_u32 s49, s52, 768
    buffer_load_dwordx4 v64, s[36:39], s49 offen offset:0 lds
    buffer_load_dwordx4 v65, s[36:39], s49 offen offset:1024 lds
    buffer_load_dwordx4 v66, s[36:39], s49 offen offset:2048 lds
    buffer_load_dwordx4 v67, s[36:39], s49 offen offset:3072 lds
    s_lshl_b32 s48, s28, 13
    s_add_u32 m0, s48, 36864
    s_add_u32 s49, s52, 21248
    buffer_load_dwordx4 v64, s[36:39], s49 offen offset:0 lds
    buffer_load_dwordx4 v65, s[36:39], s49 offen offset:1024 lds
    buffer_load_dwordx4 v66, s[36:39], s49 offen offset:2048 lds
    buffer_load_dwordx4 v67, s[36:39], s49 offen offset:3072 lds
    s_waitcnt vmcnt(32)
    s_cmp_eq_u32 s60, 0
    s_cbranch_scc1 wsg_noflag_42
    v_mov_b32_e64 v73, s60
    v_mov_b32 v74, s61
    s_mov_b64 exec, 1
    buffer_store_dword v73, v74, s[44:47], 0 offen sc1
    s_mov_b64 exec, -1
wsg_noflag_42:
    ds_read_b128 v[36:39], v104 offset:0
    ds_read_b128 v[40:43], v104 offset:4096
    ds_read_b128 v[44:47], v105 offset:0
    ds_read_b128 v[48:51], v105 offset:4096
    s_waitcnt lgkmcnt(2)
    v_mfma_f32_16x16x32_bf16 v[4:7], a[64:67], v[36:39], v[4:7]
    v_mfma_f32_16x16x32_bf16 v[8:11], a[144:147], v[36:39], v[8:11]
    v_mfma_f32_16x16x32_bf16 v[12:15], a[224:227], v[36:39], v[12:15]
    v_mfma_f32_16x16x32_bf16 v[16:19], v[240:243], v[36:39], v[16:19]
    v_mfma_f32_16x16x32_bf16 v[20:23], a[64:67], v[40:43], v[20:23]
    v_mfma_f32_16x16x32_bf16 v[24:27], a[144:147], v[40:43], v[24:27]
    v_mfma_f32_16x16x32_bf16 v[28:31], a[224:227], v[40:43], v[28:31]
    v_mfma_f32_16x16x32_bf16 v[32:35], v[240:243], v[40:43], v[32:35]
    ds_read_b128 v[36:39], v106 offset:0
    ds_read_b128 v[40:43], v106 offset:4096
    s_waitcnt lgkmcnt(2)
    v_mfma_f32_16x16x32_bf16 v[4:7], a[68:71], v[44:47], v[4:7]
    v_mfma_f32_16x16x32_bf16 v[8:11], a[148:151], v[44:47], v[8:11]
    v_mfma_f32_16x16x32_bf16 v[12:15], a[228:231], v[44:47], v[12:15]
    v_mfma_f32_16x16x32_bf16 v[16:19], v[244:247], v[44:47], v[16:19]
    v_mfma_f32_16x16x32_bf16 v[20:23], a[68:71], v[48:51], v[20:23]
    v_mfma_f32_16x16x32_bf16 v[24:27], a[148:151], v[48:51], v[24:27]
    v_mfma_f32_16x16x32_bf16 v[28:31], a[228:231], v[48:51], v[28:31]
    v_mfma_f32_16x16x32_bf16 v[32:35], v[244:247], v[48:51], v[32:35]
    ds_read_b128 v[44:47], v107 offset:0
    ds_read_b128 v[48:51], v107 offset:4096
    s_waitcnt lgkmcnt(2)
    v_mfma_f32_16x16x32_bf16 v[4:7], a[72:75], v[36:39], v[4:7]
    v_mfma_f32_16x16x32_bf16 v[8:11], a[152:155], v[36:39], v[8:11]
    v_mfma_f32_16x16x32_bf16 v[12:15], a[232:235], v[36:39], v[12:15]
    v_mfma_f32_16x16x32_bf16 v[16:19], v[248:251], v[36:39], v[16:19]
    v_mfma_f32_16x16x32_bf16 v[20:23], a[72:75], v[40:43], v[20:23]
    v_mfma_f32_16x16x32_bf16 v[24:27], a[152:155], v[40:43], v[24:27]
    v_mfma_f32_16x16x32_bf16 v[28:31], a[232:235], v[40:43], v[28:31]
    v_mfma_f32_16x16x32_bf16 v[32:35], v[248:251], v[40:43], v[32:35]
    s_waitcnt lgkmcnt(0)
    v_mfma_f32_16x16x32_bf16 v[4:7], a[76:79], v[44:47], v[4:7]
    v_mfma_f32_16x16x32_bf16 v[8:11], a[156:159], v[44:47], v[8:11]
    v_mfma_f32_16x16x32_bf16 v[12:15], a[236:239], v[44:47], v[12:15]
    v_mfma_f32_16x16x32_bf16 v[16:19], v[252:255], v[44:47], v[16:19]
    v_mfma_f32_16x16x32_bf16 v[20:23], a[76:79], v[48:51], v[20:23]
    v_mfma_f32_16x16x32_bf16 v[24:27], a[156:159], v[48:51], v[24:27]
    v_mfma_f32_16x16x32_bf16 v[28:31], a[236:239], v[48:51], v[28:31]
    v_mfma_f32_16x16x32_bf16 v[32:35], v[252:255], v[48:51], v[32:35]
    s_lshl_b32 s48, s28, 13
    s_add_u32 m0, s48, 65536
    s_add_u32 s49, s52, 1024
    buffer_load_dwordx4 v64, s[36:39], s49 offen offset:0 lds
    buffer_load_dwordx4 v65, s[36:39], s49 offen offset:1024 lds
    buffer_load_dwordx4 v66, s[36:39], s49 offen offset:2048 lds
    buffer_load_dwordx4 v67, s[36:39], s49 offen offset:3072 lds
    s_lshl_b32 s48, s28, 13
    s_add_u32 m0, s48, 69632
    s_add_u32 s49, s52, 21504
    s_nop 0
    buffer_load_dwordx4 v64, s[36:39], s49 offen offset:0 lds
    buffer_load_dwordx4 v65, s[36:39], s49 offen offset:1024 lds
    buffer_load_dwordx4 v66, s[36:39], s49 offen offset:2048 lds
    buffer_load_dwordx4 v67, s[36:39], s49 offen offset:3072 lds
    v_cvt_pk_bf16_f32 v80, v4, v5
    v_cvt_pk_bf16_f32 v81, v6, v7
    v_cvt_pk_bf16_f32 v82, v8, v9
    v_cvt_pk_bf16_f32 v83, v10, v11
    v_cvt_pk_bf16_f32 v84, v20, v21
    v_cvt_pk_bf16_f32 v85, v22, v23
    v_cvt_pk_bf16_f32 v86, v24, v25
    v_cvt_pk_bf16_f32 v87, v26, v27
    v_cvt_pk_bf16_f32 v88, v12, v13
    v_cvt_pk_bf16_f32 v89, v14, v15
    v_cvt_pk_bf16_f32 v90, v16, v17
    v_cvt_pk_bf16_f32 v91, v18, v19
    v_cvt_pk_bf16_f32 v92, v28, v29
    v_cvt_pk_bf16_f32 v93, v30, v31
    v_cvt_pk_bf16_f32 v94, v32, v33
    v_cvt_pk_bf16_f32 v95, v34, v35
    buffer_store_dwordx4 v[80:83], v72, s[40:43], s58 offen offset:0 sc1
    buffer_store_dwordx4 v[84:87], v72, s[40:43], s58 offen offset:1024 sc1
    buffer_store_dwordx4 v[88:91], v72, s[40:43], s58 offen offset:2048 sc1
    buffer_store_dwordx4 v[92:95], v72, s[40:43], s58 offen offset:3072 sc1
    s_add_u32 s58, s58, 1048576
    s_cmp_eq_u32 s60, 0
    s_cbranch_scc0 wsg_not0_43
    s_waitcnt vmcnt(0)
    s_cmp_eq_u32 s3, 1
    s_cbranch_scc1 cck_ok_44
    s_mov_b32 s90, 0
    v_and_b32 v73, 7, v0
    v_lshlrev_b32 v73, 5, v73
    v_lshrrev_b32_e64 v74, 3, v0
    v_lshl_add_u32 v73, v74, 2, v73
cck_45:
    s_mov_b64 exec, 0xffff
    global_load_dword v74, v73, s[24:25] sc1
    s_waitcnt vmcnt(0)
    v_cmp_ne_u32_e64 vcc, 32, v74
    s_mov_b64 exec, -1
    s_cbranch_vccz cck_ok_44
    s_mov_b32 s91, 0
    v_readlane_b32 s92, v74, 8
    s_add_u32 s91, s91, s92
    v_readlane_b32 s92, v74, 9
    s_add_u32 s91, s91, s92
    v_readlane_b32 s92, v74, 10
    s_add_u32 s91, s91, s92
    v_readlane_b32 s92, v74, 11
    s_add_u32 s91, s91, s92
    v_readlane_b32 s92, v74, 12
    s_add_u32 s91, s91, s92
    v_readlane_b32 s92, v74, 13
    s_add_u32 s91, s91, s92
    v_readlane_b32 s92, v74, 14
    s_add_u32 s91, s91, s92
    v_readlane_b32 s92, v74, 15
    s_add_u32 s91, s91, s92
    s_cmp_ge_u32 s91, 256
    s_cbranch_scc1 k_reassign
    s_add_u32 s90, s90, 1
    s_cmp_lt_u32 s90, 300000
    s_cbranch_scc0 k_fail
    s_sleep 1
    s_branch cck_45
cck_ok_44:
    v_mov_b32 v73, 1
    v_mov_b32 v74, s61
    s_mov_b64 exec, 1
    buffer_store_dword v73, v74, s[44:47], 0 offen sc1
    s_mov_b64 exec, -1
wsg_not0_43:
    s_mov_b32 s59, s52
    s_add_u32 s60, s60, 1
    s_cmp_le_u32 s60, s63
    s_cbranch_scc1 wsg_loop_41
    s_branch w1_fin_40
w1_loop_v_39:
wsg_loop_46:
    s_add_u32 s52, s59, 163840
    s_cmp_eq_u32 s60, s63
    s_cselect_b32 s52, s59, s52
    s_waitcnt vmcnt(36)
    ds_read_b128 v[36:39], v104 offset:32768
    ds_read_b128 v[40:43], v104 offset:36864
    ds_read_b128 v[44:47], v105 offset:32768
    ds_read_b128 v[48:51], v105 offset:36864
    s_waitcnt lgkmcnt(2)
    v_mfma_f32_16x16x32_bf16 v[4:7], v[36:39], a[0:3], 0
    v_mfma_f32_16x16x32_bf16 v[8:11], v[36:39], a[80:83], 0
    v_mfma_f32_16x16x32_bf16 v[12:15], v[36:39], a[160:163], 0
    v_mfma_f32_16x16x32_bf16 v[16:19], v[36:39], a[240:243], 0
    v_mfma_f32_16x16x32_bf16 v[20:23], v[40:43], a[0:3], 0
    v_mfma_f32_16x16x32_bf16 v[24:27], v[40:43], a[80:83], 0
    v_mfma_f32_16x16x32_bf16 v[28:31], v[40:43], a[160:163], 0
    v_mfma_f32_16x16x32_bf16 v[32:35], v[40:43], a[240:243], 0
    ds_read_b128 v[36:39], v106 offset:32768
    ds_read_b128 v[40:43], v106 offset:36864
    s_waitcnt lgkmcnt(2)
    v_mfma_f32_16x16x32_bf16 v[4:7], v[44:47], a[4:7], v[4:7]
    v_mfma_f32_16x16x32_bf16 v[8:11], v[44:47], a[84:87], v[8:11]
    v_mfma_f32_16x16x32_bf16 v[12:15], v[44:47], a[164:167], v[12:15]
    v_mfma_f32_16x16x32_bf16 v[16:19], v[44:47], a[244:247], v[16:19]
    v_mfma_f32_16x16x32_bf16 v[20:23], v[48:51], a[4:7], v[20:23]
    v_mfma_f32_16x16x32_bf16 v[24:27], v[48:51], a[84:87], v[24:27]
    v_mfma_f32_16x16x32_bf16 v[28:31], v[48:51], a[164:167], v[28:31]
    v_mfma_f32_16x16x32_bf16 v[32:35], v[48:51], a[244:247], v[32:35]
    ds_read_b128 v[44:47], v107 offset:32768
    ds_read_b128 v[48:51], v107 offset:36864
    s_waitcnt lgkmcnt(2)
    v_mfma_f32_16x16x32_bf16 v[4:7], v[36:39], a[8:11], v[4:7]
    v_mfma_f32_16x16x32_bf16 v[8:11], v[36:39], a[88:91], v[8:11]
    v_mfma_f32_16x16x32_bf16 v[12:15], v[36:39], a[168:171], v[12:15]
    v_mfma_f32_16x16x32_bf16 v[16:19], v[36:39], a[248:251], v[16:19]
    v_mfma_f32_16x16x32_bf16 v[20:23], v[40:43], a[8:11], v[20:23]
    v_mfma_f32_16x16x32_bf16 v[24:27], v[40:43], a[88:91], v[24:27]
    v_mfma_f32_16x16x32_bf16 v[28:31], v[40:43], a[168:171], v[28:31]
    v_mfma_f32_16x16x32_bf16 v[32:35], v[40:43], a[248:251], v[32:35]
    s_waitcnt lgkmcnt(0)
    v_mfma_f32_16x16x32_bf16 v[4:7], v[44:47], a[12:15], v[4:7]
    v_mfma_f32_16x16x32_bf16 v[8:11], v[44:47], a[92:95], v[8:11]
    v_mfma_f32_16x16x32_bf16 v[12:15], v[44:47], a[172:175], v[12:15]
    v_mfma_f32_16x16x32_bf16 v[16:19], v[44:47], a[252:255], v[16:19]
    v_mfma_f32_16x16x32_bf16 v[20:23], v[48:51], a[12:15], v[20:23]
    v_mfma_f32_16x16x32_bf16 v[24:27], v[48:51], a[92:95], v[24:27]
    v_mfma_f32_16x16x32_bf16 v[28:31], v[48:51], a[172:175], v[28:31]
    v_mfma_f32_16x16x32_bf16 v[32:35], v[48:51], a[252:255], v[32:35]
    s_lshl_b32 s48, s28, 13
    s_add_u32 m0, s48, 98304
    s_add_u32 s49, s52, 0
    buffer_load_dwordx4 v64, s[36:39], s49 offen offset:0 lds
    buffer_load_dwordx4 v65, s[36:39], s49 offen offset:1024 lds
    buffer_load_dwordx4 v66, s[36:39], s49 offen offset:2048 lds
    buffer_load_dwordx4 v67, s[36:39], s49 offen offset:3072 lds
    s_lshl_b32 s48, s28, 13
    s_add_u32 m0, s48, 102400
    s_add_u32 s49, s52, 20480
    buffer_load_dwordx4 v64, s[36:39], s49 offen offset:0 lds
    buffer_load_dwordx4 v65, s[36:39], s49 offen offset:1024 lds
    buffer_load_dwordx4 v66, s[36:39], s49 offen offset:2048 lds
    buffer_load_dwordx4 v67, s[36:39], s49 offen offset:3072 lds
    s_waitcnt vmcnt(36)
    ds_read_b128 v[36:39], v108 offset:0
    ds_read_b128 v[40:43], v108 offset:4096
    ds_read_b128 v[44:47], v109 offset:0
    ds_read_b128 v[48:51], v109 offset:4096
    s_waitcnt lgkmcnt(2)
    v_mfma_f32_16x16x32_bf16 v[4:7], v[36:39], a[16:19], v[4:7]
    v_mfma_f32_16x16x32_bf16 v[8:11], v[36:39], a[96:99], v[8:11]
    v_mfma_f32_16x16x32_bf16 v[12:15], v[36:39], a[176:179], v[12:15]
    v_mfma_f32_16x16x32_bf16 v[16:19], v[36:39], v[192:195], v[16:19]
    v_mfma_f32_16x16x32_bf16 v[20:23], v[40:43], a[16:19], v[20:23]
    v_mfma_f32_16x16x32_bf16 v[24:27], v[40:43], a[96:99], v[24:27]
    v_mfma_f32_16x16x32_bf16 v[28:31], v[40:43], a[176:179], v[28:31]
    v_mfma_f32_16x16x32_bf16 v[32:35], v[40:43], v[192:195], v[32:35]
    ds_read_b128 v[36:39], v110 offset:0
    ds_read_b128 v[40:43], v110 offset:4096
    s_waitcnt lgkmcnt(2)
    v_mfma_f32_16x16x32_bf16 v[4:7], v[44:47], a[20:23], v[4:7]
    v_mfma_f32_16x16x32_bf16 v[8:11], v[44:47], a[100:103], v[8:11]
    v_mfma_f32_16x16x32_bf16 v[12:15], v[44:47], a[180:183], v[12:15]
    v_mfma_f32_16x16x32_bf16 v[16:19], v[44:47], v[196:199], v[16:19]
    v_mfma_f32_16x16x32_bf16 v[20:23], v[48:51], a[20:23], v[20:23]
    v_mfma_f32_16x16x32_bf16 v[24:27], v[48:51], a[100:103], v[24:27]
    v_mfma_f32_16x16x32_bf16 v[28:31], v[48:51], a[180:183], v[28:31]
    v_mfma_f32_16x16x32_bf16 v[32:35], v[48:51], v[196:199], v[32:35]
    ds_read_b128 v[44:47], v111 offset:0
    ds_read_b128 v[48:51], v111 offset:4096
    s_waitcnt lgkmcnt(2)
    v_mfma_f32_16x16x32_bf16 v[4:7], v[36:39], a[24:27], v[4:7]
    v_mfma_f32_16x16x32_bf16 v[8:11], v[36:39], a[104:107], v[8:11]
    v_mfma_f32_16x16x32_bf16 v[12:15], v[36:39], a[184:187], v[12:15]
    v_mfma_f32_16x16x32_bf16 v[16:19], v[36:39], v[200:203], v[16:19]
    v_mfma_f32_16x16x32_bf16 v[20:23], v[40:43], a[24:27], v[20:23]
    v_mfma_f32_16x16x32_bf16 v[24:27], v[40:43], a[104:107], v[24:27]
    v_mfma_f32_16x16x32_bf16 v[28:31], v[40:43], a[184:187], v[28:31]
    v_mfma_f32_16x16x32_bf16 v[32:35], v[40:43], v[200:203], v[32:35]
    s_waitcnt lgkmcnt(0)
    v_mfma_f32_16x16x32_bf16 v[4:7], v[44:47], a[28:31], v[4:7]
    v_mfma_f32_16x16x32_bf16 v[8:11], v[44:47], a[108:111], v[8:11]
    v_mfma_f32_16x16x32_bf16 v[12:15], v[44:47], a[188:191], v[12:15]
    v_mfma_f32_16x16x32_bf16 v[16:19], v[44:47], v[204:207], v[16:19]
    v_mfma_f32_16x16x32_bf16 v[20:23], v[48:51], a[28:31], v[20:23]
    v_mfma_f32_16x16x32_bf16 v[24:27], v[48:51], a[108:111], v[24:27]
    v_mfma_f32_16x16x32_bf16 v[28:31], v[48:51], a[188:191], v[28:31]
    v_mfma_f32_16x16x32_bf16 v[32:35], v[48:51], v[204:207], v[32:35]
    s_lshl_b32 s48, s28, 13
    s_add_u32 m0, s48, 131072
    s_add_u32 s49, s52, 256
    buffer_load_dwordx4 v64, s[36:39], s49 offen offset:0 lds
    buffer_load_dwordx4 v65, s[36:39], s49 offen offset:1024 lds
    buffer_load_dwordx4 v66, s[36:39], s49 offen offset:2048 lds
    buffer_load_dwordx4 v67, s[36:39], s49 offen offset:3072 lds
    s_lshl_b32 s48, s28, 13
    s_add_u32 m0, s48, 135168
    s_add_u32 s49, s52, 20736
    buffer_load_dwordx4 v64, s[36:39], s49 offen offset:0 lds
    buffer_load_dwordx4 v65, s[36:39], s49 offen offset:1024 lds
    buffer_load_dwordx4 v66, s[36:39], s49 offen offset:2048 lds
    buffer_load_dwordx4 v67, s[36:39], s49 offen offset:3072 lds
    s_waitcnt vmcnt(36)
    ds_read_b128 v[36:39], v100 offset:0
    ds_read_b128 v[40:43], v100 offset:4096
    ds_read_b128 v[44:47], v101 offset:0
    ds_read_b128 v[48:51], v101 offset:4096
    s_waitcnt lgkmcnt(2)
    v_mfma_f32_16x16x32_bf16 v[4:7], v[36:39], a[32:35], v[4:7]
    v_mfma_f32_16x16x32_bf16 v[8:11], v[36:39], a[112:115], v[8:11]
    v_mfma_f32_16x16x32_bf16 v[12:15], v[36:39], a[192:195], v[12:15]
    v_mfma_f32_16x16x32_bf16 v[16:19], v[36:39], v[208:211], v[16:19]
    v_mfma_f32_16x16x32_bf16 v[20:23], v[40:43], a[32:35], v[20:23]
    v_mfma_f32_16x16x32_bf16 v[24:27], v[40:43], a[112:115], v[24:27]
    v_mfma_f32_16x16x32_bf16 v[28:31], v[40:43], a[192:195], v[28:31]
    v_mfma_f32_16x16x32_bf16 v[32:35], v[40:43], v[208:211], v[32:35]
    ds_read_b128 v[36:39], v102 offset:0
    ds_read_b128 v[40:43], v102 offset:4096
    s_waitcnt lgkmcnt(2)
    v_mfma_f32_16x16x32_bf16 v[4:7], v[44:47], a[36:39], v[4:7]
    v_mfma_f32_16x16x32_bf16 v[8:11], v[44:47], a[116:119], v[8:11]
    v_mfma_f32_16x16x32_bf16 v[12:15], v[44:47], a[196:199], v[12:15]
    v_mfma_f32_16x16x32_bf16 v[16:19], v[44:47], v[212:215], v[16:19]
    v_mfma_f32_16x16x32_bf16 v[20:23], v[48:51], a[36:39], v[20:23]
    v_mfma_f32_16x16x32_bf16 v[24:27], v[48:51], a[116:119], v[24:27]
    v_mfma_f32_16x16x32_bf16 v[28:31], v[48:51], a[196:199], v[28:31]
    v_mfma_f32_16x16x32_bf16 v[32:35], v[48:51], v[212:215], v[32:35]
    ds_read_b128 v[44:47], v103 offset:0
    ds_read_b128 v[48:51], v103 offset:4096
    s_waitcnt lgkmcnt(2)
    v_mfma_f32_16x16x32_bf16 v[4:7], v[36:39], a[40:43], v[4:7]
    v_mfma_f32_16x16x32_bf16 v[8:11], v[36:39], a[120:123], v[8:11]
    v_mfma_f32_16x16x32_bf16 v[12:15], v[36:39], a[200:203], v[12:15]
    v_mfma_f32_16x16x32_bf16 v[16:19], v[36:39], v[216:219], v[16:19]
    v_mfma_f32_16x16x32_bf16 v[20:23], v[40:43], a[40:43], v[20:23]
    v_mfma_f32_16x16x32_bf16 v[24:27], v[40:43], a[120:123], v[24:27]
    v_mfma_f32_16x16x32_bf16 v[28:31], v[40:43], a[200:203], v[28:31]
    v_mfma_f32_16x16x32_bf16 v[32:35], v[40:43], v[216:219], v[32:35]
    s_waitcnt lgkmcnt(0)
    v_mfma_f32_16x16x32_bf16 v[4:7], v[44:47], a[44:47], v[4:7]
    v_mfma_f32_16x16x32_bf16 v[8:11], v[44:47], a[124:127], v[8:11]
    v_mfma_f32_16x16x32_bf16 v[12:15], v[44:47], a[204:207], v[12:15]
    v_mfma_f32_16x16x32_bf16 v[16:19], v[44:47], v[220:223], v[16:19]
    v_mfma_f32_16x16x32_bf16 v[20:23], v[48:51], a[44:47], v[20:23]
    v_mfma_f32_16x16x32_bf16 v[24:27], v[48:51], a[124:127], v[24:27]
    v_mfma_f32_16x16x32_bf16 v[28:31], v[48:51], a[204:207], v[28:31]
    v_mfma_f32_16x16x32_bf16 v[32:35], v[48:51], v[220:223], v[32:35]
    s_lshl_b32 s48, s28, 13
    s_add_u32 m0, s48, 0
    s_add_u32 s49, s52, 512
    buffer_load_dwordx4 v64, s[36:39], s49 offen offset:0 lds
    buffer_load_dwordx4 v65, s[36:39], s49 offen offset:1024 lds
    buffer_load_dwordx4 v66, s[36:39], s49 offen offset:2048 lds
    buffer_load_dwordx4 v67, s[36:39], s49 offen offset:3072 lds
    s_lshl_b32 s48, s28, 13
    s_add_u32 m0, s48, 4096
    s_add_u32 s49, s52, 20992
    buffer_load_dwordx4 v64, s[36:39], s49 offen offset:0 lds
    buffer_load_dwordx4 v65, s[36:39], s49 offen offset:1024 lds
    buffer_load_dwordx4 v66, s[36:39], s49 offen offset:2048 lds
    buffer_load_dwordx4 v67, s[36:39], s49 offen offset:3072 lds
    s_waitcnt vmcnt(36)
    ds_read_b128 v[36:39], v100 offset:32768
    ds_read_b128 v[40:43], v100 offset:36864
    ds_read_b128 v[44:47], v101 offset:32768
    ds_read_b128 v[48:51], v101 offset:36864
    s_waitcnt lgkmcnt(2)
    v_mfma_f32_16x16x32_bf16 v[4:7], v[36:39], a[48:51], v[4:7]
    v_mfma_f32_16x16x32_bf16 v[8:11], v[36:39], a[128:131], v[8:11]
    v_mfma_f32_16x16x32_bf16 v[12:15], v[36:39], a[208:211], v[12:15]
    v_mfma_f32_16x16x32_bf16 v[16:19], v[36:39], v[224:227], v[16:19]
    v_mfma_f32_16x16x32_bf16 v[20:23], v[40:43], a[48:51], v[20:23]
    v_mfma_f32_16x16x32_bf16 v[24:27], v[40:43], a[128:131], v[24:27]
    v_mfma_f32_16x16x32_bf16 v[28:31], v[40:43], a[208:211], v[28:31]
    v_mfma_f32_16x16x32_bf16 v[32:35], v[40:43], v[224:227], v[32:35]
    ds_read_b128 v[36:39], v102 offset:32768
    ds_read_b128 v[40:43], v102 offset:36864
    s_waitcnt lgkmcnt(2)
    v_mfma_f32_16x16x32_bf16 v[4:7], v[44:47], a[52:55], v[4:7]
    v_mfma_f32_16x16x32_bf16 v[8:11], v[44:47], a[132:135], v[8:11]
    v_mfma_f32_16x16x32_bf16 v[12:15], v[44:47], a[212:215], v[12:15]
    v_mfma_f32_16x16x32_bf16 v[16:19], v[44:47], v[228:231], v[16:19]
    v_mfma_f32_16x16x32_bf16 v[20:23], v[48:51], a[52:55], v[20:23]
    v_mfma_f32_16x16x32_bf16 v[24:27], v[48:51], a[132:135], v[24:27]
    v_mfma_f32_16x16x32_bf16 v[28:31], v[48:51], a[212:215], v[28:31]
    v_mfma_f32_16x16x32_bf16 v[32:35], v[48:51], v[228:231], v[32:35]
    ds_read_b128 v[44:47], v103 offset:32768
    ds_read_b128 v[48:51], v103 offset:36864
    s_waitcnt lgkmcnt(2)
    v_mfma_f32_16x16x32_bf16 v[4:7], v[36:39], a[56:59], v[4:7]
    v_mfma_f32_16x16x32_bf16 v[8:11], v[36:39], a[136:139], v[8:11]
    v_mfma_f32_16x16x32_bf16 v[12:15], v[36:39], a[216:219], v[12:15]
    v_mfma_f32_16x16x32_bf16 v[16:19], v[36:39], v[232:235], v[16:19]
    v_mfma_f32_16x16x32_bf16 v[20:23], v[40:43], a[56:59], v[20:23]
    v_mfma_f32_16x16x32_bf16 v[24:27], v[40:43], a[136:139], v[24:27]
    v_mfma_f32_16x16x32_bf16 v[28:31], v[40:43], a[216:219], v[28:31]
    v_mfma_f32_16x16x32_bf16 v[32:35], v[40:43], v[232:235], v[32:35]
    s_waitcnt lgkmcnt(0)
    v_mfma_f32_16x16x32_bf16 v[4:7], v[44:47], a[60:63], v[4:7]
    v_mfma_f32_16x16x32_bf16 v[8:11], v[44:47], a[140:143], v[8:11]
    v_mfma_f32_16x16x32_bf16 v[12:15], v[44:47], a[220:223], v[12:15]
    v_mfma_f32_16x16x32_bf16 v[16:19], v[44:47], v[236:239], v[16:19]
    v_mfma_f32_16x16x32_bf16 v[20:23], v[48:51], a[60:63], v[20:23]
    v_mfma_f32_16x16x32_bf16 v[24:27], v[48:51], a[140:143], v[24:27]
    v_mfma_f32_16x16x32_bf16 v[28:31], v[48:51], a[220:223], v[28:31]
    v_mfma_f32_16x16x32_bf16 v[32:35], v[48:51], v[236:239], v[32:35]
    s_lshl_b32 s48, s28, 13
    s_add_u32 m0, s48, 32768
    s_add_u32 s49, s52, 768
    buffer_load_dwordx4 v64, s[36:39], s49 offen offset:0 lds
    buffer_load_dwordx4 v65, s[36:39], s49 offen offset:1024 lds
    buffer_load_dwordx4 v66, s[36:39], s49 offen offset:2048 lds
    buffer_load_dwordx4 v67, s[36:39], s49 offen offset:3072 lds
    s_lshl_b32 s48, s28, 13
    s_add_u32 m0, s48, 36864
    s_add_u32 s49, s52, 21248
    buffer_load_dwordx4 v64, s[36:39], s49 offen offset:0 lds
    buffer_load_dwordx4 v65, s[36:39], s49 offen offset:1024 lds
    buffer_load_dwordx4 v66, s[36:39], s49 offen offset:2048 lds
    buffer_load_dwordx4 v67, s[36:39], s49 offen offset:3072 lds
    s_waitcnt vmcnt(32)
    s_cmp_eq_u32 s60, 0
    s_cbranch_scc1 wsg_noflag_47
    v_mov_b32 v73, s60
    v_mov_b32 v74, s61
    s_mov_b64 exec, 1
    buffer_store_dword v73, v74, s[44:47], 0 offen sc1
    s_mov_b64 exec, -1
wsg_noflag_47:
    ds_read_b128 v[36:39], v104 offset:0
    ds_read_b128 v[40:43], v104 offset:4096
    ds_read_b128 v[44:47], v105 offset:0
    ds_read_b128 v[48:51], v105 offset:4096
    s_waitcnt lgkmcnt(2)
    v_mfma_f32_16x16x32_bf16 v[4:7], v[36:39], a[64:67], v[4:7]
    v_mfma_f32_16x16x32_bf16 v[8:11], v[36:39], a[144:147], v[8:11]
    v_mfma_f32_16x16x32_bf16 v[12:15], v[36:39], a[224:227], v[12:15]
    v_mfma_f32_16x16x32_bf16 v[16:19], v[36:39], v[240:243], v[16:19]
    v_mfma_f32_16x16x32_bf16 v[20:23], v[40:43], a[64:67], v[20:23]
    v_mfma_f32_16x16x32_bf16 v[24:27], v[40:43], a[144:147], v[24:27]
    v_mfma_f32_16x16x32_bf16 v[28:31], v[40:43], a[224:227], v[28:31]
    v_mfma_f32_16x16x32_bf16 v[32:35], v[40:43], v[240:243], v[32:35]
    ds_read_b128 v[36:39], v106 offset:0
    ds_read_b128 v[40:43], v106 offset:4096
    s_waitcnt lgkmcnt(2)
    v_mfma_f32_16x16x32_bf16 v[4:7], v[44:47], a[68:71], v[4:7]
    v_mfma_f32_16x16x32_bf16 v[8:11], v[44:47], a[148:151], v[8:11]
    v_mfma_f32_16x16x32_bf16 v[12:15], v[44:47], a[228:231], v[12:15]
    v_mfma_f32_16x16x32_bf16 v[16:19], v[44:47], v[244:247], v[16:19]
    v_mfma_f32_16x16x32_bf16 v[20:23], v[48:51], a[68:71], v[20:23]
    v_mfma_f32_16x16x32_bf16 v[24:27], v[48:51], a[148:151], v[24:27]
    v_mfma_f32_16x16x32_bf16 v[28:31], v[48:51], a[228:231], v[28:31]
    v_mfma_f32_16x16x32_bf16 v[32:35], v[48:51], v[244:247], v[32:35]
    ds_read_b128 v[44:47], v107 offset:0
    ds_read_b128 v[48:51], v107 offset:4096
    s_waitcnt lgkmcnt(2)
    v_mfma_f32_16x16x32_bf16 v[4:7], v[36:39], a[72:75], v[4:7]
    v_mfma_f32_16x16x32_bf16 v[8:11], v[36:39], a[152:155], v[8:11]
    v_mfma_f32_16x16x32_bf16 v[12:15], v[36:39], a[232:235], v[12:15]
    v_mfma_f32_16x16x32_bf16 v[16:19], v[36:39], v[248:251], v[16:19]
    v_mfma_f32_16x16x32_bf16 v[20:23], v[40:43], a[72:75], v[20:23]
    v_mfma_f32_16x16x32_bf16 v[24:27], v[40:43], a[152:155], v[24:27]
    v_mfma_f32_16x16x32_bf16 v[28:31], v[40:43], a[232:235], v[28:31]
    v_mfma_f32_16x16x32_bf16 v[32:35], v[40:43], v[248:251], v[32:35]
    s_waitcnt lgkmcnt(0)
    v_mfma_f32_16x16x32_bf16 v[4:7], v[44:47], a[76:79], v[4:7]
    v_mfma_f32_16x16x32_bf16 v[8:11], v[44:47], a[156:159], v[8:11]
    v_mfma_f32_16x16x32_bf16 v[12:15], v[44:47], a[236:239], v[12:15]
    v_mfma_f32_16x16x32_bf16 v[16:19], v[44:47], v[252:255], v[16:19]
    v_mfma_f32_16x16x32_bf16 v[20:23], v[48:51], a[76:79], v[20:23]
    v_mfma_f32_16x16x32_bf16 v[24:27], v[48:51], a[156:159], v[24:27]
    v_mfma_f32_16x16x32_bf16 v[28:31], v[48:51], a[236:239], v[28:31]
    v_mfma_f32_16x16x32_bf16 v[32:35], v[48:51], v[252:255], v[32:35]
    s_lshl_b32 s48, s28, 13
    s_add_u32 m0, s48, 65536
    s_add_u32 s49, s52, 1024
    buffer_load_dwordx4 v64, s[36:39], s49 offen offset:0 lds
    buffer_load_dwordx4 v65, s[36:39], s49 offen offset:1024 lds
    buffer_load_dwordx4 v66, s[36:39], s49 offen offset:2048 lds
    buffer_load_dwordx4 v67, s[36:39], s49 offen offset:3072 lds
    s_lshl_b32 s48, s28, 13
    s_add_u32 m0, s48, 69632
    s_add_u32 s49, s52, 21504
    s_nop 0
    buffer_load_dwordx4 v64, s[36:39], s49 offen offset:0 lds
    buffer_load_dwordx4 v65, s[36:39], s49 offen offset:1024 lds
    buffer_load_dwordx4 v66, s[36:39], s49 offen offset:2048 lds
    buffer_load_dwordx4 v67, s[36:39], s49 offen offset:3072 lds
    v_cvt_pk_bf16_f32 v80, v4, v5
    v_cvt_pk_bf16_f32 v81, v6, v7
    v_cvt_pk_bf16_f32 v82, v20, v21
    v_cvt_pk_bf16_f32 v83, v22, v23
    v_cvt_pk_bf16_f32 v84, v8, v9
    v_cvt_pk_bf16_f32 v85, v10, v11
    v_cvt_pk_bf16_f32 v86, v24, v25
    v_cvt_pk_bf16_f32 v87, v26, v27
    v_cvt_pk_bf16_f32 v88, v12, v13
    v_cvt_pk_bf16_f32 v89, v14, v15
    v_cvt_pk_bf16_f32 v90, v28, v29
    v_cvt_pk_bf16_f32 v91, v30, v31
    v_cvt_pk_bf16_f32 v92, v16, v17
    v_cvt_pk_bf16_f32 v93, v18, v19
    v_cvt_pk_bf16_f32 v94, v32, v33
    v_cvt_pk_bf16_f32 v95, v34, v35
    buffer_store_dwordx4 v[80:83], v72, s[40:43], s58 offen offset:0 sc1
    buffer_store_dwordx4 v[84:87], v72, s[40:43], s58 offen offset:1024 sc1
    buffer_store_dwordx4 v[88:91], v72, s[40:43], s58 offen offset:2048 sc1
    buffer_store_dwordx4 v[92:95], v72, s[40:43], s58 offen offset:3072 sc1
    s_add_u32 s58, s58, 1048576
    s_cmp_eq_u32 s60, 0
    s_cbranch_scc0 wsg_not0_48
    s_waitcnt vmcnt(0)
    s_cmp_eq_u32 s3, 1
    s_cbranch_scc1 cck_ok_49
    s_mov_b32 s90, 0
    v_and_b32 v73, 7, v0
    v_lshlrev_b32 v73, 5, v73
    v_lshrrev_b32_e64 v74, 3, v0
    v_lshl_add_u32 v73, v74, 2, v73
cck_50:
    s_mov_b64 exec, 0xffff
    global_load_dword v74, v73, s[24:25] sc1
    s_waitcnt vmcnt(0)
    v_cmp_ne_u32_e64 vcc, 32, v74
    s_mov_b64 exec, -1
    s_cbranch_vccz cck_ok_49
    s_mov_b32 s91, 0
    v_readlane_b32 s92, v74, 8
    s_add_u32 s91, s91, s92
    v_readlane_b32 s92, v74, 9
    s_add_u32 s91, s91, s92
    v_readlane_b32 s92, v74, 10
    s_add_u32 s91, s91, s92
    v_readlane_b32 s92, v74, 11
    s_add_u32 s91, s91, s92
    v_readlane_b32 s92, v74, 12
    s_add_u32 s91, s91, s92
    v_readlane_b32 s92, v74, 13
    s_add_u32 s91, s91, s92
    v_readlane_b32 s92, v74, 14
    s_add_u32 s91, s91, s92
    v_readlane_b32 s92, v74, 15
    s_add_u32 s91, s91, s92
    s_cmp_ge_u32 s91, 256
    s_cbranch_scc1 k_reassign
    s_add_u32 s90, s90, 1
    s_cmp_lt_u32 s90, 300000
    s_cbranch_scc0 k_fail
    s_sleep 1
    s_branch cck_50
cck_ok_49:
    v_mov_b32 v73, 1
    v_mov_b32 v74, s61
    s_mov_b64 exec, 1
    buffer_store_dword v73, v74, s[44:47], 0 offen sc1
    s_mov_b64 exec, -1
wsg_not0_48:
    s_mov_b32 s59, s52
    s_add_u32 s60, s60, 1
    s_cmp_le_u32 s60, s63
    s_cbranch_scc1 wsg_loop_46
    s_branch w1_fin_40
w1_fin_40:
    s_waitcnt vmcnt(0)
    v_mov_b32 v73, 16
    v_mov_b32 v74, s61
    s_mov_b64 exec, 1
    buffer_store_dword v73, v74, s[44:47], 0 offen sc1
    s_mov_b64 exec, -1
    s_waitcnt vmcnt(0)
    s_barrier
    s_branch k_after_w1
k_after_w1:
    s_cmp_lt_u32 s29, 32
    s_cbranch_scc1 k_w5
    s_cmp_lt_u32 s29, 112
    s_cbranch_scc1 k_w6
    s_sub_u32 s29, s29, 112
    s_cmp_ge_u32 s29, 64
    s_cbranch_scc1 k_bq
    s_lshr_b32 s53, s29, 1
    s_mul_i32 s54, s53, 20
    s_add_u32 s55, s54, 1280
    s_add_u32 s54, s54, 640
    s_and_b32 s64, s54, 0xfffffff8
    s_lshl_b32 s64, s64, 1
    s_bfe_u32 s66, s54, 0x10002
    s_and_b32 s65, s55, 0xfffffff8
    s_lshl_b32 s65, s65, 1
    s_bfe_u32 s67, s55, 0x10002
    s_mov_b32 s74, 0x3fb8aa3b
    s_mov_b32 s75, 0x3fb8aa3b
    s_mov_b32 s76, 0x358637bd
    s_mov_b32 s77, 0x358637bd
    s_mov_b32 s78, 1.0
    s_mov_b32 s79, 1.0
    s_add_u32 s44, s26, 0x5500000
    s_addc_u32 s45, s27, 0
    s_and_b32 s45, s45, 0xffff
    s_mov_b32 s46, 0x8000
    s_mov_b32 s47, 0x20000
    s_add_u32 s40, s26, 0x6400000
    s_addc_u32 s41, s27, 0
    s_and_b32 s41, s41, 0xffff
    s_mov_b32 s42, 0x40000
    s_mov_b32 s43, 0x20000
    s_mov_b32 s32, s18
    s_mov_b32 s33, s19
    s_and_b32 s33, s33, 0xffff
    s_mov_b32 s34, 0x258000
    s_mov_b32 s35, 0x20000
    v_lshrrev_b32 v1, 4, v0
    v_and_b32 v1, 1, v1
    s_and_b32 s48, s28, 1
    s_lshl_b32 s48, s48, 1
    v_or_b32 v1, s48, v1
    v_bfe_u32 v2, v0, 1, 2
    v_xor_b32 v1, v1, v2
    v_cmp_lt_u32 vcc, 1, v1
    v_mov_b32 v2, s64
    v_mov_b32 v3, s65
    v_cndmask_b32 v2, v2, v3, vcc
    v_and_b32 v1, 1, v1
    v_lshl_add_u32 v2, v1, 5, v2
    v_and_b32_e64 v1, 1, v0
    v_lshl_add_u32 v2, v1, 4, v2
    v_lshrrev_b32_e64 v1, 3, v0
    v_mul_u32_u24 v1, 3840, v1
    v_add_u32 v1, v1, v2
    s_mul_i32 s48, s28, 30720
    s_lshl_b32 s49, s28, 10
    s_mov_b32 m0, s49
    s_add_u32 s49, s49, 4096
    buffer_load_dwordx4 v1, s[32:35], s48 offen lds
    s_add_u32 s48, s48, 122880
    s_mov_b32 m0, s49
    s_add_u32 s49, s49, 4096
    buffer_load_dwordx4 v1, s[32:35], s48 offen lds
    s_add_u32 s48, s48, 122880
    s_mov_b32 m0, s49
    s_add_u32 s49, s49, 4096
    buffer_load_dwordx4 v1, s[32:35], s48 offen lds
    s_add_u32 s48, s48, 122880
    s_mov_b32 m0, s49
    s_add_u32 s49, s49, 4096
    buffer_load_dwordx4 v1, s[32:35], s48 offen lds
    s_add_u32 s48, s48, 122880
    s_mov_b32 m0, s49
    s_add_u32 s49, s49, 4096
    buffer_load_dwordx4 v1, s[32:35], s48 offen lds
    s_add_u32 s48, s48, 122880
    s_mov_b32 m0, s49
    s_add_u32 s49, s49, 4096
    buffer_load_dwordx4 v1, s[32:35], s48 offen lds
    s_add_u32 s48, s48, 122880
    s_mov_b32 m0, s49
    s_add_u32 s49, s49, 4096
    buffer_load_dwordx4 v1, s[32:35], s48 offen lds
    s_add_u32 s48, s48, 122880
    s_mov_b32 m0, s49
    s_add_u32 s49, s49, 4096
    buffer_load_dwordx4 v1, s[32:35], s48 offen lds
    s_add_u32 s48, s48, 122880
    s_mov_b32 m0, s49
    s_add_u32 s49, s49, 4096
    buffer_load_dwordx4 v1, s[32:35], s48 offen lds
    s_add_u32 s48, s48, 122880
    s_mov_b32 m0, s49
    s_add_u32 s49, s49, 4096
    buffer_load_dwordx4 v1, s[32:35], s48 offen lds
    s_add_u32 s48, s48, 122880
    s_mov_b32 m0, s49
    s_add_u32 s49, s49, 4096
    buffer_load_dwordx4 v1, s[32:35], s48 offen lds
    s_add_u32 s48, s48, 122880
    s_mov_b32 m0, s49
    s_add_u32 s49, s49, 4096
    buffer_load_dwordx4 v1, s[32:35], s48 offen lds
    s_add_u32 s48, s48, 122880
    s_mov_b32 m0, s49
    s_add_u32 s49, s49, 4096
    buffer_load_dwordx4 v1, s[32:35], s48 offen lds
    s_add_u32 s48, s48, 122880
    s_mov_b32 m0, s49
    s_add_u32 s49, s49, 4096
    buffer_load_dwordx4 v1, s[32:35], s48 offen lds
    s_add_u32 s48, s48, 122880
    s_mov_b32 m0, s49
    s_add_u32 s49, s49, 4096
    buffer_load_dwordx4 v1, s[32:35], s48 offen lds
    s_add_u32 s48, s48, 122880
    s_mov_b32 m0, s49
    s_add_u32 s49, s49, 4096
    buffer_load_dwordx4 v1, s[32:35], s48 offen lds
    s_add_u32 s48, s48, 122880
    s_mov_b32 m0, s49
    s_add_u32 s49, s49, 4096
    buffer_load_dwordx4 v1, s[32:35], s48 offen lds
    s_add_u32 s48, s48, 122880
    s_mov_b32 m0, s49
    s_add_u32 s49, s49, 4096
    buffer_load_dwordx4 v1, s[32:35], s48 offen lds
    s_add_u32 s48, s48, 122880
    s_mov_b32 m0, s49
    s_add_u32 s49, s49, 4096
    buffer_load_dwordx4 v1, s[32:35], s48 offen lds
    s_add_u32 s48, s48, 122880
    s_mov_b32 m0, s49
    s_add_u32 s49, s49, 4096
    buffer_load_dwordx4 v1, s[32:35], s48 offen lds
    s_add_u32 s48, s48, 122880
    s_mov_b32 s36, s16
    s_mov_b32 s37, s17
    s_and_b32 s37, s37, 0xffff
    s_mov_b32 s38, 0x280000
    s_mov_b32 s39, 0x20000
    v_lshrrev_b32 v73, 4, v0
    v_add_u32 v74, 0, v73
    v_and_b32 v75, 15, v0
    v_xor_b32 v75, v75, v74
    v_lshlrev_b32_e64 v75, 4, v75
    v_mul_u32_u24 v74, 1280, v74
    v_add_u32 v74, v74, v75
    v_subrev_u32 v64, 0, v74
    v_add_u32 v74, 4, v73
    v_and_b32 v75, 15, v0
    v_xor_b32 v75, v75, v74
    v_lshlrev_b32 v75, 4, v75
    v_mul_u32_u24 v74, 1280, v74
    v_add_u32_e64 v74, v74, v75
    v_subrev_u32 v65, 1024, v74
    v_add_u32 v74, 8, v73
    v_and_b32 v75, 15, v0
    v_xor_b32 v75, v75, v74
    v_lshlrev_b32 v75, 4, v75
    v_mul_u32_u24 v74, 1280, v74
    v_add_u32_e64 v74, v74, v75
    v_subrev_u32 v66, 2048, v74
    v_add_u32 v74, 12, v73
    v_and_b32 v75, 15, v0
    v_xor_b32 v75, v75, v74
    v_lshlrev_b32 v75, 4, v75
    v_mul_u32_u24 v74, 1280, v74
    v_add_u32_e64 v74, v74, v75
    v_subrev_u32 v67, 3072, v74
    v_and_b32 v74, 15, v0
    v_xor_b32 v75, v73, v74
    v_lshlrev_b32 v74, 8, v74
    s_lshl_b32 s48, s28, 13
    v_add_u32 v74, s48, v74
    v_xor_b32 v76, 0, v75
    v_lshlrev_b32 v76, 4, v76
    v_add_u32 v100, v74, v76
    v_add_u32 v104, 0x10000, v100
    v_add_u32 v108, 0x20000, v100
    v_xor_b32 v76, 4, v75
    v_lshlrev_b32 v76, 4, v76
    v_add_u32_e64 v101, v74, v76
    v_add_u32 v105, 0x10000, v101
    v_add_u32 v109, 0x20000, v101
    v_xor_b32 v76, 8, v75
    v_lshlrev_b32 v76, 4, v76
    v_add_u32_e64 v102, v74, v76
    v_add_u32 v106, 0x10000, v102
    v_add_u32 v110, 0x20000, v102
    v_xor_b32 v76, 12, v75
    v_lshlrev_b32 v76, 4, v76
    v_add_u32_e64 v103, v74, v76
    v_add_u32 v107, 0x10000, v103
    v_add_u32 v111, 0x20000, v103
    v_lshlrev_b32 v72, 4, v0
    s_and_b32 s53, s29, 1
    s_mul_i32 s59, s53, 1310720
    s_mul_i32 s53, s28, 40960
    s_add_u32 s59, s59, s53
    s_mov_b32 s63, 7
    s_lshl_b32 s48, s28, 13
    s_add_u32 m0, s48, 98304
    s_add_u32 s49, s59, 0
    buffer_load_dwordx4 v64, s[36:39], s49 offen offset:0 lds
    buffer_load_dwordx4 v65, s[36:39], s49 offen offset:1024 lds
    buffer_load_dwordx4 v66, s[36:39], s49 offen offset:2048 lds
    buffer_load_dwordx4 v67, s[36:39], s49 offen offset:3072 lds
    s_lshl_b32 s48, s28, 13
    s_add_u32 m0, s48, 102400
    s_add_u32 s49, s59, 20480
    buffer_load_dwordx4 v64, s[36:39], s49 offen offset:0 lds
    buffer_load_dwordx4 v65, s[36:39], s49 offen offset:1024 lds
    buffer_load_dwordx4 v66, s[36:39], s49 offen offset:2048 lds
    buffer_load_dwordx4 v67, s[36:39], s49 offen offset:3072 lds
    s_lshl_b32 s48, s28, 13
    s_add_u32 m0, s48, 131072
    s_add_u32 s49, s59, 256
    buffer_load_dwordx4 v64, s[36:39], s49 offen offset:0 lds
    buffer_load_dwordx4 v65, s[36:39], s49 offen offset:1024 lds
    buffer_load_dwordx4 v66, s[36:39], s49 offen offset:2048 lds
    buffer_load_dwordx4 v67, s[36:39], s49 offen offset:3072 lds
    s_lshl_b32 s48, s28, 13
    s_add_u32 m0, s48, 135168
    s_add_u32 s49, s59, 20736
    buffer_load_dwordx4 v64, s[36:39], s49 offen offset:0 lds
    buffer_load_dwordx4 v65, s[36:39], s49 offen offset:1024 lds
    buffer_load_dwordx4 v66, s[36:39], s49 offen offset:2048 lds
    buffer_load_dwordx4 v67, s[36:39], s49 offen offset:3072 lds
    s_waitcnt vmcnt(16)
    s_barrier
    v_and_b32 v82, 3, v0
    v_lshlrev_b32_e64 v82, 3, v82
    v_bfe_u32 v81, v0, 3, 2
    s_lshl_b32 s48, s66, 3
    s_add_u32 s48, s48, 0
    v_add_u32 v80, s48, v82
    v_lshrrev_b32 v76, 5, v80
    v_add_u32 v76, 0, v76
    v_xor_b32 v76, v76, v81
    v_lshlrev_b32 v76, 5, v76
    v_and_b32 v80, 31, v80
    v_add_u32 v76, v76, v80
    s_lshl_b32 s48, s66, 3
    s_add_u32 s48, s48, 32
    v_add_u32 v80, s48, v82
    v_lshrrev_b32 v77, 5, v80
    v_add_u32 v77, 0, v77
    v_xor_b32 v77, v77, v81
    v_lshlrev_b32 v77, 5, v77
    v_and_b32 v80, 31, v80
    v_add_u32 v77, v77, v80
    s_lshl_b32 s48, s67, 3
    s_add_u32 s48, s48, 0
    v_add_u32 v80, s48, v82
    v_lshrrev_b32 v78, 5, v80
    v_add_u32 v78, 2, v78
    v_xor_b32 v78, v78, v81
    v_lshlrev_b32 v78, 5, v78
    v_and_b32 v80, 31, v80
    v_add_u32 v78, v78, v80
    s_lshl_b32 s48, s67, 3
    s_add_u32 s48, s48, 32
    v_add_u32 v80, s48, v82
    v_lshrrev_b32 v79, 5, v80
    v_add_u32 v79, 2, v79
    v_xor_b32 v79, v79, v81
    v_lshlrev_b32 v79, 5, v79
    v_and_b32 v80, 31, v80
    v_add_u32 v79, v79, v80
    v_lshrrev_b32 v80, 4, v0
    v_lshlrev_b32 v80, 3, v80
    v_bfe_u32 v81, v0, 2, 2
    v_add_u32 v80, v80, v81
    v_lshlrev_b32 v80, 7, v80
    v_add_u32 v76, v76, v80
    v_add_u32 v77, v77, v80
    v_add_u32 v78, v78, v80
    v_add_u32 v79, v79, v80
    v_and_b32_e64 v80, 15, v0
    v_cmp_gt_u32 s[68:69], 4, v80
    ds_read_b64_tr_b16 a[0:1], v76 offset:0
    ds_read_b64_tr_b16 a[2:3], v76 offset:512
    ds_read_b64_tr_b16 v[84:85], v77 offset:0
    ds_read_b64_tr_b16 v[86:87], v77 offset:512
    ds_read_b64_tr_b16 a[160:161], v78 offset:0
    ds_read_b64_tr_b16 a[162:163], v78 offset:512
    ds_read_b64_tr_b16 v[88:89], v79 offset:0
    ds_read_b64_tr_b16 v[90:91], v79 offset:512
    s_waitcnt lgkmcnt(0)
    s_nop 0
    v_cndmask_b32 v84, 0, v84, s[68:69]
    v_cndmask_b32 v85, 0, v85, s[68:69]
    v_cndmask_b32 v86, 0, v86, s[68:69]
    v_cndmask_b32 v87, 0, v87, s[68:69]
    v_accvgpr_write_b32 a80, v84
    v_accvgpr_write_b32 a81, v85
    v_accvgpr_write_b32 a82, v86
    v_accvgpr_write_b32 a83, v87
    v_cndmask_b32 v88, 0, v88, s[68:69]
    v_cndmask_b32 v89, 0, v89, s[68:69]
    v_cndmask_b32 v90, 0, v90, s[68:69]
    v_cndmask_b32 v91, 0, v91, s[68:69]
    v_accvgpr_write_b32 a240, v88
    v_accvgpr_write_b32 a241, v89
    v_accvgpr_write_b32 a242, v90
    v_accvgpr_write_b32 a243, v91
    ds_read_b64_tr_b16 a[4:5], v76 offset:4096
    ds_read_b64_tr_b16 a[6:7], v76 offset:4608
    ds_read_b64_tr_b16 v[84:85], v77 offset:4096
    ds_read_b64_tr_b16 v[86:87], v77 offset:4608
    ds_read_b64_tr_b16 a[164:165], v78 offset:4096
    ds_read_b64_tr_b16 a[166:167], v78 offset:4608
    ds_read_b64_tr_b16 v[88:89], v79 offset:4096
    ds_read_b64_tr_b16 v[90:91], v79 offset:4608
    s_waitcnt lgkmcnt(0)
    s_nop 0
    v_cndmask_b32 v84, 0, v84, s[68:69]
    v_cndmask_b32 v85, 0, v85, s[68:69]
    v_cndmask_b32 v86, 0, v86, s[68:69]
    v_cndmask_b32 v87, 0, v87, s[68:69]
    v_accvgpr_write_b32 a84, v84
    v_accvgpr_write_b32 a85, v85
    v_accvgpr_write_b32 a86, v86
    v_accvgpr_write_b32 a87, v87
    v_cndmask_b32 v88, 0, v88, s[68:69]
    v_cndmask_b32 v89, 0, v89, s[68:69]
    v_cndmask_b32 v90, 0, v90, s[68:69]
    v_cndmask_b32 v91, 0, v91, s[68:69]
    v_accvgpr_write_b32 a244, v88
    v_accvgpr_write_b32 a245, v89
    v_accvgpr_write_b32 a246, v90
    v_accvgpr_write_b32 a247, v91
    ds_read_b64_tr_b16 a[8:9], v76 offset:8192
    ds_read_b64_tr_b16 a[10:11], v76 offset:8704
    ds_read_b64_tr_b16 v[84:85], v77 offset:8192
    ds_read_b64_tr_b16 v[86:87], v77 offset:8704
    ds_read_b64_tr_b16 a[168:169], v78 offset:8192
    ds_read_b64_tr_b16 a[170:171], v78 offset:8704
    ds_read_b64_tr_b16 v[88:89], v79 offset:8192
    ds_read_b64_tr_b16 v[90:91], v79 offset:8704
    s_waitcnt lgkmcnt(0)
    s_nop 0
    v_cndmask_b32 v84, 0, v84, s[68:69]
    v_cndmask_b32 v85, 0, v85, s[68:69]
    v_cndmask_b32 v86, 0, v86, s[68:69]
    v_cndmask_b32 v87, 0, v87, s[68:69]
    v_accvgpr_write_b32 a88, v84
    v_accvgpr_write_b32 a89, v85
    v_accvgpr_write_b32 a90, v86
    v_accvgpr_write_b32 a91, v87
    v_cndmask_b32 v88, 0, v88, s[68:69]
    v_cndmask_b32 v89, 0, v89, s[68:69]
    v_cndmask_b32 v90, 0, v90, s[68:69]
    v_cndmask_b32 v91, 0, v91, s[68:69]
    v_accvgpr_write_b32 a248, v88
    v_accvgpr_write_b32 a249, v89
    v_accvgpr_write_b32 a250, v90
    v_accvgpr_write_b32 a251, v91
    ds_read_b64_tr_b16 a[12:13], v76 offset:12288
    ds_read_b64_tr_b16 a[14:15], v76 offset:12800
    ds_read_b64_tr_b16 v[84:85], v77 offset:12288
    ds_read_b64_tr_b16 v[86:87], v77 offset:12800
    ds_read_b64_tr_b16 a[172:173], v78 offset:12288
    ds_read_b64_tr_b16 a[174:175], v78 offset:12800
    ds_read_b64_tr_b16 v[88:89], v79 offset:12288
    ds_read_b64_tr_b16 v[90:91], v79 offset:12800
    s_waitcnt lgkmcnt(0)
    s_nop 0
    v_cndmask_b32 v84, 0, v84, s[68:69]
    v_cndmask_b32 v85, 0, v85, s[68:69]
    v_cndmask_b32 v86, 0, v86, s[68:69]
    v_cndmask_b32 v87, 0, v87, s[68:69]
    v_accvgpr_write_b32 a92, v84
    v_accvgpr_write_b32 a93, v85
    v_accvgpr_write_b32 a94, v86
    v_accvgpr_write_b32 a95, v87
    v_cndmask_b32 v88, 0, v88, s[68:69]
    v_cndmask_b32 v89, 0, v89, s[68:69]
    v_cndmask_b32 v90, 0, v90, s[68:69]
    v_cndmask_b32 v91, 0, v91, s[68:69]
    v_accvgpr_write_b32 a252, v88
    v_accvgpr_write_b32 a253, v89
    v_accvgpr_write_b32 a254, v90
    v_accvgpr_write_b32 a255, v91
    ds_read_b64_tr_b16 a[16:17], v76 offset:16384
    ds_read_b64_tr_b16 a[18:19], v76 offset:16896
    ds_read_b64_tr_b16 v[84:85], v77 offset:16384
    ds_read_b64_tr_b16 v[86:87], v77 offset:16896
    ds_read_b64_tr_b16 a[176:177], v78 offset:16384
    ds_read_b64_tr_b16 a[178:179], v78 offset:16896
    ds_read_b64_tr_b16 v[88:89], v79 offset:16384
    ds_read_b64_tr_b16 v[90:91], v79 offset:16896
    s_waitcnt lgkmcnt(0)
    s_nop 0
    v_cndmask_b32 v84, 0, v84, s[68:69]
    v_cndmask_b32 v85, 0, v85, s[68:69]
    v_cndmask_b32 v86, 0, v86, s[68:69]
    v_cndmask_b32 v87, 0, v87, s[68:69]
    v_accvgpr_write_b32 a96, v84
    v_accvgpr_write_b32 a97, v85
    v_accvgpr_write_b32 a98, v86
    v_accvgpr_write_b32 a99, v87
    v_cndmask_b32 v88, 0, v88, s[68:69]
    v_cndmask_b32 v89, 0, v89, s[68:69]
    v_cndmask_b32 v90, 0, v90, s[68:69]
    v_cndmask_b32 v91, 0, v91, s[68:69]
    v_mov_b32 v192, v88
    v_mov_b32 v193, v89
    v_mov_b32 v194, v90
    v_mov_b32 v195, v91
    ds_read_b64_tr_b16 a[20:21], v76 offset:20480
    ds_read_b64_tr_b16 a[22:23], v76 offset:20992
    ds_read_b64_tr_b16 v[84:85], v77 offset:20480
    ds_read_b64_tr_b16 v[86:87], v77 offset:20992
    ds_read_b64_tr_b16 a[180:181], v78 offset:20480
    ds_read_b64_tr_b16 a[182:183], v78 offset:20992
    ds_read_b64_tr_b16 v[88:89], v79 offset:20480
    ds_read_b64_tr_b16 v[90:91], v79 offset:20992
    s_waitcnt lgkmcnt(0)
    s_nop 0
    v_cndmask_b32 v84, 0, v84, s[68:69]
    v_cndmask_b32 v85, 0, v85, s[68:69]
    v_cndmask_b32 v86, 0, v86, s[68:69]
    v_cndmask_b32 v87, 0, v87, s[68:69]
    v_accvgpr_write_b32 a100, v84
    v_accvgpr_write_b32 a101, v85
    v_accvgpr_write_b32 a102, v86
    v_accvgpr_write_b32 a103, v87
    v_cndmask_b32 v88, 0, v88, s[68:69]
    v_cndmask_b32 v89, 0, v89, s[68:69]
    v_cndmask_b32 v90, 0, v90, s[68:69]
    v_cndmask_b32 v91, 0, v91, s[68:69]
    v_mov_b32 v196, v88
    v_mov_b32 v197, v89
    v_mov_b32 v198, v90
    v_mov_b32 v199, v91
    ds_read_b64_tr_b16 a[24:25], v76 offset:24576
    ds_read_b64_tr_b16 a[26:27], v76 offset:25088
    ds_read_b64_tr_b16 v[84:85], v77 offset:24576
    ds_read_b64_tr_b16 v[86:87], v77 offset:25088
    ds_read_b64_tr_b16 a[184:185], v78 offset:24576
    ds_read_b64_tr_b16 a[186:187], v78 offset:25088
    ds_read_b64_tr_b16 v[88:89], v79 offset:24576
    ds_read_b64_tr_b16 v[90:91], v79 offset:25088
    s_waitcnt lgkmcnt(0)
    s_nop 0
    v_cndmask_b32 v84, 0, v84, s[68:69]
    v_cndmask_b32 v85, 0, v85, s[68:69]
    v_cndmask_b32 v86, 0, v86, s[68:69]
    v_cndmask_b32 v87, 0, v87, s[68:69]
    v_accvgpr_write_b32 a104, v84
    v_accvgpr_write_b32 a105, v85
    v_accvgpr_write_b32 a106, v86
    v_accvgpr_write_b32 a107, v87
    v_cndmask_b32 v88, 0, v88, s[68:69]
    v_cndmask_b32 v89, 0, v89, s[68:69]
    v_cndmask_b32 v90, 0, v90, s[68:69]
    v_cndmask_b32 v91, 0, v91, s[68:69]
    v_mov_b32 v200, v88
    v_mov_b32 v201, v89
    v_mov_b32 v202, v90
    v_mov_b32 v203, v91
    ds_read_b64_tr_b16 a[28:29], v76 offset:28672
    ds_read_b64_tr_b16 a[30:31], v76 offset:29184
    ds_read_b64_tr_b16 v[84:85], v77 offset:28672
    ds_read_b64_tr_b16 v[86:87], v77 offset:29184
    ds_read_b64_tr_b16 a[188:189], v78 offset:28672
    ds_read_b64_tr_b16 a[190:191], v78 offset:29184
    ds_read_b64_tr_b16 v[88:89], v79 offset:28672
    ds_read_b64_tr_b16 v[90:91], v79 offset:29184
    s_waitcnt lgkmcnt(0)
    s_nop 0
    v_cndmask_b32 v84, 0, v84, s[68:69]
    v_cndmask_b32 v85, 0, v85, s[68:69]
    v_cndmask_b32 v86, 0, v86, s[68:69]
    v_cndmask_b32 v87, 0, v87, s[68:69]
    v_accvgpr_write_b32 a108, v84
    v_accvgpr_write_b32 a109, v85
    v_accvgpr_write_b32 a110, v86
    v_accvgpr_write_b32 a111, v87
    v_cndmask_b32 v88, 0, v88, s[68:69]
    v_cndmask_b32 v89, 0, v89, s[68:69]
    v_cndmask_b32 v90, 0, v90, s[68:69]
    v_cndmask_b32 v91, 0, v91, s[68:69]
    v_mov_b32 v204, v88
    v_mov_b32 v205, v89
    v_mov_b32 v206, v90
    v_mov_b32 v207, v91
    ds_read_b64_tr_b16 a[32:33], v76 offset:32768
    ds_read_b64_tr_b16 a[34:35], v76 offset:33280
    ds_read_b64_tr_b16 v[84:85], v77 offset:32768
    ds_read_b64_tr_b16 v[86:87], v77 offset:33280
    ds_read_b64_tr_b16 a[192:193], v78 offset:32768
    ds_read_b64_tr_b16 a[194:195], v78 offset:33280
    ds_read_b64_tr_b16 v[88:89], v79 offset:32768
    ds_read_b64_tr_b16 v[90:91], v79 offset:33280
    s_waitcnt lgkmcnt(0)
    s_nop 0
    v_cndmask_b32 v84, 0, v84, s[68:69]
    v_cndmask_b32 v85, 0, v85, s[68:69]
    v_cndmask_b32 v86, 0, v86, s[68:69]
    v_cndmask_b32 v87, 0, v87, s[68:69]
    v_accvgpr_write_b32 a112, v84
    v_accvgpr_write_b32 a113, v85
    v_accvgpr_write_b32 a114, v86
    v_accvgpr_write_b32 a115, v87
    v_cndmask_b32 v88, 0, v88, s[68:69]
    v_cndmask_b32 v89, 0, v89, s[68:69]
    v_cndmask_b32 v90, 0, v90, s[68:69]
    v_cndmask_b32 v91, 0, v91, s[68:69]
    v_mov_b32 v208, v88
    v_mov_b32 v209, v89
    v_mov_b32 v210, v90
    v_mov_b32 v211, v91
    ds_read_b64_tr_b16 a[36:37], v76 offset:36864
    ds_read_b64_tr_b16 a[38:39], v76 offset:37376
    ds_read_b64_tr_b16 v[84:85], v77 offset:36864
    ds_read_b64_tr_b16 v[86:87], v77 offset:37376
    ds_read_b64_tr_b16 a[196:197], v78 offset:36864
    ds_read_b64_tr_b16 a[198:199], v78 offset:37376
    ds_read_b64_tr_b16 v[88:89], v79 offset:36864
    ds_read_b64_tr_b16 v[90:91], v79 offset:37376
    s_waitcnt lgkmcnt(0)
    s_nop 0
    v_cndmask_b32 v84, 0, v84, s[68:69]
    v_cndmask_b32 v85, 0, v85, s[68:69]
    v_cndmask_b32 v86, 0, v86, s[68:69]
    v_cndmask_b32 v87, 0, v87, s[68:69]
    v_accvgpr_write_b32 a116, v84
    v_accvgpr_write_b32 a117, v85
    v_accvgpr_write_b32 a118, v86
    v_accvgpr_write_b32 a119, v87
    v_cndmask_b32 v88, 0, v88, s[68:69]
    v_cndmask_b32 v89, 0, v89, s[68:69]
    v_cndmask_b32 v90, 0, v90, s[68:69]
    v_cndmask_b32 v91, 0, v91, s[68:69]
    v_mov_b32 v212, v88
    v_mov_b32 v213, v89
    v_mov_b32 v214, v90
    v_mov_b32 v215, v91
    v_add_u32 v76, 40960, v76
    v_add_u32 v77, 40960, v77
    v_add_u32 v78, 40960, v78
    v_add_u32 v79, 40960, v79
    ds_read_b64_tr_b16 a[40:41], v76 offset:0
    ds_read_b64_tr_b16 a[42:43], v76 offset:512
    ds_read_b64_tr_b16 v[84:85], v77 offset:0
    ds_read_b64_tr_b16 v[86:87], v77 offset:512
    ds_read_b64_tr_b16 a[200:201], v78 offset:0
    ds_read_b64_tr_b16 a[202:203], v78 offset:512
    ds_read_b64_tr_b16 v[88:89], v79 offset:0
    ds_read_b64_tr_b16 v[90:91], v79 offset:512
    s_waitcnt lgkmcnt(0)
    s_nop 0
    v_cndmask_b32 v84, 0, v84, s[68:69]
    v_cndmask_b32 v85, 0, v85, s[68:69]
    v_cndmask_b32 v86, 0, v86, s[68:69]
    v_cndmask_b32 v87, 0, v87, s[68:69]
    v_accvgpr_write_b32 a120, v84
    v_accvgpr_write_b32 a121, v85
    v_accvgpr_write_b32 a122, v86
    v_accvgpr_write_b32 a123, v87
    v_cndmask_b32 v88, 0, v88, s[68:69]
    v_cndmask_b32 v89, 0, v89, s[68:69]
    v_cndmask_b32 v90, 0, v90, s[68:69]
    v_cndmask_b32 v91, 0, v91, s[68:69]
    v_mov_b32 v216, v88
    v_mov_b32 v217, v89
    v_mov_b32 v218, v90
    v_mov_b32 v219, v91
    ds_read_b64_tr_b16 a[44:45], v76 offset:4096
    ds_read_b64_tr_b16 a[46:47], v76 offset:4608
    ds_read_b64_tr_b16 v[84:85], v77 offset:4096
    ds_read_b64_tr_b16 v[86:87], v77 offset:4608
    ds_read_b64_tr_b16 a[204:205], v78 offset:4096
    ds_read_b64_tr_b16 a[206:207], v78 offset:4608
    ds_read_b64_tr_b16 v[88:89], v79 offset:4096
    ds_read_b64_tr_b16 v[90:91], v79 offset:4608
    s_waitcnt lgkmcnt(0)
    s_nop 0
    v_cndmask_b32 v84, 0, v84, s[68:69]
    v_cndmask_b32 v85, 0, v85, s[68:69]
    v_cndmask_b32 v86, 0, v86, s[68:69]
    v_cndmask_b32 v87, 0, v87, s[68:69]
    v_accvgpr_write_b32 a124, v84
    v_accvgpr_write_b32 a125, v85
    v_accvgpr_write_b32 a126, v86
    v_accvgpr_write_b32 a127, v87
    v_cndmask_b32 v88, 0, v88, s[68:69]
    v_cndmask_b32 v89, 0, v89, s[68:69]
    v_cndmask_b32 v90, 0, v90, s[68:69]
    v_cndmask_b32 v91, 0, v91, s[68:69]
    v_mov_b32 v220, v88
    v_mov_b32 v221, v89
    v_mov_b32 v222, v90
    v_mov_b32 v223, v91
    ds_read_b64_tr_b16 a[48:49], v76 offset:8192
    ds_read_b64_tr_b16 a[50:51], v76 offset:8704
    ds_read_b64_tr_b16 v[84:85], v77 offset:8192
    ds_read_b64_tr_b16 v[86:87], v77 offset:8704
    ds_read_b64_tr_b16 a[208:209], v78 offset:8192
    ds_read_b64_tr_b16 a[210:211], v78 offset:8704
    ds_read_b64_tr_b16 v[88:89], v79 offset:8192
    ds_read_b64_tr_b16 v[90:91], v79 offset:8704
    s_waitcnt lgkmcnt(0)
    s_nop 0
    v_cndmask_b32 v84, 0, v84, s[68:69]
    v_cndmask_b32 v85, 0, v85, s[68:69]
    v_cndmask_b32 v86, 0, v86, s[68:69]
    v_cndmask_b32 v87, 0, v87, s[68:69]
    v_accvgpr_write_b32 a128, v84
    v_accvgpr_write_b32 a129, v85
    v_accvgpr_write_b32 a130, v86
    v_accvgpr_write_b32 a131, v87
    v_cndmask_b32 v88, 0, v88, s[68:69]
    v_cndmask_b32 v89, 0, v89, s[68:69]
    v_cndmask_b32 v90, 0, v90, s[68:69]
    v_cndmask_b32 v91, 0, v91, s[68:69]
    v_mov_b32 v224, v88
    v_mov_b32 v225, v89
    v_mov_b32 v226, v90
    v_mov_b32 v227, v91
    ds_read_b64_tr_b16 a[52:53], v76 offset:12288
    ds_read_b64_tr_b16 a[54:55], v76 offset:12800
    ds_read_b64_tr_b16 v[84:85], v77 offset:12288
    ds_read_b64_tr_b16 v[86:87], v77 offset:12800
    ds_read_b64_tr_b16 a[212:213], v78 offset:12288
    ds_read_b64_tr_b16 a[214:215], v78 offset:12800
    ds_read_b64_tr_b16 v[88:89], v79 offset:12288
    ds_read_b64_tr_b16 v[90:91], v79 offset:12800
    s_waitcnt lgkmcnt(0)
    s_nop 0
    v_cndmask_b32 v84, 0, v84, s[68:69]
    v_cndmask_b32 v85, 0, v85, s[68:69]
    v_cndmask_b32 v86, 0, v86, s[68:69]
    v_cndmask_b32 v87, 0, v87, s[68:69]
    v_accvgpr_write_b32 a132, v84
    v_accvgpr_write_b32 a133, v85
    v_accvgpr_write_b32 a134, v86
    v_accvgpr_write_b32 a135, v87
    v_cndmask_b32 v88, 0, v88, s[68:69]
    v_cndmask_b32 v89, 0, v89, s[68:69]
    v_cndmask_b32 v90, 0, v90, s[68:69]
    v_cndmask_b32 v91, 0, v91, s[68:69]
    v_mov_b32 v228, v88
    v_mov_b32 v229, v89
    v_mov_b32 v230, v90
    v_mov_b32 v231, v91
    ds_read_b64_tr_b16 a[56:57], v76 offset:16384
    ds_read_b64_tr_b16 a[58:59], v76 offset:16896
    ds_read_b64_tr_b16 v[84:85], v77 offset:16384
    ds_read_b64_tr_b16 v[86:87], v77 offset:16896
    ds_read_b64_tr_b16 a[216:217], v78 offset:16384
    ds_read_b64_tr_b16 a[218:219], v78 offset:16896
    ds_read_b64_tr_b16 v[88:89], v79 offset:16384
    ds_read_b64_tr_b16 v[90:91], v79 offset:16896
    s_waitcnt lgkmcnt(0)
    s_nop 0
    v_cndmask_b32 v84, 0, v84, s[68:69]
    v_cndmask_b32 v85, 0, v85, s[68:69]
    v_cndmask_b32 v86, 0, v86, s[68:69]
    v_cndmask_b32 v87, 0, v87, s[68:69]
    v_accvgpr_write_b32 a136, v84
    v_accvgpr_write_b32 a137, v85
    v_accvgpr_write_b32 a138, v86
    v_accvgpr_write_b32 a139, v87
    v_cndmask_b32 v88, 0, v88, s[68:69]
    v_cndmask_b32 v89, 0, v89, s[68:69]
    v_cndmask_b32 v90, 0, v90, s[68:69]
    v_cndmask_b32 v91, 0, v91, s[68:69]
    v_mov_b32 v232, v88
    v_mov_b32 v233, v89
    v_mov_b32 v234, v90
    v_mov_b32 v235, v91
    ds_read_b64_tr_b16 a[60:61], v76 offset:20480
    ds_read_b64_tr_b16 a[62:63], v76 offset:20992
    ds_read_b64_tr_b16 v[84:85], v77 offset:20480
    ds_read_b64_tr_b16 v[86:87], v77 offset:20992
    ds_read_b64_tr_b16 a[220:221], v78 offset:20480
    ds_read_b64_tr_b16 a[222:223], v78 offset:20992
    ds_read_b64_tr_b16 v[88:89], v79 offset:20480
    ds_read_b64_tr_b16 v[90:91], v79 offset:20992
    s_waitcnt lgkmcnt(0)
    s_nop 0
    v_cndmask_b32 v84, 0, v84, s[68:69]
    v_cndmask_b32 v85, 0, v85, s[68:69]
    v_cndmask_b32 v86, 0, v86, s[68:69]
    v_cndmask_b32 v87, 0, v87, s[68:69]
    v_accvgpr_write_b32 a140, v84
    v_accvgpr_write_b32 a141, v85
    v_accvgpr_write_b32 a142, v86
    v_accvgpr_write_b32 a143, v87
    v_cndmask_b32 v88, 0, v88, s[68:69]
    v_cndmask_b32 v89, 0, v89, s[68:69]
    v_cndmask_b32 v90, 0, v90, s[68:69]
    v_cndmask_b32 v91, 0, v91, s[68:69]
    v_mov_b32 v236, v88
    v_mov_b32 v237, v89
    v_mov_b32 v238, v90
    v_mov_b32 v239, v91
    ds_read_b64_tr_b16 a[64:65], v76 offset:24576
    ds_read_b64_tr_b16 a[66:67], v76 offset:25088
    ds_read_b64_tr_b16 v[84:85], v77 offset:24576
    ds_read_b64_tr_b16 v[86:87], v77 offset:25088
    ds_read_b64_tr_b16 a[224:225], v78 offset:24576
    ds_read_b64_tr_b16 a[226:227], v78 offset:25088
    ds_read_b64_tr_b16 v[88:89], v79 offset:24576
    ds_read_b64_tr_b16 v[90:91], v79 offset:25088
    s_waitcnt lgkmcnt(0)
    s_nop 0
    v_cndmask_b32 v84, 0, v84, s[68:69]
    v_cndmask_b32 v85, 0, v85, s[68:69]
    v_cndmask_b32 v86, 0, v86, s[68:69]
    v_cndmask_b32 v87, 0, v87, s[68:69]
    v_accvgpr_write_b32 a144, v84
    v_accvgpr_write_b32 a145, v85
    v_accvgpr_write_b32 a146, v86
    v_accvgpr_write_b32 a147, v87
    v_cndmask_b32 v88, 0, v88, s[68:69]
    v_cndmask_b32 v89, 0, v89, s[68:69]
    v_cndmask_b32 v90, 0, v90, s[68:69]
    v_cndmask_b32 v91, 0, v91, s[68:69]
    v_mov_b32 v240, v88
    v_mov_b32 v241, v89
    v_mov_b32 v242, v90
    v_mov_b32 v243, v91
    ds_read_b64_tr_b16 a[68:69], v76 offset:28672
    ds_read_b64_tr_b16 a[70:71], v76 offset:29184
    ds_read_b64_tr_b16 v[84:85], v77 offset:28672
    ds_read_b64_tr_b16 v[86:87], v77 offset:29184
    ds_read_b64_tr_b16 a[228:229], v78 offset:28672
    ds_read_b64_tr_b16 a[230:231], v78 offset:29184
    ds_read_b64_tr_b16 v[88:89], v79 offset:28672
    ds_read_b64_tr_b16 v[90:91], v79 offset:29184
    s_waitcnt lgkmcnt(0)
    s_nop 0
    v_cndmask_b32 v84, 0, v84, s[68:69]
    v_cndmask_b32 v85, 0, v85, s[68:69]
    v_cndmask_b32 v86, 0, v86, s[68:69]
    v_cndmask_b32 v87, 0, v87, s[68:69]
    v_accvgpr_write_b32 a148, v84
    v_accvgpr_write_b32 a149, v85
    v_accvgpr_write_b32 a150, v86
    v_accvgpr_write_b32 a151, v87
    v_cndmask_b32 v88, 0, v88, s[68:69]
    v_cndmask_b32 v89, 0, v89, s[68:69]
    v_cndmask_b32 v90, 0, v90, s[68:69]
    v_cndmask_b32 v91, 0, v91, s[68:69]
    v_mov_b32 v244, v88
    v_mov_b32 v245, v89
    v_mov_b32 v246, v90
    v_mov_b32 v247, v91
    ds_read_b64_tr_b16 a[72:73], v76 offset:32768
    ds_read_b64_tr_b16 a[74:75], v76 offset:33280
    ds_read_b64_tr_b16 v[84:85], v77 offset:32768
    ds_read_b64_tr_b16 v[86:87], v77 offset:33280
    ds_read_b64_tr_b16 a[232:233], v78 offset:32768
    ds_read_b64_tr_b16 a[234:235], v78 offset:33280
    ds_read_b64_tr_b16 v[88:89], v79 offset:32768
    ds_read_b64_tr_b16 v[90:91], v79 offset:33280
    s_waitcnt lgkmcnt(0)
    s_nop 0
    v_cndmask_b32 v84, 0, v84, s[68:69]
    v_cndmask_b32 v85, 0, v85, s[68:69]
    v_cndmask_b32 v86, 0, v86, s[68:69]
    v_cndmask_b32 v87, 0, v87, s[68:69]
    v_accvgpr_write_b32 a152, v84
    v_accvgpr_write_b32 a153, v85
    v_accvgpr_write_b32 a154, v86
    v_accvgpr_write_b32 a155, v87
    v_cndmask_b32 v88, 0, v88, s[68:69]
    v_cndmask_b32 v89, 0, v89, s[68:69]
    v_cndmask_b32 v90, 0, v90, s[68:69]
    v_cndmask_b32 v91, 0, v91, s[68:69]
    v_mov_b32 v248, v88
    v_mov_b32 v249, v89
    v_mov_b32 v250, v90
    v_mov_b32 v251, v91
    ds_read_b64_tr_b16 a[76:77], v76 offset:36864
    ds_read_b64_tr_b16 a[78:79], v76 offset:37376
    ds_read_b64_tr_b16 v[84:85], v77 offset:36864
    ds_read_b64_tr_b16 v[86:87], v77 offset:37376
    ds_read_b64_tr_b16 a[236:237], v78 offset:36864
    ds_read_b64_tr_b16 a[238:239], v78 offset:37376
    ds_read_b64_tr_b16 v[88:89], v79 offset:36864
    ds_read_b64_tr_b16 v[90:91], v79 offset:37376
    s_waitcnt lgkmcnt(0)
    s_nop 0
    v_cndmask_b32 v84, 0, v84, s[68:69]
    v_cndmask_b32 v85, 0, v85, s[68:69]
    v_cndmask_b32 v86, 0, v86, s[68:69]
    v_cndmask_b32 v87, 0, v87, s[68:69]
    v_accvgpr_write_b32 a156, v84
    v_accvgpr_write_b32 a157, v85
    v_accvgpr_write_b32 a158, v86
    v_accvgpr_write_b32 a159, v87
    v_cndmask_b32 v88, 0, v88, s[68:69]
    v_cndmask_b32 v89, 0, v89, s[68:69]
    v_cndmask_b32 v90, 0, v90, s[68:69]
    v_cndmask_b32 v91, 0, v91, s[68:69]
    v_mov_b32 v252, v88
    v_mov_b32 v253, v89
    v_mov_b32 v254, v90
    v_mov_b32 v255, v91
    s_waitcnt lgkmcnt(0)
    s_barrier
    s_lshl_b32 s48, s28, 13
    s_add_u32 m0, s48, 0
    s_add_u32 s49, s59, 512
    buffer_load_dwordx4 v64, s[36:39], s49 offen offset:0 lds
    buffer_load_dwordx4 v65, s[36:39], s49 offen offset:1024 lds
    buffer_load_dwordx4 v66, s[36:39], s49 offen offset:2048 lds
    buffer_load_dwordx4 v67, s[36:39], s49 offen offset:3072 lds
    s_lshl_b32 s48, s28, 13
    s_add_u32 m0, s48, 4096
    s_add_u32 s49, s59, 20992
    buffer_load_dwordx4 v64, s[36:39], s49 offen offset:0 lds
    buffer_load_dwordx4 v65, s[36:39], s49 offen offset:1024 lds
    buffer_load_dwordx4 v66, s[36:39], s49 offen offset:2048 lds
    buffer_load_dwordx4 v67, s[36:39], s49 offen offset:3072 lds
    s_lshl_b32 s48, s28, 13
    s_add_u32 m0, s48, 32768
    s_add_u32 s49, s59, 768
    buffer_load_dwordx4 v64, s[36:39], s49 offen offset:0 lds
    buffer_load_dwordx4 v65, s[36:39], s49 offen offset:1024 lds
    buffer_load_dwordx4 v66, s[36:39], s49 offen offset:2048 lds
    buffer_load_dwordx4 v67, s[36:39], s49 offen offset:3072 lds
    s_lshl_b32 s48, s28, 13
    s_add_u32 m0, s48, 36864
    s_add_u32 s49, s59, 21248
    buffer_load_dwordx4 v64, s[36:39], s49 offen offset:0 lds
    buffer_load_dwordx4 v65, s[36:39], s49 offen offset:1024 lds
    buffer_load_dwordx4 v66, s[36:39], s49 offen offset:2048 lds
    buffer_load_dwordx4 v67, s[36:39], s49 offen offset:3072 lds
    s_lshl_b32 s48, s28, 13
    s_add_u32 m0, s48, 65536
    s_add_u32 s49, s59, 1024
    buffer_load_dwordx4 v64, s[36:39], s49 offen offset:0 lds
    buffer_load_dwordx4 v65, s[36:39], s49 offen offset:1024 lds
    buffer_load_dwordx4 v66, s[36:39], s49 offen offset:2048 lds
    buffer_load_dwordx4 v67, s[36:39], s49 offen offset:3072 lds
    s_lshl_b32 s48, s28, 13
    s_add_u32 m0, s48, 69632
    s_add_u32 s49, s59, 21504
    buffer_load_dwordx4 v64, s[36:39], s49 offen offset:0 lds
    buffer_load_dwordx4 v65, s[36:39], s49 offen offset:1024 lds
    buffer_load_dwordx4 v66, s[36:39], s49 offen offset:2048 lds
    buffer_load_dwordx4 v67, s[36:39], s49 offen offset:3072 lds
    s_mov_b32 s60, 0
    s_waitcnt vmcnt(0)
    v_mov_b32 v112, 0
    v_mov_b32 v113, 0
    v_mov_b32 v114, 0
    v_mov_b32 v115, 0
    v_mov_b32 v116, 0
    v_mov_b32 v117, 0
    v_mov_b32 v118, 0
    v_mov_b32 v119, 0
    v_mov_b32 v120, 0
    v_mov_b32 v121, 0
    v_mov_b32 v122, 0
    v_mov_b32 v123, 0
    v_mov_b32 v124, 0
    v_mov_b32 v125, 0
    v_mov_b32 v126, 0
    v_mov_b32 v127, 0
    v_and_b32 v128, 15, v0
    v_cmp_eq_u32 s[72:73], 4, v128
    v_mov_b32 v143, 0x3f803f80
wsg_loop_52:
    s_add_u32 s52, s59, 163840
    s_cmp_eq_u32 s60, s63
    s_cselect_b32 s52, s59, s52
    s_waitcnt vmcnt(32)
    ds_read_b128 v[36:39], v104 offset:32768
    ds_read_b128 v[40:43], v104 offset:36864
    ds_read_b128 v[44:47], v105 offset:32768
    ds_read_b128 v[48:51], v105 offset:36864
    s_waitcnt lgkmcnt(2)
    v_mfma_f32_16x16x32_bf16 v[4:7], v[36:39], a[0:3], 0
    v_mfma_f32_16x16x32_bf16 v[8:11], v[36:39], a[80:83], 0
    v_mfma_f32_16x16x32_bf16 v[12:15], v[36:39], a[160:163], 0
    v_mfma_f32_16x16x32_bf16 v[16:19], v[36:39], a[240:243], 0
    v_mfma_f32_16x16x32_bf16 v[20:23], v[40:43], a[0:3], 0
    v_mfma_f32_16x16x32_bf16 v[24:27], v[40:43], a[80:83], 0
    v_mfma_f32_16x16x32_bf16 v[28:31], v[40:43], a[160:163], 0
    v_mfma_f32_16x16x32_bf16 v[32:35], v[40:43], a[240:243], 0
    ds_read_b128 v[36:39], v106 offset:32768
    ds_read_b128 v[40:43], v106 offset:36864
    s_waitcnt lgkmcnt(2)
    v_mfma_f32_16x16x32_bf16 v[4:7], v[44:47], a[4:7], v[4:7]
    v_mfma_f32_16x16x32_bf16 v[8:11], v[44:47], a[84:87], v[8:11]
    v_mfma_f32_16x16x32_bf16 v[12:15], v[44:47], a[164:167], v[12:15]
    v_mfma_f32_16x16x32_bf16 v[16:19], v[44:47], a[244:247], v[16:19]
    v_mfma_f32_16x16x32_bf16 v[20:23], v[48:51], a[4:7], v[20:23]
    v_mfma_f32_16x16x32_bf16 v[24:27], v[48:51], a[84:87], v[24:27]
    v_mfma_f32_16x16x32_bf16 v[28:31], v[48:51], a[164:167], v[28:31]
    v_mfma_f32_16x16x32_bf16 v[32:35], v[48:51], a[244:247], v[32:35]
    ds_read_b128 v[44:47], v107 offset:32768
    ds_read_b128 v[48:51], v107 offset:36864
    s_waitcnt lgkmcnt(2)
    v_mfma_f32_16x16x32_bf16 v[4:7], v[36:39], a[8:11], v[4:7]
    v_mfma_f32_16x16x32_bf16 v[8:11], v[36:39], a[88:91], v[8:11]
    v_mfma_f32_16x16x32_bf16 v[12:15], v[36:39], a[168:171], v[12:15]
    v_mfma_f32_16x16x32_bf16 v[16:19], v[36:39], a[248:251], v[16:19]
    v_mfma_f32_16x16x32_bf16 v[20:23], v[40:43], a[8:11], v[20:23]
    v_mfma_f32_16x16x32_bf16 v[24:27], v[40:43], a[88:91], v[24:27]
    v_mfma_f32_16x16x32_bf16 v[28:31], v[40:43], a[168:171], v[28:31]
    v_mfma_f32_16x16x32_bf16 v[32:35], v[40:43], a[248:251], v[32:35]
    s_waitcnt lgkmcnt(0)
    v_mfma_f32_16x16x32_bf16 v[4:7], v[44:47], a[12:15], v[4:7]
    v_mfma_f32_16x16x32_bf16 v[8:11], v[44:47], a[92:95], v[8:11]
    v_mfma_f32_16x16x32_bf16 v[12:15], v[44:47], a[172:175], v[12:15]
    v_mfma_f32_16x16x32_bf16 v[16:19], v[44:47], a[252:255], v[16:19]
    v_mfma_f32_16x16x32_bf16 v[20:23], v[48:51], a[12:15], v[20:23]
    v_mfma_f32_16x16x32_bf16 v[24:27], v[48:51], a[92:95], v[24:27]
    v_mfma_f32_16x16x32_bf16 v[28:31], v[48:51], a[172:175], v[28:31]
    v_mfma_f32_16x16x32_bf16 v[32:35], v[48:51], a[252:255], v[32:35]
    s_lshl_b32 s48, s28, 13
    s_add_u32 m0, s48, 98304
    s_add_u32 s49, s52, 0
    buffer_load_dwordx4 v64, s[36:39], s49 offen offset:0 lds
    buffer_load_dwordx4 v65, s[36:39], s49 offen offset:1024 lds
    buffer_load_dwordx4 v66, s[36:39], s49 offen offset:2048 lds
    buffer_load_dwordx4 v67, s[36:39], s49 offen offset:3072 lds
    s_lshl_b32 s48, s28, 13
    s_add_u32 m0, s48, 102400
    s_add_u32 s49, s52, 20480
    buffer_load_dwordx4 v64, s[36:39], s49 offen offset:0 lds
    buffer_load_dwordx4 v65, s[36:39], s49 offen offset:1024 lds
    buffer_load_dwordx4 v66, s[36:39], s49 offen offset:2048 lds
    buffer_load_dwordx4 v67, s[36:39], s49 offen offset:3072 lds
    s_waitcnt vmcnt(32)
    ds_read_b128 v[36:39], v108 offset:0
    ds_read_b128 v[40:43], v108 offset:4096
    ds_read_b128 v[44:47], v109 offset:0
    ds_read_b128 v[48:51], v109 offset:4096
    s_waitcnt lgkmcnt(2)
    v_mfma_f32_16x16x32_bf16 v[4:7], v[36:39], a[16:19], v[4:7]
    v_mfma_f32_16x16x32_bf16 v[8:11], v[36:39], a[96:99], v[8:11]
    v_mfma_f32_16x16x32_bf16 v[12:15], v[36:39], a[176:179], v[12:15]
    v_mfma_f32_16x16x32_bf16 v[16:19], v[36:39], v[192:195], v[16:19]
    v_mfma_f32_16x16x32_bf16 v[20:23], v[40:43], a[16:19], v[20:23]
    v_mfma_f32_16x16x32_bf16 v[24:27], v[40:43], a[96:99], v[24:27]
    v_mfma_f32_16x16x32_bf16 v[28:31], v[40:43], a[176:179], v[28:31]
    v_mfma_f32_16x16x32_bf16 v[32:35], v[40:43], v[192:195], v[32:35]
    ds_read_b128 v[36:39], v110 offset:0
    ds_read_b128 v[40:43], v110 offset:4096
    s_waitcnt lgkmcnt(2)
    v_mfma_f32_16x16x32_bf16 v[4:7], v[44:47], a[20:23], v[4:7]
    v_mfma_f32_16x16x32_bf16 v[8:11], v[44:47], a[100:103], v[8:11]
    v_mfma_f32_16x16x32_bf16 v[12:15], v[44:47], a[180:183], v[12:15]
    v_mfma_f32_16x16x32_bf16 v[16:19], v[44:47], v[196:199], v[16:19]
    v_mfma_f32_16x16x32_bf16 v[20:23], v[48:51], a[20:23], v[20:23]
    v_mfma_f32_16x16x32_bf16 v[24:27], v[48:51], a[100:103], v[24:27]
    v_mfma_f32_16x16x32_bf16 v[28:31], v[48:51], a[180:183], v[28:31]
    v_mfma_f32_16x16x32_bf16 v[32:35], v[48:51], v[196:199], v[32:35]
    ds_read_b128 v[44:47], v111 offset:0
    ds_read_b128 v[48:51], v111 offset:4096
    s_waitcnt lgkmcnt(2)
    v_mfma_f32_16x16x32_bf16 v[4:7], v[36:39], a[24:27], v[4:7]
    v_mfma_f32_16x16x32_bf16 v[8:11], v[36:39], a[104:107], v[8:11]
    v_mfma_f32_16x16x32_bf16 v[12:15], v[36:39], a[184:187], v[12:15]
    v_mfma_f32_16x16x32_bf16 v[16:19], v[36:39], v[200:203], v[16:19]
    v_mfma_f32_16x16x32_bf16 v[20:23], v[40:43], a[24:27], v[20:23]
    v_mfma_f32_16x16x32_bf16 v[24:27], v[40:43], a[104:107], v[24:27]
    v_mfma_f32_16x16x32_bf16 v[28:31], v[40:43], a[184:187], v[28:31]
    v_mfma_f32_16x16x32_bf16 v[32:35], v[40:43], v[200:203], v[32:35]
    s_waitcnt lgkmcnt(0)
    v_mfma_f32_16x16x32_bf16 v[4:7], v[44:47], a[28:31], v[4:7]
    v_mfma_f32_16x16x32_bf16 v[8:11], v[44:47], a[108:111], v[8:11]
    v_mfma_f32_16x16x32_bf16 v[12:15], v[44:47], a[188:191], v[12:15]
    v_mfma_f32_16x16x32_bf16 v[16:19], v[44:47], v[204:207], v[16:19]
    v_mfma_f32_16x16x32_bf16 v[20:23], v[48:51], a[28:31], v[20:23]
    v_mfma_f32_16x16x32_bf16 v[24:27], v[48:51], a[108:111], v[24:27]
    v_mfma_f32_16x16x32_bf16 v[28:31], v[48:51], a[188:191], v[28:31]
    v_mfma_f32_16x16x32_bf16 v[32:35], v[48:51], v[204:207], v[32:35]
    s_lshl_b32 s48, s28, 13
    s_add_u32 m0, s48, 131072
    s_add_u32 s49, s52, 256
    buffer_load_dwordx4 v64, s[36:39], s49 offen offset:0 lds
    buffer_load_dwordx4 v65, s[36:39], s49 offen offset:1024 lds
    buffer_load_dwordx4 v66, s[36:39], s49 offen offset:2048 lds
    buffer_load_dwordx4 v67, s[36:39], s49 offen offset:3072 lds
    s_lshl_b32 s48, s28, 13
    s_add_u32 m0, s48, 135168
    s_add_u32 s49, s52, 20736
    buffer_load_dwordx4 v64, s[36:39], s49 offen offset:0 lds
    buffer_load_dwordx4 v65, s[36:39], s49 offen offset:1024 lds
    buffer_load_dwordx4 v66, s[36:39], s49 offen offset:2048 lds
    buffer_load_dwordx4 v67, s[36:39], s49 offen offset:3072 lds
    s_waitcnt vmcnt(32)
    ds_read_b128 v[36:39], v100 offset:0
    ds_read_b128 v[40:43], v100 offset:4096
    ds_read_b128 v[44:47], v101 offset:0
    ds_read_b128 v[48:51], v101 offset:4096
    s_waitcnt lgkmcnt(2)
    v_mfma_f32_16x16x32_bf16 v[4:7], v[36:39], a[32:35], v[4:7]
    v_mfma_f32_16x16x32_bf16 v[8:11], v[36:39], a[112:115], v[8:11]
    v_mfma_f32_16x16x32_bf16 v[12:15], v[36:39], a[192:195], v[12:15]
    v_mfma_f32_16x16x32_bf16 v[16:19], v[36:39], v[208:211], v[16:19]
    v_mfma_f32_16x16x32_bf16 v[20:23], v[40:43], a[32:35], v[20:23]
    v_mfma_f32_16x16x32_bf16 v[24:27], v[40:43], a[112:115], v[24:27]
    v_mfma_f32_16x16x32_bf16 v[28:31], v[40:43], a[192:195], v[28:31]
    v_mfma_f32_16x16x32_bf16 v[32:35], v[40:43], v[208:211], v[32:35]
    ds_read_b128 v[36:39], v102 offset:0
    ds_read_b128 v[40:43], v102 offset:4096
    s_waitcnt lgkmcnt(2)
    v_mfma_f32_16x16x32_bf16 v[4:7], v[44:47], a[36:39], v[4:7]
    v_mfma_f32_16x16x32_bf16 v[8:11], v[44:47], a[116:119], v[8:11]
    v_mfma_f32_16x16x32_bf16 v[12:15], v[44:47], a[196:199], v[12:15]
    v_mfma_f32_16x16x32_bf16 v[16:19], v[44:47], v[212:215], v[16:19]
    v_mfma_f32_16x16x32_bf16 v[20:23], v[48:51], a[36:39], v[20:23]
    v_mfma_f32_16x16x32_bf16 v[24:27], v[48:51], a[116:119], v[24:27]
    v_mfma_f32_16x16x32_bf16 v[28:31], v[48:51], a[196:199], v[28:31]
    v_mfma_f32_16x16x32_bf16 v[32:35], v[48:51], v[212:215], v[32:35]
    ds_read_b128 v[44:47], v103 offset:0
    ds_read_b128 v[48:51], v103 offset:4096
    s_waitcnt lgkmcnt(2)
    v_mfma_f32_16x16x32_bf16 v[4:7], v[36:39], a[40:43], v[4:7]
    v_mfma_f32_16x16x32_bf16 v[8:11], v[36:39], a[120:123], v[8:11]
    v_mfma_f32_16x16x32_bf16 v[12:15], v[36:39], a[200:203], v[12:15]
    v_mfma_f32_16x16x32_bf16 v[16:19], v[36:39], v[216:219], v[16:19]
    v_mfma_f32_16x16x32_bf16 v[20:23], v[40:43], a[40:43], v[20:23]
    v_mfma_f32_16x16x32_bf16 v[24:27], v[40:43], a[120:123], v[24:27]
    v_mfma_f32_16x16x32_bf16 v[28:31], v[40:43], a[200:203], v[28:31]
    v_mfma_f32_16x16x32_bf16 v[32:35], v[40:43], v[216:219], v[32:35]
    s_waitcnt lgkmcnt(0)
    v_mfma_f32_16x16x32_bf16 v[4:7], v[44:47], a[44:47], v[4:7]
    v_mfma_f32_16x16x32_bf16 v[8:11], v[44:47], a[124:127], v[8:11]
    v_mfma_f32_16x16x32_bf16 v[12:15], v[44:47], a[204:207], v[12:15]
    v_mfma_f32_16x16x32_bf16 v[16:19], v[44:47], v[220:223], v[16:19]
    v_mfma_f32_16x16x32_bf16 v[20:23], v[48:51], a[44:47], v[20:23]
    v_mfma_f32_16x16x32_bf16 v[24:27], v[48:51], a[124:127], v[24:27]
    v_mfma_f32_16x16x32_bf16 v[28:31], v[48:51], a[204:207], v[28:31]
    v_mfma_f32_16x16x32_bf16 v[32:35], v[48:51], v[220:223], v[32:35]
    s_lshl_b32 s48, s28, 13
    s_add_u32 m0, s48, 0
    s_add_u32 s49, s52, 512
    buffer_load_dwordx4 v64, s[36:39], s49 offen offset:0 lds
    buffer_load_dwordx4 v65, s[36:39], s49 offen offset:1024 lds
    buffer_load_dwordx4 v66, s[36:39], s49 offen offset:2048 lds
    buffer_load_dwordx4 v67, s[36:39], s49 offen offset:3072 lds
    s_lshl_b32 s48, s28, 13
    s_add_u32 m0, s48, 4096
    s_add_u32 s49, s52, 20992
    buffer_load_dwordx4 v64, s[36:39], s49 offen offset:0 lds
    buffer_load_dwordx4 v65, s[36:39], s49 offen offset:1024 lds
    buffer_load_dwordx4 v66, s[36:39], s49 offen offset:2048 lds
    buffer_load_dwordx4 v67, s[36:39], s49 offen offset:3072 lds
    s_waitcnt vmcnt(32)
    ds_read_b128 v[36:39], v100 offset:32768
    ds_read_b128 v[40:43], v100 offset:36864
    ds_read_b128 v[44:47], v101 offset:32768
    ds_read_b128 v[48:51], v101 offset:36864
    s_waitcnt lgkmcnt(2)
    v_mfma_f32_16x16x32_bf16 v[4:7], v[36:39], a[48:51], v[4:7]
    v_mfma_f32_16x16x32_bf16 v[8:11], v[36:39], a[128:131], v[8:11]
    v_mfma_f32_16x16x32_bf16 v[12:15], v[36:39], a[208:211], v[12:15]
    v_mfma_f32_16x16x32_bf16 v[16:19], v[36:39], v[224:227], v[16:19]
    v_mfma_f32_16x16x32_bf16 v[20:23], v[40:43], a[48:51], v[20:23]
    v_mfma_f32_16x16x32_bf16 v[24:27], v[40:43], a[128:131], v[24:27]
    v_mfma_f32_16x16x32_bf16 v[28:31], v[40:43], a[208:211], v[28:31]
    v_mfma_f32_16x16x32_bf16 v[32:35], v[40:43], v[224:227], v[32:35]
    ds_read_b128 v[36:39], v102 offset:32768
    ds_read_b128 v[40:43], v102 offset:36864
    s_waitcnt lgkmcnt(2)
    v_mfma_f32_16x16x32_bf16 v[4:7], v[44:47], a[52:55], v[4:7]
    v_mfma_f32_16x16x32_bf16 v[8:11], v[44:47], a[132:135], v[8:11]
    v_mfma_f32_16x16x32_bf16 v[12:15], v[44:47], a[212:215], v[12:15]
    v_mfma_f32_16x16x32_bf16 v[16:19], v[44:47], v[228:231], v[16:19]
    v_mfma_f32_16x16x32_bf16 v[20:23], v[48:51], a[52:55], v[20:23]
    v_mfma_f32_16x16x32_bf16 v[24:27], v[48:51], a[132:135], v[24:27]
    v_mfma_f32_16x16x32_bf16 v[28:31], v[48:51], a[212:215], v[28:31]
    v_mfma_f32_16x16x32_bf16 v[32:35], v[48:51], v[228:231], v[32:35]
    ds_read_b128 v[44:47], v103 offset:32768
    ds_read_b128 v[48:51], v103 offset:36864
    s_waitcnt lgkmcnt(2)
    v_mfma_f32_16x16x32_bf16 v[4:7], v[36:39], a[56:59], v[4:7]
    v_mfma_f32_16x16x32_bf16 v[8:11], v[36:39], a[136:139], v[8:11]
    v_mfma_f32_16x16x32_bf16 v[12:15], v[36:39], a[216:219], v[12:15]
    v_mfma_f32_16x16x32_bf16 v[16:19], v[36:39], v[232:235], v[16:19]
    v_mfma_f32_16x16x32_bf16 v[20:23], v[40:43], a[56:59], v[20:23]
    v_mfma_f32_16x16x32_bf16 v[24:27], v[40:43], a[136:139], v[24:27]
    v_mfma_f32_16x16x32_bf16 v[28:31], v[40:43], a[216:219], v[28:31]
    v_mfma_f32_16x16x32_bf16 v[32:35], v[40:43], v[232:235], v[32:35]
    s_waitcnt lgkmcnt(0)
    v_mfma_f32_16x16x32_bf16 v[4:7], v[44:47], a[60:63], v[4:7]
    v_mfma_f32_16x16x32_bf16 v[8:11], v[44:47], a[140:143], v[8:11]
    v_mfma_f32_16x16x32_bf16 v[12:15], v[44:47], a[220:223], v[12:15]
    v_mfma_f32_16x16x32_bf16 v[16:19], v[44:47], v[236:239], v[16:19]
    v_mfma_f32_16x16x32_bf16 v[20:23], v[48:51], a[60:63], v[20:23]
    v_mfma_f32_16x16x32_bf16 v[24:27], v[48:51], a[140:143], v[24:27]
    v_mfma_f32_16x16x32_bf16 v[28:31], v[48:51], a[220:223], v[28:31]
    v_mfma_f32_16x16x32_bf16 v[32:35], v[48:51], v[236:239], v[32:35]
    s_lshl_b32 s48, s28, 13
    s_add_u32 m0, s48, 32768
    s_add_u32 s49, s52, 768
    buffer_load_dwordx4 v64, s[36:39], s49 offen offset:0 lds
    buffer_load_dwordx4 v65, s[36:39], s49 offen offset:1024 lds
    buffer_load_dwordx4 v66, s[36:39], s49 offen offset:2048 lds
    buffer_load_dwordx4 v67, s[36:39], s49 offen offset:3072 lds
    s_lshl_b32 s48, s28, 13
    s_add_u32 m0, s48, 36864
    s_add_u32 s49, s52, 21248
    buffer_load_dwordx4 v64, s[36:39], s49 offen offset:0 lds
    buffer_load_dwordx4 v65, s[36:39], s49 offen offset:1024 lds
    buffer_load_dwordx4 v66, s[36:39], s49 offen offset:2048 lds
    buffer_load_dwordx4 v67, s[36:39], s49 offen offset:3072 lds
    s_waitcnt vmcnt(32)
    ds_read_b128 v[36:39], v104 offset:0
    ds_read_b128 v[40:43], v104 offset:4096
    ds_read_b128 v[44:47], v105 offset:0
    ds_read_b128 v[48:51], v105 offset:4096
    s_waitcnt lgkmcnt(2)
    v_mfma_f32_16x16x32_bf16 v[4:7], v[36:39], a[64:67], v[4:7]
    v_mfma_f32_16x16x32_bf16 v[8:11], v[36:39], a[144:147], v[8:11]
    v_mfma_f32_16x16x32_bf16 v[12:15], v[36:39], a[224:227], v[12:15]
    v_mfma_f32_16x16x32_bf16 v[16:19], v[36:39], v[240:243], v[16:19]
    v_mfma_f32_16x16x32_bf16 v[20:23], v[40:43], a[64:67], v[20:23]
    v_mfma_f32_16x16x32_bf16 v[24:27], v[40:43], a[144:147], v[24:27]
    v_mfma_f32_16x16x32_bf16 v[28:31], v[40:43], a[224:227], v[28:31]
    v_mfma_f32_16x16x32_bf16 v[32:35], v[40:43], v[240:243], v[32:35]
    ds_read_b128 v[36:39], v106 offset:0
    ds_read_b128 v[40:43], v106 offset:4096
    s_waitcnt lgkmcnt(2)
    v_mfma_f32_16x16x32_bf16 v[4:7], v[44:47], a[68:71], v[4:7]
    v_mfma_f32_16x16x32_bf16 v[8:11], v[44:47], a[148:151], v[8:11]
    v_mfma_f32_16x16x32_bf16 v[12:15], v[44:47], a[228:231], v[12:15]
    v_mfma_f32_16x16x32_bf16 v[16:19], v[44:47], v[244:247], v[16:19]
    v_mfma_f32_16x16x32_bf16 v[20:23], v[48:51], a[68:71], v[20:23]
    v_mfma_f32_16x16x32_bf16 v[24:27], v[48:51], a[148:151], v[24:27]
    v_mfma_f32_16x16x32_bf16 v[28:31], v[48:51], a[228:231], v[28:31]
    v_mfma_f32_16x16x32_bf16 v[32:35], v[48:51], v[244:247], v[32:35]
    ds_read_b128 v[44:47], v107 offset:0
    ds_read_b128 v[48:51], v107 offset:4096
    s_waitcnt lgkmcnt(2)
    v_mfma_f32_16x16x32_bf16 v[4:7], v[36:39], a[72:75], v[4:7]
    v_mfma_f32_16x16x32_bf16 v[8:11], v[36:39], a[152:155], v[8:11]
    v_mfma_f32_16x16x32_bf16 v[12:15], v[36:39], a[232:235], v[12:15]
    v_mfma_f32_16x16x32_bf16 v[16:19], v[36:39], v[248:251], v[16:19]
    v_mfma_f32_16x16x32_bf16 v[20:23], v[40:43], a[72:75], v[20:23]
    v_mfma_f32_16x16x32_bf16 v[24:27], v[40:43], a[152:155], v[24:27]
    v_mfma_f32_16x16x32_bf16 v[28:31], v[40:43], a[232:235], v[28:31]
    v_mfma_f32_16x16x32_bf16 v[32:35], v[40:43], v[248:251], v[32:35]
    s_waitcnt lgkmcnt(0)
    v_mfma_f32_16x16x32_bf16 v[4:7], v[44:47], a[76:79], v[4:7]
    v_mfma_f32_16x16x32_bf16 v[8:11], v[44:47], a[156:159], v[8:11]
    v_mfma_f32_16x16x32_bf16 v[12:15], v[44:47], a[236:239], v[12:15]
    v_mfma_f32_16x16x32_bf16 v[16:19], v[44:47], v[252:255], v[16:19]
    v_mfma_f32_16x16x32_bf16 v[20:23], v[48:51], a[76:79], v[20:23]
    v_mfma_f32_16x16x32_bf16 v[24:27], v[48:51], a[156:159], v[24:27]
    v_mfma_f32_16x16x32_bf16 v[28:31], v[48:51], a[236:239], v[28:31]
    v_mfma_f32_16x16x32_bf16 v[32:35], v[48:51], v[252:255], v[32:35]
    s_lshl_b32 s48, s28, 13
    s_add_u32 m0, s48, 65536
    s_add_u32 s49, s52, 1024
    buffer_load_dwordx4 v64, s[36:39], s49 offen offset:0 lds
    buffer_load_dwordx4 v65, s[36:39], s49 offen offset:1024 lds
    buffer_load_dwordx4 v66, s[36:39], s49 offen offset:2048 lds
    buffer_load_dwordx4 v67, s[36:39], s49 offen offset:3072 lds
    s_lshl_b32 s48, s28, 13
    s_add_u32 m0, s48, 69632
    s_add_u32 s49, s52, 21504
    buffer_load_dwordx4 v64, s[36:39], s49 offen offset:0 lds
    buffer_load_dwordx4 v65, s[36:39], s49 offen offset:1024 lds
    buffer_load_dwordx4 v66, s[36:39], s49 offen offset:2048 lds
    buffer_load_dwordx4 v67, s[36:39], s49 offen offset:3072 lds
    v_cvt_pk_bf16_f32 v128, v4, v5
    v_and_b32 v129, 0xffff0000, v128
    v_lshlrev_b32 v128, 16, v128
    v_pk_mul_f32 v[130:131], v[128:129], s[74:75]
    v_exp_f32 v130, v130
    v_exp_f32 v131, v131
    v_pk_add_f32 v[132:133], v[128:129], s[78:79]
    v_cmp_lt_f32_e64 vcc, 0, v128
    v_cmp_lt_f32 s[70:71], 0, v129
    s_nop 0
    v_cndmask_b32 v130, v130, v132, vcc
    v_cndmask_b32 v131, v131, v133, s[70:71]
    v_pk_add_f32 v[130:131], v[130:131], s[76:77]
    v_cvt_pk_bf16_f32 v80, v130, v131
    v_cvt_pk_bf16_f32 v134, v6, v7
    v_and_b32 v135, 0xffff0000, v134
    v_lshlrev_b32_e64 v134, 16, v134
    v_pk_mul_f32 v[136:137], v[134:135], s[74:75]
    v_exp_f32 v136, v136
    v_exp_f32 v137, v137
    v_pk_add_f32 v[138:139], v[134:135], s[78:79]
    v_cmp_lt_f32_e64 vcc, 0, v134
    v_cmp_lt_f32 s[70:71], 0, v135
    s_nop 0
    v_cndmask_b32 v136, v136, v138, vcc
    v_cndmask_b32 v137, v137, v139, s[70:71]
    v_pk_add_f32 v[136:137], v[136:137], s[76:77]
    v_cvt_pk_bf16_f32 v81, v136, v137
    v_cvt_pk_bf16_f32 v128, v20, v21
    v_and_b32 v129, 0xffff0000, v128
    v_lshlrev_b32_e64 v128, 16, v128
    v_pk_mul_f32 v[130:131], v[128:129], s[74:75]
    v_exp_f32 v130, v130
    v_exp_f32 v131, v131
    v_pk_add_f32 v[132:133], v[128:129], s[78:79]
    v_cmp_lt_f32_e64 vcc, 0, v128
    v_cmp_lt_f32 s[70:71], 0, v129
    s_nop 0
    v_cndmask_b32 v130, v130, v132, vcc
    v_cndmask_b32 v131, v131, v133, s[70:71]
    v_pk_add_f32 v[130:131], v[130:131], s[76:77]
    v_cvt_pk_bf16_f32 v82, v130, v131
    v_cvt_pk_bf16_f32 v134, v22, v23
    v_and_b32 v135, 0xffff0000, v134
    v_lshlrev_b32_e64 v134, 16, v134
    v_pk_mul_f32 v[136:137], v[134:135], s[74:75]
    v_exp_f32 v136, v136
    v_exp_f32 v137, v137
    v_pk_add_f32 v[138:139], v[134:135], s[78:79]
    v_cmp_lt_f32_e64 vcc, 0, v134
    v_cmp_lt_f32 s[70:71], 0, v135
    s_nop 0
    v_cndmask_b32 v136, v136, v138, vcc
    v_cndmask_b32 v137, v137, v139, s[70:71]
    v_pk_add_f32 v[136:137], v[136:137], s[76:77]
    v_cvt_pk_bf16_f32 v83, v136, v137
    v_cvt_pk_bf16_f32 v128, v8, v9
    v_and_b32 v129, 0xffff0000, v128
    v_lshlrev_b32_e64 v128, 16, v128
    v_pk_mul_f32 v[130:131], v[128:129], s[74:75]
    v_exp_f32 v130, v130
    v_exp_f32 v131, v131
    v_pk_add_f32 v[132:133], v[128:129], s[78:79]
    v_cmp_lt_f32_e64 vcc, 0, v128
    v_cmp_lt_f32 s[70:71], 0, v129
    s_nop 0
    v_cndmask_b32 v130, v130, v132, vcc
    v_cndmask_b32 v131, v131, v133, s[70:71]
    v_pk_add_f32 v[130:131], v[130:131], s[76:77]
    v_cvt_pk_bf16_f32 v84, v130, v131
    v_cvt_pk_bf16_f32 v134, v10, v11
    v_and_b32 v135, 0xffff0000, v134
    v_lshlrev_b32_e64 v134, 16, v134
    v_pk_mul_f32 v[136:137], v[134:135], s[74:75]
    v_exp_f32 v136, v136
    v_exp_f32 v137, v137
    v_pk_add_f32 v[138:139], v[134:135], s[78:79]
    v_cmp_lt_f32_e64 vcc, 0, v134
    v_cmp_lt_f32 s[70:71], 0, v135
    s_nop 0
    v_cndmask_b32 v136, v136, v138, vcc
    v_cndmask_b32 v137, v137, v139, s[70:71]
    v_pk_add_f32 v[136:137], v[136:137], s[76:77]
    v_cvt_pk_bf16_f32 v85, v136, v137
    v_cvt_pk_bf16_f32 v128, v24, v25
    v_and_b32 v129, 0xffff0000, v128
    v_lshlrev_b32_e64 v128, 16, v128
    v_pk_mul_f32 v[130:131], v[128:129], s[74:75]
    v_exp_f32 v130, v130
    v_exp_f32 v131, v131
    v_pk_add_f32 v[132:133], v[128:129], s[78:79]
    v_cmp_lt_f32_e64 vcc, 0, v128
    v_cmp_lt_f32 s[70:71], 0, v129
    s_nop 0
    v_cndmask_b32 v130, v130, v132, vcc
    v_cndmask_b32 v131, v131, v133, s[70:71]
    v_pk_add_f32 v[130:131], v[130:131], s[76:77]
    v_cvt_pk_bf16_f32 v86, v130, v131
    v_cvt_pk_bf16_f32 v134, v26, v27
    v_and_b32 v135, 0xffff0000, v134
    v_lshlrev_b32_e64 v134, 16, v134
    v_pk_mul_f32 v[136:137], v[134:135], s[74:75]
    v_exp_f32 v136, v136
    v_exp_f32 v137, v137
    v_pk_add_f32 v[138:139], v[134:135], s[78:79]
    v_cmp_lt_f32_e64 vcc, 0, v134
    v_cmp_lt_f32 s[70:71], 0, v135
    s_nop 0
    v_cndmask_b32 v136, v136, v138, vcc
    v_cndmask_b32 v137, v137, v139, s[70:71]
    v_pk_add_f32 v[136:137], v[136:137], s[76:77]
    v_cvt_pk_bf16_f32 v87, v136, v137
    v_cvt_pk_bf16_f32 v88, v12, v13
    v_cvt_pk_bf16_f32 v89, v14, v15
    v_cvt_pk_bf16_f32 v90, v28, v29
    v_cvt_pk_bf16_f32 v91, v30, v31
    v_cvt_pk_bf16_f32 v92, v16, v17
    v_cvt_pk_bf16_f32 v93, v18, v19
    v_cvt_pk_bf16_f32 v94, v32, v33
    v_cvt_pk_bf16_f32 v95, v34, v35
    v_cndmask_b32 v92, v92, v143, s[72:73]
    v_cndmask_b32 v93, v93, v143, s[72:73]
    v_cndmask_b32 v94, v94, v143, s[72:73]
    v_cndmask_b32 v95, v95, v143, s[72:73]
    v_mfma_f32_16x16x32_bf16 v[112:115], v[80:83], v[88:91], v[112:115]
    s_nop 0
    v_mfma_f32_16x16x32_bf16 v[116:119], v[80:83], v[92:95], v[116:119]
    v_mfma_f32_16x16x32_bf16 v[120:123], v[84:87], v[88:91], v[120:123]
    v_mfma_f32_16x16x32_bf16 v[124:127], v[84:87], v[92:95], v[124:127]
    s_mov_b32 s59, s52
    s_add_u32 s60, s60, 1
    s_cmp_le_u32 s60, s63
    s_cbranch_scc1 wsg_loop_52
    s_branch bkv_fin_51
bkv_fin_51:
    s_waitcnt vmcnt(0)
    s_barrier
    s_lshl_b32 s48, s28, 12
    v_add_u32 v128, s48, v72
    ds_write_b128 v128, v[112:115] offset:0
    ds_write_b128 v128, v[116:119] offset:1024
    ds_write_b128 v128, v[120:123] offset:2048
    ds_write_b128 v128, v[124:127] offset:3072
    s_waitcnt lgkmcnt(0)
    s_barrier
    s_lshl_b32 s48, s28, 10
    v_add_u32 v128, s48, v72
    ds_read_b128 v[112:115], v128 offset:0
    ds_read_b128 v[116:119], v128 offset:4096
    ds_read_b128 v[120:123], v128 offset:8192
    ds_read_b128 v[124:127], v128 offset:12288
    s_waitcnt lgkmcnt(0)
    v_add_f32 v112, v112, v116
    v_add_f32 v120, v120, v124
    v_add_f32 v113, v113, v117
    v_add_f32 v121, v121, v125
    v_add_f32 v114, v114, v118
    v_add_f32 v122, v122, v126
    v_add_f32 v115, v115, v119
    v_add_f32 v123, v123, v127
    v_add_f32 v112, v112, v120
    v_add_f32 v113, v113, v121
    v_add_f32 v114, v114, v122
    v_add_f32_e64 v115, v115, v123
    s_lshl_b32 s49, s29, 12
    s_add_u32 s48, s48, s49
    buffer_store_dwordx4 v[112:115], v72, s[40:43], s48 offen sc1
    s_waitcnt vmcnt(0)
    s_barrier
    s_cmp_eq_u32 s28, 0
    s_cbranch_scc0 bkv_nf_53
    s_lshl_b32 s61, s29, 2
    s_add_u32 s61, s61, 12288
    v_mov_b32 v73, 1
    v_mov_b32 v74, s61
    s_mov_b64 exec, 1
    buffer_store_dword v73, v74, s[44:47], 0 offen sc1
    s_mov_b64 exec, -1
    s_waitcnt vmcnt(0)
bkv_nf_53:
    s_branch k_b3
k_bq:
    s_sub_u32 s30, s29, 64
    s_mul_i32 s54, s30, 40
    s_add_u32 s55, s54, 20
    s_and_b32 s64, s54, 0xfffffff8
    s_lshl_b32 s64, s64, 1
    s_bfe_u32 s66, s54, 0x10002
    s_and_b32 s65, s55, 0xfffffff8
    s_lshl_b32 s65, s65, 1
    s_bfe_u32 s67, s55, 0x10002
    s_mov_b32 s74, 0x3fb8aa3b
    s_mov_b32 s75, 0x3fb8aa3b
    s_mov_b32 s76, 0x358637bd
    s_mov_b32 s77, 0x358637bd
    s_mov_b32 s78, 1.0
    s_mov_b32 s79, 1.0
    s_add_u32 s44, s26, 0x5500000
    s_addc_u32 s45, s27, 0
    s_and_b32 s45, s45, 0xffff
    s_mov_b32 s46, 0x8000
    s_mov_b32 s47, 0x20000
    s_add_u32 s40, s26, 0x5800000
    s_addc_u32 s41, s27, 0
    s_and_b32 s41, s41, 0xffff
    s_mov_b32 s42, 0x400000
    s_mov_b32 s43, 0x20000
    s_lshl_b32 s61, s30, 2
    s_add_u32 s61, s61, s28
    s_lshl_b32 s61, s61, 2
    s_add_u32 s61, s61, 12544
    s_mov_b32 s32, s18
    s_mov_b32 s33, s19
    s_and_b32 s33, s33, 0xffff
    s_mov_b32 s34, 0x258000
    s_mov_b32 s35, 0x20000
    v_lshrrev_b32 v1, 4, v0
    v_and_b32 v1, 1, v1
    s_and_b32 s48, s28, 1
    s_lshl_b32 s48, s48, 1
    v_or_b32 v1, s48, v1
    v_bfe_u32 v2, v0, 1, 2
    v_xor_b32 v1, v1, v2
    v_cmp_lt_u32 vcc, 1, v1
    v_mov_b32 v2, s64
    v_mov_b32 v3, s65
    v_cndmask_b32 v2, v2, v3, vcc
    v_and_b32 v1, 1, v1
    v_lshl_add_u32 v2, v1, 5, v2
    v_and_b32_e64 v1, 1, v0
    v_lshl_add_u32 v2, v1, 4, v2
    v_lshrrev_b32_e64 v1, 3, v0
    v_mul_u32_u24 v1, 3840, v1
    v_add_u32 v1, v1, v2
    s_mul_i32 s48, s28, 30720
    s_lshl_b32 s49, s28, 10
    s_mov_b32 m0, s49
    s_add_u32 s49, s49, 4096
    buffer_load_dwordx4 v1, s[32:35], s48 offen lds
    s_add_u32 s48, s48, 122880
    s_mov_b32 m0, s49
    s_add_u32 s49, s49, 4096
    buffer_load_dwordx4 v1, s[32:35], s48 offen lds
    s_add_u32 s48, s48, 122880
    s_mov_b32 m0, s49
    s_add_u32 s49, s49, 4096
    buffer_load_dwordx4 v1, s[32:35], s48 offen lds
    s_add_u32 s48, s48, 122880
    s_mov_b32 m0, s49
    s_add_u32 s49, s49, 4096
    buffer_load_dwordx4 v1, s[32:35], s48 offen lds
    s_add_u32 s48, s48, 122880
    s_mov_b32 m0, s49
    s_add_u32 s49, s49, 4096
    buffer_load_dwordx4 v1, s[32:35], s48 offen lds
    s_add_u32 s48, s48, 122880
    s_mov_b32 m0, s49
    s_add_u32 s49, s49, 4096
    buffer_load_dwordx4 v1, s[32:35], s48 offen lds
    s_add_u32 s48, s48, 122880
    s_mov_b32 m0, s49
    s_add_u32 s49, s49, 4096
    buffer_load_dwordx4 v1, s[32:35], s48 offen lds
    s_add_u32 s48, s48, 122880
    s_mov_b32 m0, s49
    s_add_u32 s49, s49, 4096
    buffer_load_dwordx4 v1, s[32:35], s48 offen lds
    s_add_u32 s48, s48, 122880
    s_mov_b32 m0, s49
    s_add_u32 s49, s49, 4096
    buffer_load_dwordx4 v1, s[32:35], s48 offen lds
    s_add_u32 s48, s48, 122880
    s_mov_b32 m0, s49
    s_add_u32 s49, s49, 4096
    buffer_load_dwordx4 v1, s[32:35], s48 offen lds
    s_add_u32 s48, s48, 122880
    s_mov_b32 m0, s49
    s_add_u32 s49, s49, 4096
    buffer_load_dwordx4 v1, s[32:35], s48 offen lds
    s_add_u32 s48, s48, 122880
    s_mov_b32 m0, s49
    s_add_u32 s49, s49, 4096
    buffer_load_dwordx4 v1, s[32:35], s48 offen lds
    s_add_u32 s48, s48, 122880
    s_mov_b32 m0, s49
    s_add_u32 s49, s49, 4096
    buffer_load_dwordx4 v1, s[32:35], s48 offen lds
    s_add_u32 s48, s48, 122880
    s_mov_b32 m0, s49
    s_add_u32 s49, s49, 4096
    buffer_load_dwordx4 v1, s[32:35], s48 offen lds
    s_add_u32 s48, s48, 122880
    s_mov_b32 m0, s49
    s_add_u32 s49, s49, 4096
    buffer_load_dwordx4 v1, s[32:35], s48 offen lds
    s_add_u32 s48, s48, 122880
    s_mov_b32 m0, s49
    s_add_u32 s49, s49, 4096
    buffer_load_dwordx4 v1, s[32:35], s48 offen lds
    s_add_u32 s48, s48, 122880
    s_mov_b32 m0, s49
    s_add_u32 s49, s49, 4096
    buffer_load_dwordx4 v1, s[32:35], s48 offen lds
    s_add_u32 s48, s48, 122880
    s_mov_b32 m0, s49
    s_add_u32 s49, s49, 4096
    buffer_load_dwordx4 v1, s[32:35], s48 offen lds
    s_add_u32 s48, s48, 122880
    s_mov_b32 m0, s49
    s_add_u32 s49, s49, 4096
    buffer_load_dwordx4 v1, s[32:35], s48 offen lds
    s_add_u32 s48, s48, 122880
    s_mov_b32 m0, s49
    s_add_u32 s49, s49, 4096
    buffer_load_dwordx4 v1, s[32:35], s48 offen lds
    s_add_u32 s48, s48, 122880
    s_mov_b32 s36, s16
    s_mov_b32 s37, s17
    s_and_b32 s37, s37, 0xffff
    s_mov_b32 s38, 0x280000
    s_mov_b32 s39, 0x20000
    v_lshrrev_b32 v73, 4, v0
    v_add_u32 v74, 0, v73
    v_and_b32 v75, 15, v0
    v_xor_b32 v75, v75, v74
    v_lshlrev_b32_e64 v75, 4, v75
    v_mul_u32_u24 v74, 1280, v74
    v_add_u32 v74, v74, v75
    v_subrev_u32 v64, 0, v74
    v_add_u32 v74, 4, v73
    v_and_b32 v75, 15, v0
    v_xor_b32 v75, v75, v74
    v_lshlrev_b32 v75, 4, v75
    v_mul_u32_u24 v74, 1280, v74
    v_add_u32_e64 v74, v74, v75
    v_subrev_u32 v65, 1024, v74
    v_add_u32 v74, 8, v73
    v_and_b32 v75, 15, v0
    v_xor_b32 v75, v75, v74
    v_lshlrev_b32 v75, 4, v75
    v_mul_u32_u24 v74, 1280, v74
    v_add_u32_e64 v74, v74, v75
    v_subrev_u32 v66, 2048, v74
    v_add_u32 v74, 12, v73
    v_and_b32 v75, 15, v0
    v_xor_b32 v75, v75, v74
    v_lshlrev_b32 v75, 4, v75
    v_mul_u32_u24 v74, 1280, v74
    v_add_u32_e64 v74, v74, v75
    v_subrev_u32 v67, 3072, v74
    v_and_b32 v74, 15, v0
    v_xor_b32 v75, v73, v74
    v_lshlrev_b32 v74, 8, v74
    s_lshl_b32 s48, s28, 13
    v_add_u32 v74, s48, v74
    v_xor_b32 v76, 0, v75
    v_lshlrev_b32 v76, 4, v76
    v_add_u32 v100, v74, v76
    v_add_u32 v104, 0x10000, v100
    v_add_u32 v108, 0x20000, v100
    v_xor_b32 v76, 4, v75
    v_lshlrev_b32 v76, 4, v76
    v_add_u32_e64 v101, v74, v76
    v_add_u32 v105, 0x10000, v101
    v_add_u32 v109, 0x20000, v101
    v_xor_b32 v76, 8, v75
    v_lshlrev_b32 v76, 4, v76
    v_add_u32_e64 v102, v74, v76
    v_add_u32 v106, 0x10000, v102
    v_add_u32 v110, 0x20000, v102
    v_xor_b32 v76, 12, v75
    v_lshlrev_b32 v76, 4, v76
    v_add_u32_e64 v103, v74, v76
    v_add_u32 v107, 0x10000, v103
    v_add_u32 v111, 0x20000, v103
    v_lshlrev_b32 v72, 4, v0
    s_mul_i32 s59, s28, 40960
    s_mov_b32 s63, 15
    s_lshl_b32 s48, s28, 13
    s_add_u32 m0, s48, 98304
    s_add_u32 s49, s59, 0
    buffer_load_dwordx4 v64, s[36:39], s49 offen offset:0 lds
    buffer_load_dwordx4 v65, s[36:39], s49 offen offset:1024 lds
    buffer_load_dwordx4 v66, s[36:39], s49 offen offset:2048 lds
    buffer_load_dwordx4 v67, s[36:39], s49 offen offset:3072 lds
    s_lshl_b32 s48, s28, 13
    s_add_u32 m0, s48, 102400
    s_add_u32 s49, s59, 20480
    buffer_load_dwordx4 v64, s[36:39], s49 offen offset:0 lds
    buffer_load_dwordx4 v65, s[36:39], s49 offen offset:1024 lds
    buffer_load_dwordx4 v66, s[36:39], s49 offen offset:2048 lds
    buffer_load_dwordx4 v67, s[36:39], s49 offen offset:3072 lds
    s_lshl_b32 s48, s28, 13
    s_add_u32 m0, s48, 131072
    s_add_u32 s49, s59, 256
    buffer_load_dwordx4 v64, s[36:39], s49 offen offset:0 lds
    buffer_load_dwordx4 v65, s[36:39], s49 offen offset:1024 lds
    buffer_load_dwordx4 v66, s[36:39], s49 offen offset:2048 lds
    buffer_load_dwordx4 v67, s[36:39], s49 offen offset:3072 lds
    s_lshl_b32 s48, s28, 13
    s_add_u32 m0, s48, 135168
    s_add_u32 s49, s59, 20736
    buffer_load_dwordx4 v64, s[36:39], s49 offen offset:0 lds
    buffer_load_dwordx4 v65, s[36:39], s49 offen offset:1024 lds
    buffer_load_dwordx4 v66, s[36:39], s49 offen offset:2048 lds
    buffer_load_dwordx4 v67, s[36:39], s49 offen offset:3072 lds
    s_waitcnt vmcnt(16)
    s_barrier
    v_and_b32 v82, 3, v0
    v_lshlrev_b32_e64 v82, 3, v82
    v_bfe_u32 v81, v0, 3, 2
    s_lshl_b32 s48, s66, 3
    s_add_u32 s48, s48, 0
    v_add_u32 v80, s48, v82
    v_lshrrev_b32 v76, 5, v80
    v_add_u32 v76, 0, v76
    v_xor_b32 v76, v76, v81
    v_lshlrev_b32 v76, 5, v76
    v_and_b32 v80, 31, v80
    v_add_u32 v76, v76, v80
    s_lshl_b32 s48, s66, 3
    s_add_u32 s48, s48, 32
    v_add_u32 v80, s48, v82
    v_lshrrev_b32 v77, 5, v80
    v_add_u32 v77, 0, v77
    v_xor_b32 v77, v77, v81
    v_lshlrev_b32 v77, 5, v77
    v_and_b32 v80, 31, v80
    v_add_u32 v77, v77, v80
    s_lshl_b32 s48, s67, 3
    s_add_u32 s48, s48, 0
    v_add_u32 v80, s48, v82
    v_lshrrev_b32 v78, 5, v80
    v_add_u32 v78, 2, v78
    v_xor_b32 v78, v78, v81
    v_lshlrev_b32 v78, 5, v78
    v_and_b32 v80, 31, v80
    v_add_u32 v78, v78, v80
    s_lshl_b32 s48, s67, 3
    s_add_u32 s48, s48, 32
    v_add_u32 v80, s48, v82
    v_lshrrev_b32 v79, 5, v80
    v_add_u32 v79, 2, v79
    v_xor_b32 v79, v79, v81
    v_lshlrev_b32 v79, 5, v79
    v_and_b32 v80, 31, v80
    v_add_u32 v79, v79, v80
    v_lshrrev_b32 v80, 4, v0
    v_lshlrev_b32 v80, 3, v80
    v_bfe_u32 v81, v0, 2, 2
    v_add_u32 v80, v80, v81
    v_lshlrev_b32 v80, 7, v80
    v_add_u32 v76, v76, v80
    v_add_u32 v77, v77, v80
    v_add_u32 v78, v78, v80
    v_add_u32 v79, v79, v80
    v_and_b32_e64 v80, 15, v0
    v_cmp_gt_u32 s[68:69], 4, v80
    ds_read_b64_tr_b16 a[0:1], v76 offset:0
    ds_read_b64_tr_b16 a[2:3], v76 offset:512
    ds_read_b64_tr_b16 v[84:85], v77 offset:0
    ds_read_b64_tr_b16 v[86:87], v77 offset:512
    ds_read_b64_tr_b16 a[160:161], v78 offset:0
    ds_read_b64_tr_b16 a[162:163], v78 offset:512
    ds_read_b64_tr_b16 v[88:89], v79 offset:0
    ds_read_b64_tr_b16 v[90:91], v79 offset:512
    s_waitcnt lgkmcnt(0)
    s_nop 0
    v_cndmask_b32 v84, 0, v84, s[68:69]
    v_cndmask_b32 v85, 0, v85, s[68:69]
    v_cndmask_b32 v86, 0, v86, s[68:69]
    v_cndmask_b32 v87, 0, v87, s[68:69]
    v_accvgpr_write_b32 a80, v84
    v_accvgpr_write_b32 a81, v85
    v_accvgpr_write_b32 a82, v86
    v_accvgpr_write_b32 a83, v87
    v_cndmask_b32 v88, 0, v88, s[68:69]
    v_cndmask_b32 v89, 0, v89, s[68:69]
    v_cndmask_b32 v90, 0, v90, s[68:69]
    v_cndmask_b32 v91, 0, v91, s[68:69]
    v_accvgpr_write_b32 a240, v88
    v_accvgpr_write_b32 a241, v89
    v_accvgpr_write_b32 a242, v90
    v_accvgpr_write_b32 a243, v91
    ds_read_b64_tr_b16 a[4:5], v76 offset:4096
    ds_read_b64_tr_b16 a[6:7], v76 offset:4608
    ds_read_b64_tr_b16 v[84:85], v77 offset:4096
    ds_read_b64_tr_b16 v[86:87], v77 offset:4608
    ds_read_b64_tr_b16 a[164:165], v78 offset:4096
    ds_read_b64_tr_b16 a[166:167], v78 offset:4608
    ds_read_b64_tr_b16 v[88:89], v79 offset:4096
    ds_read_b64_tr_b16 v[90:91], v79 offset:4608
    s_waitcnt lgkmcnt(0)
    s_nop 0
    v_cndmask_b32 v84, 0, v84, s[68:69]
    v_cndmask_b32 v85, 0, v85, s[68:69]
    v_cndmask_b32 v86, 0, v86, s[68:69]
    v_cndmask_b32 v87, 0, v87, s[68:69]
    v_accvgpr_write_b32 a84, v84
    v_accvgpr_write_b32 a85, v85
    v_accvgpr_write_b32 a86, v86
    v_accvgpr_write_b32 a87, v87
    v_cndmask_b32 v88, 0, v88, s[68:69]
    v_cndmask_b32 v89, 0, v89, s[68:69]
    v_cndmask_b32 v90, 0, v90, s[68:69]
    v_cndmask_b32 v91, 0, v91, s[68:69]
    v_accvgpr_write_b32 a244, v88
    v_accvgpr_write_b32 a245, v89
    v_accvgpr_write_b32 a246, v90
    v_accvgpr_write_b32 a247, v91
    ds_read_b64_tr_b16 a[8:9], v76 offset:8192
    ds_read_b64_tr_b16 a[10:11], v76 offset:8704
    ds_read_b64_tr_b16 v[84:85], v77 offset:8192
    ds_read_b64_tr_b16 v[86:87], v77 offset:8704
    ds_read_b64_tr_b16 a[168:169], v78 offset:8192
    ds_read_b64_tr_b16 a[170:171], v78 offset:8704
    ds_read_b64_tr_b16 v[88:89], v79 offset:8192
    ds_read_b64_tr_b16 v[90:91], v79 offset:8704
    s_waitcnt lgkmcnt(0)
    s_nop 0
    v_cndmask_b32 v84, 0, v84, s[68:69]
    v_cndmask_b32 v85, 0, v85, s[68:69]
    v_cndmask_b32 v86, 0, v86, s[68:69]
    v_cndmask_b32 v87, 0, v87, s[68:69]
    v_accvgpr_write_b32 a88, v84
    v_accvgpr_write_b32 a89, v85
    v_accvgpr_write_b32 a90, v86
    v_accvgpr_write_b32 a91, v87
    v_cndmask_b32 v88, 0, v88, s[68:69]
    v_cndmask_b32 v89, 0, v89, s[68:69]
    v_cndmask_b32 v90, 0, v90, s[68:69]
    v_cndmask_b32 v91, 0, v91, s[68:69]
    v_accvgpr_write_b32 a248, v88
    v_accvgpr_write_b32 a249, v89
    v_accvgpr_write_b32 a250, v90
    v_accvgpr_write_b32 a251, v91
    ds_read_b64_tr_b16 a[12:13], v76 offset:12288
    ds_read_b64_tr_b16 a[14:15], v76 offset:12800
    ds_read_b64_tr_b16 v[84:85], v77 offset:12288
    ds_read_b64_tr_b16 v[86:87], v77 offset:12800
    ds_read_b64_tr_b16 a[172:173], v78 offset:12288
    ds_read_b64_tr_b16 a[174:175], v78 offset:12800
    ds_read_b64_tr_b16 v[88:89], v79 offset:12288
    ds_read_b64_tr_b16 v[90:91], v79 offset:12800
    s_waitcnt lgkmcnt(0)
    s_nop 0
    v_cndmask_b32 v84, 0, v84, s[68:69]
    v_cndmask_b32 v85, 0, v85, s[68:69]
    v_cndmask_b32 v86, 0, v86, s[68:69]
    v_cndmask_b32 v87, 0, v87, s[68:69]
    v_accvgpr_write_b32 a92, v84
    v_accvgpr_write_b32 a93, v85
    v_accvgpr_write_b32 a94, v86
    v_accvgpr_write_b32 a95, v87
    v_cndmask_b32 v88, 0, v88, s[68:69]
    v_cndmask_b32 v89, 0, v89, s[68:69]
    v_cndmask_b32 v90, 0, v90, s[68:69]
    v_cndmask_b32 v91, 0, v91, s[68:69]
    v_accvgpr_write_b32 a252, v88
    v_accvgpr_write_b32 a253, v89
    v_accvgpr_write_b32 a254, v90
    v_accvgpr_write_b32 a255, v91
    ds_read_b64_tr_b16 a[16:17], v76 offset:16384
    ds_read_b64_tr_b16 a[18:19], v76 offset:16896
    ds_read_b64_tr_b16 v[84:85], v77 offset:16384
    ds_read_b64_tr_b16 v[86:87], v77 offset:16896
    ds_read_b64_tr_b16 a[176:177], v78 offset:16384
    ds_read_b64_tr_b16 a[178:179], v78 offset:16896
    ds_read_b64_tr_b16 v[88:89], v79 offset:16384
    ds_read_b64_tr_b16 v[90:91], v79 offset:16896
    s_waitcnt lgkmcnt(0)
    s_nop 0
    v_cndmask_b32 v84, 0, v84, s[68:69]
    v_cndmask_b32 v85, 0, v85, s[68:69]
    v_cndmask_b32 v86, 0, v86, s[68:69]
    v_cndmask_b32 v87, 0, v87, s[68:69]
    v_accvgpr_write_b32 a96, v84
    v_accvgpr_write_b32 a97, v85
    v_accvgpr_write_b32 a98, v86
    v_accvgpr_write_b32 a99, v87
    v_cndmask_b32 v88, 0, v88, s[68:69]
    v_cndmask_b32 v89, 0, v89, s[68:69]
    v_cndmask_b32 v90, 0, v90, s[68:69]
    v_cndmask_b32 v91, 0, v91, s[68:69]
    v_mov_b32 v192, v88
    v_mov_b32 v193, v89
    v_mov_b32 v194, v90
    v_mov_b32 v195, v91
    ds_read_b64_tr_b16 a[20:21], v76 offset:20480
    ds_read_b64_tr_b16 a[22:23], v76 offset:20992
    ds_read_b64_tr_b16 v[84:85], v77 offset:20480
    ds_read_b64_tr_b16 v[86:87], v77 offset:20992
    ds_read_b64_tr_b16 a[180:181], v78 offset:20480
    ds_read_b64_tr_b16 a[182:183], v78 offset:20992
    ds_read_b64_tr_b16 v[88:89], v79 offset:20480
    ds_read_b64_tr_b16 v[90:91], v79 offset:20992
    s_waitcnt lgkmcnt(0)
    s_nop 0
    v_cndmask_b32 v84, 0, v84, s[68:69]
    v_cndmask_b32 v85, 0, v85, s[68:69]
    v_cndmask_b32 v86, 0, v86, s[68:69]
    v_cndmask_b32 v87, 0, v87, s[68:69]
    v_accvgpr_write_b32 a100, v84
    v_accvgpr_write_b32 a101, v85
    v_accvgpr_write_b32 a102, v86
    v_accvgpr_write_b32 a103, v87
    v_cndmask_b32 v88, 0, v88, s[68:69]
    v_cndmask_b32 v89, 0, v89, s[68:69]
    v_cndmask_b32 v90, 0, v90, s[68:69]
    v_cndmask_b32 v91, 0, v91, s[68:69]
    v_mov_b32 v196, v88
    v_mov_b32 v197, v89
    v_mov_b32 v198, v90
    v_mov_b32 v199, v91
    ds_read_b64_tr_b16 a[24:25], v76 offset:24576
    ds_read_b64_tr_b16 a[26:27], v76 offset:25088
    ds_read_b64_tr_b16 v[84:85], v77 offset:24576
    ds_read_b64_tr_b16 v[86:87], v77 offset:25088
    ds_read_b64_tr_b16 a[184:185], v78 offset:24576
    ds_read_b64_tr_b16 a[186:187], v78 offset:25088
    ds_read_b64_tr_b16 v[88:89], v79 offset:24576
    ds_read_b64_tr_b16 v[90:91], v79 offset:25088
    s_waitcnt lgkmcnt(0)
    s_nop 0
    v_cndmask_b32 v84, 0, v84, s[68:69]
    v_cndmask_b32 v85, 0, v85, s[68:69]
    v_cndmask_b32 v86, 0, v86, s[68:69]
    v_cndmask_b32 v87, 0, v87, s[68:69]
    v_accvgpr_write_b32 a104, v84
    v_accvgpr_write_b32 a105, v85
    v_accvgpr_write_b32 a106, v86
    v_accvgpr_write_b32 a107, v87
    v_cndmask_b32 v88, 0, v88, s[68:69]
    v_cndmask_b32 v89, 0, v89, s[68:69]
    v_cndmask_b32 v90, 0, v90, s[68:69]
    v_cndmask_b32 v91, 0, v91, s[68:69]
    v_mov_b32 v200, v88
    v_mov_b32 v201, v89
    v_mov_b32 v202, v90
    v_mov_b32 v203, v91
    ds_read_b64_tr_b16 a[28:29], v76 offset:28672
    ds_read_b64_tr_b16 a[30:31], v76 offset:29184
    ds_read_b64_tr_b16 v[84:85], v77 offset:28672
    ds_read_b64_tr_b16 v[86:87], v77 offset:29184
    ds_read_b64_tr_b16 a[188:189], v78 offset:28672
    ds_read_b64_tr_b16 a[190:191], v78 offset:29184
    ds_read_b64_tr_b16 v[88:89], v79 offset:28672
    ds_read_b64_tr_b16 v[90:91], v79 offset:29184
    s_waitcnt lgkmcnt(0)
    s_nop 0
    v_cndmask_b32 v84, 0, v84, s[68:69]
    v_cndmask_b32 v85, 0, v85, s[68:69]
    v_cndmask_b32 v86, 0, v86, s[68:69]
    v_cndmask_b32 v87, 0, v87, s[68:69]
    v_accvgpr_write_b32 a108, v84
    v_accvgpr_write_b32 a109, v85
    v_accvgpr_write_b32 a110, v86
    v_accvgpr_write_b32 a111, v87
    v_cndmask_b32 v88, 0, v88, s[68:69]
    v_cndmask_b32 v89, 0, v89, s[68:69]
    v_cndmask_b32 v90, 0, v90, s[68:69]
    v_cndmask_b32 v91, 0, v91, s[68:69]
    v_mov_b32 v204, v88
    v_mov_b32 v205, v89
    v_mov_b32 v206, v90
    v_mov_b32 v207, v91
    ds_read_b64_tr_b16 a[32:33], v76 offset:32768
    ds_read_b64_tr_b16 a[34:35], v76 offset:33280
    ds_read_b64_tr_b16 v[84:85], v77 offset:32768
    ds_read_b64_tr_b16 v[86:87], v77 offset:33280
    ds_read_b64_tr_b16 a[192:193], v78 offset:32768
    ds_read_b64_tr_b16 a[194:195], v78 offset:33280
    ds_read_b64_tr_b16 v[88:89], v79 offset:32768
    ds_read_b64_tr_b16 v[90:91], v79 offset:33280
    s_waitcnt lgkmcnt(0)
    s_nop 0
    v_cndmask_b32 v84, 0, v84, s[68:69]
    v_cndmask_b32 v85, 0, v85, s[68:69]
    v_cndmask_b32 v86, 0, v86, s[68:69]
    v_cndmask_b32 v87, 0, v87, s[68:69]
    v_accvgpr_write_b32 a112, v84
    v_accvgpr_write_b32 a113, v85
    v_accvgpr_write_b32 a114, v86
    v_accvgpr_write_b32 a115, v87
    v_cndmask_b32 v88, 0, v88, s[68:69]
    v_cndmask_b32 v89, 0, v89, s[68:69]
    v_cndmask_b32 v90, 0, v90, s[68:69]
    v_cndmask_b32 v91, 0, v91, s[68:69]
    v_mov_b32 v208, v88
    v_mov_b32 v209, v89
    v_mov_b32 v210, v90
    v_mov_b32 v211, v91
    ds_read_b64_tr_b16 a[36:37], v76 offset:36864
    ds_read_b64_tr_b16 a[38:39], v76 offset:37376
    ds_read_b64_tr_b16 v[84:85], v77 offset:36864
    ds_read_b64_tr_b16 v[86:87], v77 offset:37376
    ds_read_b64_tr_b16 a[196:197], v78 offset:36864
    ds_read_b64_tr_b16 a[198:199], v78 offset:37376
    ds_read_b64_tr_b16 v[88:89], v79 offset:36864
    ds_read_b64_tr_b16 v[90:91], v79 offset:37376
    s_waitcnt lgkmcnt(0)
    s_nop 0
    v_cndmask_b32 v84, 0, v84, s[68:69]
    v_cndmask_b32 v85, 0, v85, s[68:69]
    v_cndmask_b32 v86, 0, v86, s[68:69]
    v_cndmask_b32 v87, 0, v87, s[68:69]
    v_accvgpr_write_b32 a116, v84
    v_accvgpr_write_b32 a117, v85
    v_accvgpr_write_b32 a118, v86
    v_accvgpr_write_b32 a119, v87
    v_cndmask_b32 v88, 0, v88, s[68:69]
    v_cndmask_b32 v89, 0, v89, s[68:69]
    v_cndmask_b32 v90, 0, v90, s[68:69]
    v_cndmask_b32 v91, 0, v91, s[68:69]
    v_mov_b32 v212, v88
    v_mov_b32 v213, v89
    v_mov_b32 v214, v90
    v_mov_b32 v215, v91
    v_add_u32 v76, 40960, v76
    v_add_u32 v77, 40960, v77
    v_add_u32 v78, 40960, v78
    v_add_u32 v79, 40960, v79
    ds_read_b64_tr_b16 a[40:41], v76 offset:0
    ds_read_b64_tr_b16 a[42:43], v76 offset:512
    ds_read_b64_tr_b16 v[84:85], v77 offset:0
    ds_read_b64_tr_b16 v[86:87], v77 offset:512
    ds_read_b64_tr_b16 a[200:201], v78 offset:0
    ds_read_b64_tr_b16 a[202:203], v78 offset:512
    ds_read_b64_tr_b16 v[88:89], v79 offset:0
    ds_read_b64_tr_b16 v[90:91], v79 offset:512
    s_waitcnt lgkmcnt(0)
    s_nop 0
    v_cndmask_b32 v84, 0, v84, s[68:69]
    v_cndmask_b32 v85, 0, v85, s[68:69]
    v_cndmask_b32 v86, 0, v86, s[68:69]
    v_cndmask_b32 v87, 0, v87, s[68:69]
    v_accvgpr_write_b32 a120, v84
    v_accvgpr_write_b32 a121, v85
    v_accvgpr_write_b32 a122, v86
    v_accvgpr_write_b32 a123, v87
    v_cndmask_b32 v88, 0, v88, s[68:69]
    v_cndmask_b32 v89, 0, v89, s[68:69]
    v_cndmask_b32 v90, 0, v90, s[68:69]
    v_cndmask_b32 v91, 0, v91, s[68:69]
    v_mov_b32 v216, v88
    v_mov_b32 v217, v89
    v_mov_b32 v218, v90
    v_mov_b32 v219, v91
    ds_read_b64_tr_b16 a[44:45], v76 offset:4096
    ds_read_b64_tr_b16 a[46:47], v76 offset:4608
    ds_read_b64_tr_b16 v[84:85], v77 offset:4096
    ds_read_b64_tr_b16 v[86:87], v77 offset:4608
    ds_read_b64_tr_b16 a[204:205], v78 offset:4096
    ds_read_b64_tr_b16 a[206:207], v78 offset:4608
    ds_read_b64_tr_b16 v[88:89], v79 offset:4096
    ds_read_b64_tr_b16 v[90:91], v79 offset:4608
    s_waitcnt lgkmcnt(0)
    s_nop 0
    v_cndmask_b32 v84, 0, v84, s[68:69]
    v_cndmask_b32 v85, 0, v85, s[68:69]
    v_cndmask_b32 v86, 0, v86, s[68:69]
    v_cndmask_b32 v87, 0, v87, s[68:69]
    v_accvgpr_write_b32 a124, v84
    v_accvgpr_write_b32 a125, v85
    v_accvgpr_write_b32 a126, v86
    v_accvgpr_write_b32 a127, v87
    v_cndmask_b32 v88, 0, v88, s[68:69]
    v_cndmask_b32 v89, 0, v89, s[68:69]
    v_cndmask_b32 v90, 0, v90, s[68:69]
    v_cndmask_b32 v91, 0, v91, s[68:69]
    v_mov_b32 v220, v88
    v_mov_b32 v221, v89
    v_mov_b32 v222, v90
    v_mov_b32 v223, v91
    ds_read_b64_tr_b16 a[48:49], v76 offset:8192
    ds_read_b64_tr_b16 a[50:51], v76 offset:8704
    ds_read_b64_tr_b16 v[84:85], v77 offset:8192
    ds_read_b64_tr_b16 v[86:87], v77 offset:8704
    ds_read_b64_tr_b16 a[208:209], v78 offset:8192
    ds_read_b64_tr_b16 a[210:211], v78 offset:8704
    ds_read_b64_tr_b16 v[88:89], v79 offset:8192
    ds_read_b64_tr_b16 v[90:91], v79 offset:8704
    s_waitcnt lgkmcnt(0)
    s_nop 0
    v_cndmask_b32 v84, 0, v84, s[68:69]
    v_cndmask_b32 v85, 0, v85, s[68:69]
    v_cndmask_b32 v86, 0, v86, s[68:69]
    v_cndmask_b32 v87, 0, v87, s[68:69]
    v_accvgpr_write_b32 a128, v84
    v_accvgpr_write_b32 a129, v85
    v_accvgpr_write_b32 a130, v86
    v_accvgpr_write_b32 a131, v87
    v_cndmask_b32 v88, 0, v88, s[68:69]
    v_cndmask_b32 v89, 0, v89, s[68:69]
    v_cndmask_b32 v90, 0, v90, s[68:69]
    v_cndmask_b32 v91, 0, v91, s[68:69]
    v_mov_b32 v224, v88
    v_mov_b32 v225, v89
    v_mov_b32 v226, v90
    v_mov_b32 v227, v91
    ds_read_b64_tr_b16 a[52:53], v76 offset:12288
    ds_read_b64_tr_b16 a[54:55], v76 offset:12800
    ds_read_b64_tr_b16 v[84:85], v77 offset:12288
    ds_read_b64_tr_b16 v[86:87], v77 offset:12800
    ds_read_b64_tr_b16 a[212:213], v78 offset:12288
    ds_read_b64_tr_b16 a[214:215], v78 offset:12800
    ds_read_b64_tr_b16 v[88:89], v79 offset:12288
    ds_read_b64_tr_b16 v[90:91], v79 offset:12800
    s_waitcnt lgkmcnt(0)
    s_nop 0
    v_cndmask_b32 v84, 0, v84, s[68:69]
    v_cndmask_b32 v85, 0, v85, s[68:69]
    v_cndmask_b32 v86, 0, v86, s[68:69]
    v_cndmask_b32 v87, 0, v87, s[68:69]
    v_accvgpr_write_b32 a132, v84
    v_accvgpr_write_b32 a133, v85
    v_accvgpr_write_b32 a134, v86
    v_accvgpr_write_b32 a135, v87
    v_cndmask_b32 v88, 0, v88, s[68:69]
    v_cndmask_b32 v89, 0, v89, s[68:69]
    v_cndmask_b32 v90, 0, v90, s[68:69]
    v_cndmask_b32 v91, 0, v91, s[68:69]
    v_mov_b32 v228, v88
    v_mov_b32 v229, v89
    v_mov_b32 v230, v90
    v_mov_b32 v231, v91
    ds_read_b64_tr_b16 a[56:57], v76 offset:16384
    ds_read_b64_tr_b16 a[58:59], v76 offset:16896
    ds_read_b64_tr_b16 v[84:85], v77 offset:16384
    ds_read_b64_tr_b16 v[86:87], v77 offset:16896
    ds_read_b64_tr_b16 a[216:217], v78 offset:16384
    ds_read_b64_tr_b16 a[218:219], v78 offset:16896
    ds_read_b64_tr_b16 v[88:89], v79 offset:16384
    ds_read_b64_tr_b16 v[90:91], v79 offset:16896
    s_waitcnt lgkmcnt(0)
    s_nop 0
    v_cndmask_b32 v84, 0, v84, s[68:69]
    v_cndmask_b32 v85, 0, v85, s[68:69]
    v_cndmask_b32 v86, 0, v86, s[68:69]
    v_cndmask_b32 v87, 0, v87, s[68:69]
    v_accvgpr_write_b32 a136, v84
    v_accvgpr_write_b32 a137, v85
    v_accvgpr_write_b32 a138, v86
    v_accvgpr_write_b32 a139, v87
    v_cndmask_b32 v88, 0, v88, s[68:69]
    v_cndmask_b32 v89, 0, v89, s[68:69]
    v_cndmask_b32 v90, 0, v90, s[68:69]
    v_cndmask_b32 v91, 0, v91, s[68:69]
    v_mov_b32 v232, v88
    v_mov_b32 v233, v89
    v_mov_b32 v234, v90
    v_mov_b32 v235, v91
    ds_read_b64_tr_b16 a[60:61], v76 offset:20480
    ds_read_b64_tr_b16 a[62:63], v76 offset:20992
    ds_read_b64_tr_b16 v[84:85], v77 offset:20480
    ds_read_b64_tr_b16 v[86:87], v77 offset:20992
    ds_read_b64_tr_b16 a[220:221], v78 offset:20480
    ds_read_b64_tr_b16 a[222:223], v78 offset:20992
    ds_read_b64_tr_b16 v[88:89], v79 offset:20480
    ds_read_b64_tr_b16 v[90:91], v79 offset:20992
    s_waitcnt lgkmcnt(0)
    s_nop 0
    v_cndmask_b32 v84, 0, v84, s[68:69]
    v_cndmask_b32 v85, 0, v85, s[68:69]
    v_cndmask_b32 v86, 0, v86, s[68:69]
    v_cndmask_b32 v87, 0, v87, s[68:69]
    v_accvgpr_write_b32 a140, v84
    v_accvgpr_write_b32 a141, v85
    v_accvgpr_write_b32 a142, v86
    v_accvgpr_write_b32 a143, v87
    v_cndmask_b32 v88, 0, v88, s[68:69]
    v_cndmask_b32 v89, 0, v89, s[68:69]
    v_cndmask_b32 v90, 0, v90, s[68:69]
    v_cndmask_b32 v91, 0, v91, s[68:69]
    v_mov_b32 v236, v88
    v_mov_b32 v237, v89
    v_mov_b32 v238, v90
    v_mov_b32 v239, v91
    ds_read_b64_tr_b16 a[64:65], v76 offset:24576
    ds_read_b64_tr_b16 a[66:67], v76 offset:25088
    ds_read_b64_tr_b16 v[84:85], v77 offset:24576
    ds_read_b64_tr_b16 v[86:87], v77 offset:25088
    ds_read_b64_tr_b16 a[224:225], v78 offset:24576
    ds_read_b64_tr_b16 a[226:227], v78 offset:25088
    ds_read_b64_tr_b16 v[88:89], v79 offset:24576
    ds_read_b64_tr_b16 v[90:91], v79 offset:25088
    s_waitcnt lgkmcnt(0)
    s_nop 0
    v_cndmask_b32 v84, 0, v84, s[68:69]
    v_cndmask_b32 v85, 0, v85, s[68:69]
    v_cndmask_b32 v86, 0, v86, s[68:69]
    v_cndmask_b32 v87, 0, v87, s[68:69]
    v_accvgpr_write_b32 a144, v84
    v_accvgpr_write_b32 a145, v85
    v_accvgpr_write_b32 a146, v86
    v_accvgpr_write_b32 a147, v87
    v_cndmask_b32 v88, 0, v88, s[68:69]
    v_cndmask_b32 v89, 0, v89, s[68:69]
    v_cndmask_b32 v90, 0, v90, s[68:69]
    v_cndmask_b32 v91, 0, v91, s[68:69]
    v_mov_b32 v240, v88
    v_mov_b32 v241, v89
    v_mov_b32 v242, v90
    v_mov_b32 v243, v91
    ds_read_b64_tr_b16 a[68:69], v76 offset:28672
    ds_read_b64_tr_b16 a[70:71], v76 offset:29184
    ds_read_b64_tr_b16 v[84:85], v77 offset:28672
    ds_read_b64_tr_b16 v[86:87], v77 offset:29184
    ds_read_b64_tr_b16 a[228:229], v78 offset:28672
    ds_read_b64_tr_b16 a[230:231], v78 offset:29184
    ds_read_b64_tr_b16 v[88:89], v79 offset:28672
    ds_read_b64_tr_b16 v[90:91], v79 offset:29184
    s_waitcnt lgkmcnt(0)
    s_nop 0
    v_cndmask_b32 v84, 0, v84, s[68:69]
    v_cndmask_b32 v85, 0, v85, s[68:69]
    v_cndmask_b32 v86, 0, v86, s[68:69]
    v_cndmask_b32 v87, 0, v87, s[68:69]
    v_accvgpr_write_b32 a148, v84
    v_accvgpr_write_b32 a149, v85
    v_accvgpr_write_b32 a150, v86
    v_accvgpr_write_b32 a151, v87
    v_cndmask_b32 v88, 0, v88, s[68:69]
    v_cndmask_b32 v89, 0, v89, s[68:69]
    v_cndmask_b32 v90, 0, v90, s[68:69]
    v_cndmask_b32 v91, 0, v91, s[68:69]
    v_mov_b32 v244, v88
    v_mov_b32 v245, v89
    v_mov_b32 v246, v90
    v_mov_b32 v247, v91
    ds_read_b64_tr_b16 a[72:73], v76 offset:32768
    ds_read_b64_tr_b16 a[74:75], v76 offset:33280
    ds_read_b64_tr_b16 v[84:85], v77 offset:32768
    ds_read_b64_tr_b16 v[86:87], v77 offset:33280
    ds_read_b64_tr_b16 a[232:233], v78 offset:32768
    ds_read_b64_tr_b16 a[234:235], v78 offset:33280
    ds_read_b64_tr_b16 v[88:89], v79 offset:32768
    ds_read_b64_tr_b16 v[90:91], v79 offset:33280
    s_waitcnt lgkmcnt(0)
    s_nop 0
    v_cndmask_b32 v84, 0, v84, s[68:69]
    v_cndmask_b32 v85, 0, v85, s[68:69]
    v_cndmask_b32 v86, 0, v86, s[68:69]
    v_cndmask_b32 v87, 0, v87, s[68:69]
    v_accvgpr_write_b32 a152, v84
    v_accvgpr_write_b32 a153, v85
    v_accvgpr_write_b32 a154, v86
    v_accvgpr_write_b32 a155, v87
    v_cndmask_b32 v88, 0, v88, s[68:69]
    v_cndmask_b32 v89, 0, v89, s[68:69]
    v_cndmask_b32 v90, 0, v90, s[68:69]
    v_cndmask_b32 v91, 0, v91, s[68:69]
    v_mov_b32 v248, v88
    v_mov_b32 v249, v89
    v_mov_b32 v250, v90
    v_mov_b32 v251, v91
    ds_read_b64_tr_b16 a[76:77], v76 offset:36864
    ds_read_b64_tr_b16 a[78:79], v76 offset:37376
    ds_read_b64_tr_b16 v[84:85], v77 offset:36864
    ds_read_b64_tr_b16 v[86:87], v77 offset:37376
    ds_read_b64_tr_b16 a[236:237], v78 offset:36864
    ds_read_b64_tr_b16 a[238:239], v78 offset:37376
    ds_read_b64_tr_b16 v[88:89], v79 offset:36864
    ds_read_b64_tr_b16 v[90:91], v79 offset:37376
    s_waitcnt lgkmcnt(0)
    s_nop 0
    v_cndmask_b32 v84, 0, v84, s[68:69]
    v_cndmask_b32 v85, 0, v85, s[68:69]
    v_cndmask_b32 v86, 0, v86, s[68:69]
    v_cndmask_b32 v87, 0, v87, s[68:69]
    v_accvgpr_write_b32 a156, v84
    v_accvgpr_write_b32 a157, v85
    v_accvgpr_write_b32 a158, v86
    v_accvgpr_write_b32 a159, v87
    v_cndmask_b32 v88, 0, v88, s[68:69]
    v_cndmask_b32 v89, 0, v89, s[68:69]
    v_cndmask_b32 v90, 0, v90, s[68:69]
    v_cndmask_b32 v91, 0, v91, s[68:69]
    v_mov_b32 v252, v88
    v_mov_b32 v253, v89
    v_mov_b32 v254, v90
    v_mov_b32 v255, v91
    s_waitcnt lgkmcnt(0)
    s_barrier
    s_lshl_b32 s48, s28, 13
    s_add_u32 m0, s48, 0
    s_add_u32 s49, s59, 512
    buffer_load_dwordx4 v64, s[36:39], s49 offen offset:0 lds
    buffer_load_dwordx4 v65, s[36:39], s49 offen offset:1024 lds
    buffer_load_dwordx4 v66, s[36:39], s49 offen offset:2048 lds
    buffer_load_dwordx4 v67, s[36:39], s49 offen offset:3072 lds
    s_lshl_b32 s48, s28, 13
    s_add_u32 m0, s48, 4096
    s_add_u32 s49, s59, 20992
    buffer_load_dwordx4 v64, s[36:39], s49 offen offset:0 lds
    buffer_load_dwordx4 v65, s[36:39], s49 offen offset:1024 lds
    buffer_load_dwordx4 v66, s[36:39], s49 offen offset:2048 lds
    buffer_load_dwordx4 v67, s[36:39], s49 offen offset:3072 lds
    s_lshl_b32 s48, s28, 13
    s_add_u32 m0, s48, 32768
    s_add_u32 s49, s59, 768
    buffer_load_dwordx4 v64, s[36:39], s49 offen offset:0 lds
    buffer_load_dwordx4 v65, s[36:39], s49 offen offset:1024 lds
    buffer_load_dwordx4 v66, s[36:39], s49 offen offset:2048 lds
    buffer_load_dwordx4 v67, s[36:39], s49 offen offset:3072 lds
    s_lshl_b32 s48, s28, 13
    s_add_u32 m0, s48, 36864
    s_add_u32 s49, s59, 21248
    buffer_load_dwordx4 v64, s[36:39], s49 offen offset:0 lds
    buffer_load_dwordx4 v65, s[36:39], s49 offen offset:1024 lds
    buffer_load_dwordx4 v66, s[36:39], s49 offen offset:2048 lds
    buffer_load_dwordx4 v67, s[36:39], s49 offen offset:3072 lds
    s_lshl_b32 s48, s28, 13
    s_add_u32 m0, s48, 65536
    s_add_u32 s49, s59, 1024
    buffer_load_dwordx4 v64, s[36:39], s49 offen offset:0 lds
    buffer_load_dwordx4 v65, s[36:39], s49 offen offset:1024 lds
    buffer_load_dwordx4 v66, s[36:39], s49 offen offset:2048 lds
    buffer_load_dwordx4 v67, s[36:39], s49 offen offset:3072 lds
    s_lshl_b32 s48, s28, 13
    s_add_u32 m0, s48, 69632
    s_add_u32 s49, s59, 21504
    buffer_load_dwordx4 v64, s[36:39], s49 offen offset:0 lds
    buffer_load_dwordx4 v65, s[36:39], s49 offen offset:1024 lds
    buffer_load_dwordx4 v66, s[36:39], s49 offen offset:2048 lds
    buffer_load_dwordx4 v67, s[36:39], s49 offen offset:3072 lds
    s_mov_b32 s60, 0
    s_waitcnt vmcnt(0)
    s_lshl_b32 s58, s28, 16
    s_lshl_b32 s48, s30, 11
    s_add_u32 s58, s58, s48
wsg_loop_55:
    s_add_u32 s52, s59, 163840
    s_cmp_eq_u32 s60, s63
    s_cselect_b32 s52, s59, s52
    s_waitcnt vmcnt(36)
    ds_read_b128 v[36:39], v104 offset:32768
    ds_read_b128 v[40:43], v104 offset:36864
    ds_read_b128 v[44:47], v105 offset:32768
    ds_read_b128 v[48:51], v105 offset:36864
    s_waitcnt lgkmcnt(2)
    v_mfma_f32_16x16x32_bf16 v[4:7], a[0:3], v[36:39], 0
    v_mfma_f32_16x16x32_bf16 v[8:11], a[80:83], v[36:39], 0
    v_mfma_f32_16x16x32_bf16 v[12:15], a[160:163], v[36:39], 0
    v_mfma_f32_16x16x32_bf16 v[16:19], a[240:243], v[36:39], 0
    v_mfma_f32_16x16x32_bf16 v[20:23], a[0:3], v[40:43], 0
    v_mfma_f32_16x16x32_bf16 v[24:27], a[80:83], v[40:43], 0
    v_mfma_f32_16x16x32_bf16 v[28:31], a[160:163], v[40:43], 0
    v_mfma_f32_16x16x32_bf16 v[32:35], a[240:243], v[40:43], 0
    ds_read_b128 v[36:39], v106 offset:32768
    ds_read_b128 v[40:43], v106 offset:36864
    s_waitcnt lgkmcnt(2)
    v_mfma_f32_16x16x32_bf16 v[4:7], a[4:7], v[44:47], v[4:7]
    v_mfma_f32_16x16x32_bf16 v[8:11], a[84:87], v[44:47], v[8:11]
    v_mfma_f32_16x16x32_bf16 v[12:15], a[164:167], v[44:47], v[12:15]
    v_mfma_f32_16x16x32_bf16 v[16:19], a[244:247], v[44:47], v[16:19]
    v_mfma_f32_16x16x32_bf16 v[20:23], a[4:7], v[48:51], v[20:23]
    v_mfma_f32_16x16x32_bf16 v[24:27], a[84:87], v[48:51], v[24:27]
    v_mfma_f32_16x16x32_bf16 v[28:31], a[164:167], v[48:51], v[28:31]
    v_mfma_f32_16x16x32_bf16 v[32:35], a[244:247], v[48:51], v[32:35]
    ds_read_b128 v[44:47], v107 offset:32768
    ds_read_b128 v[48:51], v107 offset:36864
    s_waitcnt lgkmcnt(2)
    v_mfma_f32_16x16x32_bf16 v[4:7], a[8:11], v[36:39], v[4:7]
    v_mfma_f32_16x16x32_bf16 v[8:11], a[88:91], v[36:39], v[8:11]
    v_mfma_f32_16x16x32_bf16 v[12:15], a[168:171], v[36:39], v[12:15]
    v_mfma_f32_16x16x32_bf16 v[16:19], a[248:251], v[36:39], v[16:19]
    v_mfma_f32_16x16x32_bf16 v[20:23], a[8:11], v[40:43], v[20:23]
    v_mfma_f32_16x16x32_bf16 v[24:27], a[88:91], v[40:43], v[24:27]
    v_mfma_f32_16x16x32_bf16 v[28:31], a[168:171], v[40:43], v[28:31]
    v_mfma_f32_16x16x32_bf16 v[32:35], a[248:251], v[40:43], v[32:35]
    s_waitcnt lgkmcnt(0)
    v_mfma_f32_16x16x32_bf16 v[4:7], a[12:15], v[44:47], v[4:7]
    v_mfma_f32_16x16x32_bf16 v[8:11], a[92:95], v[44:47], v[8:11]
    v_mfma_f32_16x16x32_bf16 v[12:15], a[172:175], v[44:47], v[12:15]
    v_mfma_f32_16x16x32_bf16 v[16:19], a[252:255], v[44:47], v[16:19]
    v_mfma_f32_16x16x32_bf16 v[20:23], a[12:15], v[48:51], v[20:23]
    v_mfma_f32_16x16x32_bf16 v[24:27], a[92:95], v[48:51], v[24:27]
    v_mfma_f32_16x16x32_bf16 v[28:31], a[172:175], v[48:51], v[28:31]
    v_mfma_f32_16x16x32_bf16 v[32:35], a[252:255], v[48:51], v[32:35]
    s_lshl_b32 s48, s28, 13
    s_add_u32 m0, s48, 98304
    s_add_u32 s49, s52, 0
    buffer_load_dwordx4 v64, s[36:39], s49 offen offset:0 lds
    buffer_load_dwordx4 v65, s[36:39], s49 offen offset:1024 lds
    buffer_load_dwordx4 v66, s[36:39], s49 offen offset:2048 lds
    buffer_load_dwordx4 v67, s[36:39], s49 offen offset:3072 lds
    s_lshl_b32 s48, s28, 13
    s_add_u32 m0, s48, 102400
    s_add_u32 s49, s52, 20480
    buffer_load_dwordx4 v64, s[36:39], s49 offen offset:0 lds
    buffer_load_dwordx4 v65, s[36:39], s49 offen offset:1024 lds
    buffer_load_dwordx4 v66, s[36:39], s49 offen offset:2048 lds
    buffer_load_dwordx4 v67, s[36:39], s49 offen offset:3072 lds
    s_waitcnt vmcnt(36)
    ds_read_b128 v[36:39], v108 offset:0
    ds_read_b128 v[40:43], v108 offset:4096
    ds_read_b128 v[44:47], v109 offset:0
    ds_read_b128 v[48:51], v109 offset:4096
    s_waitcnt lgkmcnt(2)
    v_mfma_f32_16x16x32_bf16 v[4:7], a[16:19], v[36:39], v[4:7]
    v_mfma_f32_16x16x32_bf16 v[8:11], a[96:99], v[36:39], v[8:11]
    v_mfma_f32_16x16x32_bf16 v[12:15], a[176:179], v[36:39], v[12:15]
    v_mfma_f32_16x16x32_bf16 v[16:19], v[192:195], v[36:39], v[16:19]
    v_mfma_f32_16x16x32_bf16 v[20:23], a[16:19], v[40:43], v[20:23]
    v_mfma_f32_16x16x32_bf16 v[24:27], a[96:99], v[40:43], v[24:27]
    v_mfma_f32_16x16x32_bf16 v[28:31], a[176:179], v[40:43], v[28:31]
    v_mfma_f32_16x16x32_bf16 v[32:35], v[192:195], v[40:43], v[32:35]
    ds_read_b128 v[36:39], v110 offset:0
    ds_read_b128 v[40:43], v110 offset:4096
    s_waitcnt lgkmcnt(2)
    v_mfma_f32_16x16x32_bf16 v[4:7], a[20:23], v[44:47], v[4:7]
    v_mfma_f32_16x16x32_bf16 v[8:11], a[100:103], v[44:47], v[8:11]
    v_mfma_f32_16x16x32_bf16 v[12:15], a[180:183], v[44:47], v[12:15]
    v_mfma_f32_16x16x32_bf16 v[16:19], v[196:199], v[44:47], v[16:19]
    v_mfma_f32_16x16x32_bf16 v[20:23], a[20:23], v[48:51], v[20:23]
    v_mfma_f32_16x16x32_bf16 v[24:27], a[100:103], v[48:51], v[24:27]
    v_mfma_f32_16x16x32_bf16 v[28:31], a[180:183], v[48:51], v[28:31]
    v_mfma_f32_16x16x32_bf16 v[32:35], v[196:199], v[48:51], v[32:35]
    ds_read_b128 v[44:47], v111 offset:0
    ds_read_b128 v[48:51], v111 offset:4096
    s_waitcnt lgkmcnt(2)
    v_mfma_f32_16x16x32_bf16 v[4:7], a[24:27], v[36:39], v[4:7]
    v_mfma_f32_16x16x32_bf16 v[8:11], a[104:107], v[36:39], v[8:11]
    v_mfma_f32_16x16x32_bf16 v[12:15], a[184:187], v[36:39], v[12:15]
    v_mfma_f32_16x16x32_bf16 v[16:19], v[200:203], v[36:39], v[16:19]
    v_mfma_f32_16x16x32_bf16 v[20:23], a[24:27], v[40:43], v[20:23]
    v_mfma_f32_16x16x32_bf16 v[24:27], a[104:107], v[40:43], v[24:27]
    v_mfma_f32_16x16x32_bf16 v[28:31], a[184:187], v[40:43], v[28:31]
    v_mfma_f32_16x16x32_bf16 v[32:35], v[200:203], v[40:43], v[32:35]
    s_waitcnt lgkmcnt(0)
    v_mfma_f32_16x16x32_bf16 v[4:7], a[28:31], v[44:47], v[4:7]
    v_mfma_f32_16x16x32_bf16 v[8:11], a[108:111], v[44:47], v[8:11]
    v_mfma_f32_16x16x32_bf16 v[12:15], a[188:191], v[44:47], v[12:15]
    v_mfma_f32_16x16x32_bf16 v[16:19], v[204:207], v[44:47], v[16:19]
    v_mfma_f32_16x16x32_bf16 v[20:23], a[28:31], v[48:51], v[20:23]
    v_mfma_f32_16x16x32_bf16 v[24:27], a[108:111], v[48:51], v[24:27]
    v_mfma_f32_16x16x32_bf16 v[28:31], a[188:191], v[48:51], v[28:31]
    v_mfma_f32_16x16x32_bf16 v[32:35], v[204:207], v[48:51], v[32:35]
    s_lshl_b32 s48, s28, 13
    s_add_u32 m0, s48, 131072
    s_add_u32 s49, s52, 256
    buffer_load_dwordx4 v64, s[36:39], s49 offen offset:0 lds
    buffer_load_dwordx4 v65, s[36:39], s49 offen offset:1024 lds
    buffer_load_dwordx4 v66, s[36:39], s49 offen offset:2048 lds
    buffer_load_dwordx4 v67, s[36:39], s49 offen offset:3072 lds
    s_lshl_b32 s48, s28, 13
    s_add_u32 m0, s48, 135168
    s_add_u32 s49, s52, 20736
    buffer_load_dwordx4 v64, s[36:39], s49 offen offset:0 lds
    buffer_load_dwordx4 v65, s[36:39], s49 offen offset:1024 lds
    buffer_load_dwordx4 v66, s[36:39], s49 offen offset:2048 lds
    buffer_load_dwordx4 v67, s[36:39], s49 offen offset:3072 lds
    s_waitcnt vmcnt(36)
    ds_read_b128 v[36:39], v100 offset:0
    ds_read_b128 v[40:43], v100 offset:4096
    ds_read_b128 v[44:47], v101 offset:0
    ds_read_b128 v[48:51], v101 offset:4096
    s_waitcnt lgkmcnt(2)
    v_mfma_f32_16x16x32_bf16 v[4:7], a[32:35], v[36:39], v[4:7]
    v_mfma_f32_16x16x32_bf16 v[8:11], a[112:115], v[36:39], v[8:11]
    v_mfma_f32_16x16x32_bf16 v[12:15], a[192:195], v[36:39], v[12:15]
    v_mfma_f32_16x16x32_bf16 v[16:19], v[208:211], v[36:39], v[16:19]
    v_mfma_f32_16x16x32_bf16 v[20:23], a[32:35], v[40:43], v[20:23]
    v_mfma_f32_16x16x32_bf16 v[24:27], a[112:115], v[40:43], v[24:27]
    v_mfma_f32_16x16x32_bf16 v[28:31], a[192:195], v[40:43], v[28:31]
    v_mfma_f32_16x16x32_bf16 v[32:35], v[208:211], v[40:43], v[32:35]
    ds_read_b128 v[36:39], v102 offset:0
    ds_read_b128 v[40:43], v102 offset:4096
    s_waitcnt lgkmcnt(2)
    v_mfma_f32_16x16x32_bf16 v[4:7], a[36:39], v[44:47], v[4:7]
    v_mfma_f32_16x16x32_bf16 v[8:11], a[116:119], v[44:47], v[8:11]
    v_mfma_f32_16x16x32_bf16 v[12:15], a[196:199], v[44:47], v[12:15]
    v_mfma_f32_16x16x32_bf16 v[16:19], v[212:215], v[44:47], v[16:19]
    v_mfma_f32_16x16x32_bf16 v[20:23], a[36:39], v[48:51], v[20:23]
    v_mfma_f32_16x16x32_bf16 v[24:27], a[116:119], v[48:51], v[24:27]
    v_mfma_f32_16x16x32_bf16 v[28:31], a[196:199], v[48:51], v[28:31]
    v_mfma_f32_16x16x32_bf16 v[32:35], v[212:215], v[48:51], v[32:35]
    ds_read_b128 v[44:47], v103 offset:0
    ds_read_b128 v[48:51], v103 offset:4096
    s_waitcnt lgkmcnt(2)
    v_mfma_f32_16x16x32_bf16 v[4:7], a[40:43], v[36:39], v[4:7]
    v_mfma_f32_16x16x32_bf16 v[8:11], a[120:123], v[36:39], v[8:11]
    v_mfma_f32_16x16x32_bf16 v[12:15], a[200:203], v[36:39], v[12:15]
    v_mfma_f32_16x16x32_bf16 v[16:19], v[216:219], v[36:39], v[16:19]
    v_mfma_f32_16x16x32_bf16 v[20:23], a[40:43], v[40:43], v[20:23]
    v_mfma_f32_16x16x32_bf16 v[24:27], a[120:123], v[40:43], v[24:27]
    v_mfma_f32_16x16x32_bf16 v[28:31], a[200:203], v[40:43], v[28:31]
    v_mfma_f32_16x16x32_bf16 v[32:35], v[216:219], v[40:43], v[32:35]
    s_waitcnt lgkmcnt(0)
    v_mfma_f32_16x16x32_bf16 v[4:7], a[44:47], v[44:47], v[4:7]
    v_mfma_f32_16x16x32_bf16 v[8:11], a[124:127], v[44:47], v[8:11]
    v_mfma_f32_16x16x32_bf16 v[12:15], a[204:207], v[44:47], v[12:15]
    v_mfma_f32_16x16x32_bf16 v[16:19], v[220:223], v[44:47], v[16:19]
    v_mfma_f32_16x16x32_bf16 v[20:23], a[44:47], v[48:51], v[20:23]
    v_mfma_f32_16x16x32_bf16 v[24:27], a[124:127], v[48:51], v[24:27]
    v_mfma_f32_16x16x32_bf16 v[28:31], a[204:207], v[48:51], v[28:31]
    v_mfma_f32_16x16x32_bf16 v[32:35], v[220:223], v[48:51], v[32:35]
    s_lshl_b32 s48, s28, 13
    s_add_u32 m0, s48, 0
    s_add_u32 s49, s52, 512
    buffer_load_dwordx4 v64, s[36:39], s49 offen offset:0 lds
    buffer_load_dwordx4 v65, s[36:39], s49 offen offset:1024 lds
    buffer_load_dwordx4 v66, s[36:39], s49 offen offset:2048 lds
    buffer_load_dwordx4 v67, s[36:39], s49 offen offset:3072 lds
    s_lshl_b32 s48, s28, 13
    s_add_u32 m0, s48, 4096
    s_add_u32 s49, s52, 20992
    buffer_load_dwordx4 v64, s[36:39], s49 offen offset:0 lds
    buffer_load_dwordx4 v65, s[36:39], s49 offen offset:1024 lds
    buffer_load_dwordx4 v66, s[36:39], s49 offen offset:2048 lds
    buffer_load_dwordx4 v67, s[36:39], s49 offen offset:3072 lds
    s_waitcnt vmcnt(36)
    ds_read_b128 v[36:39], v100 offset:32768
    ds_read_b128 v[40:43], v100 offset:36864
    ds_read_b128 v[44:47], v101 offset:32768
    ds_read_b128 v[48:51], v101 offset:36864
    s_waitcnt lgkmcnt(2)
    v_mfma_f32_16x16x32_bf16 v[4:7], a[48:51], v[36:39], v[4:7]
    v_mfma_f32_16x16x32_bf16 v[8:11], a[128:131], v[36:39], v[8:11]
    v_mfma_f32_16x16x32_bf16 v[12:15], a[208:211], v[36:39], v[12:15]
    v_mfma_f32_16x16x32_bf16 v[16:19], v[224:227], v[36:39], v[16:19]
    v_mfma_f32_16x16x32_bf16 v[20:23], a[48:51], v[40:43], v[20:23]
    v_mfma_f32_16x16x32_bf16 v[24:27], a[128:131], v[40:43], v[24:27]
    v_mfma_f32_16x16x32_bf16 v[28:31], a[208:211], v[40:43], v[28:31]
    v_mfma_f32_16x16x32_bf16 v[32:35], v[224:227], v[40:43], v[32:35]
    ds_read_b128 v[36:39], v102 offset:32768
    ds_read_b128 v[40:43], v102 offset:36864
    s_waitcnt lgkmcnt(2)
    v_mfma_f32_16x16x32_bf16 v[4:7], a[52:55], v[44:47], v[4:7]
    v_mfma_f32_16x16x32_bf16 v[8:11], a[132:135], v[44:47], v[8:11]
    v_mfma_f32_16x16x32_bf16 v[12:15], a[212:215], v[44:47], v[12:15]
    v_mfma_f32_16x16x32_bf16 v[16:19], v[228:231], v[44:47], v[16:19]
    v_mfma_f32_16x16x32_bf16 v[20:23], a[52:55], v[48:51], v[20:23]
    v_mfma_f32_16x16x32_bf16 v[24:27], a[132:135], v[48:51], v[24:27]
    v_mfma_f32_16x16x32_bf16 v[28:31], a[212:215], v[48:51], v[28:31]
    v_mfma_f32_16x16x32_bf16 v[32:35], v[228:231], v[48:51], v[32:35]
    ds_read_b128 v[44:47], v103 offset:32768
    ds_read_b128 v[48:51], v103 offset:36864
    s_waitcnt lgkmcnt(2)
    v_mfma_f32_16x16x32_bf16 v[4:7], a[56:59], v[36:39], v[4:7]
    v_mfma_f32_16x16x32_bf16 v[8:11], a[136:139], v[36:39], v[8:11]
    v_mfma_f32_16x16x32_bf16 v[12:15], a[216:219], v[36:39], v[12:15]
    v_mfma_f32_16x16x32_bf16 v[16:19], v[232:235], v[36:39], v[16:19]
    v_mfma_f32_16x16x32_bf16 v[20:23], a[56:59], v[40:43], v[20:23]
    v_mfma_f32_16x16x32_bf16 v[24:27], a[136:139], v[40:43], v[24:27]
    v_mfma_f32_16x16x32_bf16 v[28:31], a[216:219], v[40:43], v[28:31]
    v_mfma_f32_16x16x32_bf16 v[32:35], v[232:235], v[40:43], v[32:35]
    s_waitcnt lgkmcnt(0)
    v_mfma_f32_16x16x32_bf16 v[4:7], a[60:63], v[44:47], v[4:7]
    v_mfma_f32_16x16x32_bf16 v[8:11], a[140:143], v[44:47], v[8:11]
    v_mfma_f32_16x16x32_bf16 v[12:15], a[220:223], v[44:47], v[12:15]
    v_mfma_f32_16x16x32_bf16 v[16:19], v[236:239], v[44:47], v[16:19]
    v_mfma_f32_16x16x32_bf16 v[20:23], a[60:63], v[48:51], v[20:23]
    v_mfma_f32_16x16x32_bf16 v[24:27], a[140:143], v[48:51], v[24:27]
    v_mfma_f32_16x16x32_bf16 v[28:31], a[220:223], v[48:51], v[28:31]
    v_mfma_f32_16x16x32_bf16 v[32:35], v[236:239], v[48:51], v[32:35]
    s_lshl_b32 s48, s28, 13
    s_add_u32 m0, s48, 32768
    s_add_u32 s49, s52, 768
    buffer_load_dwordx4 v64, s[36:39], s49 offen offset:0 lds
    buffer_load_dwordx4 v65, s[36:39], s49 offen offset:1024 lds
    buffer_load_dwordx4 v66, s[36:39], s49 offen offset:2048 lds
    buffer_load_dwordx4 v67, s[36:39], s49 offen offset:3072 lds
    s_lshl_b32 s48, s28, 13
    s_add_u32 m0, s48, 36864
    s_add_u32 s49, s52, 21248
    buffer_load_dwordx4 v64, s[36:39], s49 offen offset:0 lds
    buffer_load_dwordx4 v65, s[36:39], s49 offen offset:1024 lds
    buffer_load_dwordx4 v66, s[36:39], s49 offen offset:2048 lds
    buffer_load_dwordx4 v67, s[36:39], s49 offen offset:3072 lds
    s_waitcnt vmcnt(32)
    ds_read_b128 v[36:39], v104 offset:0
    ds_read_b128 v[40:43], v104 offset:4096
    ds_read_b128 v[44:47], v105 offset:0
    ds_read_b128 v[48:51], v105 offset:4096
    s_waitcnt lgkmcnt(2)
    v_mfma_f32_16x16x32_bf16 v[4:7], a[64:67], v[36:39], v[4:7]
    v_mfma_f32_16x16x32_bf16 v[8:11], a[144:147], v[36:39], v[8:11]
    v_mfma_f32_16x16x32_bf16 v[12:15], a[224:227], v[36:39], v[12:15]
    v_mfma_f32_16x16x32_bf16 v[16:19], v[240:243], v[36:39], v[16:19]
    v_mfma_f32_16x16x32_bf16 v[20:23], a[64:67], v[40:43], v[20:23]
    v_mfma_f32_16x16x32_bf16 v[24:27], a[144:147], v[40:43], v[24:27]
    v_mfma_f32_16x16x32_bf16 v[28:31], a[224:227], v[40:43], v[28:31]
    v_mfma_f32_16x16x32_bf16 v[32:35], v[240:243], v[40:43], v[32:35]
    ds_read_b128 v[36:39], v106 offset:0
    ds_read_b128 v[40:43], v106 offset:4096
    s_waitcnt lgkmcnt(2)
    v_mfma_f32_16x16x32_bf16 v[4:7], a[68:71], v[44:47], v[4:7]
    v_mfma_f32_16x16x32_bf16 v[8:11], a[148:151], v[44:47], v[8:11]
    v_mfma_f32_16x16x32_bf16 v[12:15], a[228:231], v[44:47], v[12:15]
    v_mfma_f32_16x16x32_bf16 v[16:19], v[244:247], v[44:47], v[16:19]
    v_mfma_f32_16x16x32_bf16 v[20:23], a[68:71], v[48:51], v[20:23]
    v_mfma_f32_16x16x32_bf16 v[24:27], a[148:151], v[48:51], v[24:27]
    v_mfma_f32_16x16x32_bf16 v[28:31], a[228:231], v[48:51], v[28:31]
    v_mfma_f32_16x16x32_bf16 v[32:35], v[244:247], v[48:51], v[32:35]
    ds_read_b128 v[44:47], v107 offset:0
    ds_read_b128 v[48:51], v107 offset:4096
    s_waitcnt lgkmcnt(2)
    v_mfma_f32_16x16x32_bf16 v[4:7], a[72:75], v[36:39], v[4:7]
    v_mfma_f32_16x16x32_bf16 v[8:11], a[152:155], v[36:39], v[8:11]
    v_mfma_f32_16x16x32_bf16 v[12:15], a[232:235], v[36:39], v[12:15]
    v_mfma_f32_16x16x32_bf16 v[16:19], v[248:251], v[36:39], v[16:19]
    v_mfma_f32_16x16x32_bf16 v[20:23], a[72:75], v[40:43], v[20:23]
    v_mfma_f32_16x16x32_bf16 v[24:27], a[152:155], v[40:43], v[24:27]
    v_mfma_f32_16x16x32_bf16 v[28:31], a[232:235], v[40:43], v[28:31]
    v_mfma_f32_16x16x32_bf16 v[32:35], v[248:251], v[40:43], v[32:35]
    s_waitcnt lgkmcnt(0)
    v_mfma_f32_16x16x32_bf16 v[4:7], a[76:79], v[44:47], v[4:7]
    v_mfma_f32_16x16x32_bf16 v[8:11], a[156:159], v[44:47], v[8:11]
    v_mfma_f32_16x16x32_bf16 v[12:15], a[236:239], v[44:47], v[12:15]
    v_mfma_f32_16x16x32_bf16 v[16:19], v[252:255], v[44:47], v[16:19]
    v_mfma_f32_16x16x32_bf16 v[20:23], a[76:79], v[48:51], v[20:23]
    v_mfma_f32_16x16x32_bf16 v[24:27], a[156:159], v[48:51], v[24:27]
    v_mfma_f32_16x16x32_bf16 v[28:31], a[236:239], v[48:51], v[28:31]
    v_mfma_f32_16x16x32_bf16 v[32:35], v[252:255], v[48:51], v[32:35]
    s_lshl_b32 s48, s28, 13
    s_add_u32 m0, s48, 65536
    s_add_u32 s49, s52, 1024
    buffer_load_dwordx4 v64, s[36:39], s49 offen offset:0 lds
    buffer_load_dwordx4 v65, s[36:39], s49 offen offset:1024 lds
    buffer_load_dwordx4 v66, s[36:39], s49 offen offset:2048 lds
    buffer_load_dwordx4 v67, s[36:39], s49 offen offset:3072 lds
    s_lshl_b32 s48, s28, 13
    s_add_u32 m0, s48, 69632
    s_add_u32 s49, s52, 21504
    buffer_load_dwordx4 v64, s[36:39], s49 offen offset:0 lds
    buffer_load_dwordx4 v65, s[36:39], s49 offen offset:1024 lds
    buffer_load_dwordx4 v66, s[36:39], s49 offen offset:2048 lds
    buffer_load_dwordx4 v67, s[36:39], s49 offen offset:3072 lds
    v_cvt_pk_bf16_f32 v128, v4, v5
    v_and_b32 v129, 0xffff0000, v128
    v_lshlrev_b32 v128, 16, v128
    v_pk_mul_f32 v[130:131], v[128:129], s[74:75]
    v_exp_f32 v130, v130
    v_exp_f32 v131, v131
    v_pk_add_f32 v[132:133], v[128:129], s[78:79]
    v_cmp_lt_f32_e64 vcc, 0, v128
    v_cmp_lt_f32 s[70:71], 0, v129
    s_nop 0
    v_cndmask_b32 v130, v130, v132, vcc
    v_cndmask_b32 v131, v131, v133, s[70:71]
    v_pk_add_f32 v[130:131], v[130:131], s[76:77]
    v_cvt_pk_bf16_f32 v80, v130, v131
    v_cvt_pk_bf16_f32 v134, v6, v7
    v_and_b32 v135, 0xffff0000, v134
    v_lshlrev_b32_e64 v134, 16, v134
    v_pk_mul_f32 v[136:137], v[134:135], s[74:75]
    v_exp_f32 v136, v136
    v_exp_f32 v137, v137
    v_pk_add_f32 v[138:139], v[134:135], s[78:79]
    v_cmp_lt_f32_e64 vcc, 0, v134
    v_cmp_lt_f32 s[70:71], 0, v135
    s_nop 0
    v_cndmask_b32 v136, v136, v138, vcc
    v_cndmask_b32 v137, v137, v139, s[70:71]
    v_pk_add_f32 v[136:137], v[136:137], s[76:77]
    v_cvt_pk_bf16_f32 v81, v136, v137
    v_cvt_pk_bf16_f32 v128, v8, v9
    v_and_b32 v129, 0xffff0000, v128
    v_lshlrev_b32_e64 v128, 16, v128
    v_pk_mul_f32 v[130:131], v[128:129], s[74:75]
    v_exp_f32 v130, v130
    v_exp_f32 v131, v131
    v_pk_add_f32 v[132:133], v[128:129], s[78:79]
    v_cmp_lt_f32_e64 vcc, 0, v128
    v_cmp_lt_f32 s[70:71], 0, v129
    s_nop 0
    v_cndmask_b32 v130, v130, v132, vcc
    v_cndmask_b32 v131, v131, v133, s[70:71]
    v_pk_add_f32 v[130:131], v[130:131], s[76:77]
    v_cvt_pk_bf16_f32 v82, v130, v131
    v_cvt_pk_bf16_f32 v134, v10, v11
    v_and_b32 v135, 0xffff0000, v134
    v_lshlrev_b32_e64 v134, 16, v134
    v_pk_mul_f32 v[136:137], v[134:135], s[74:75]
    v_exp_f32 v136, v136
    v_exp_f32 v137, v137
    v_pk_add_f32 v[138:139], v[134:135], s[78:79]
    v_cmp_lt_f32_e64 vcc, 0, v134
    v_cmp_lt_f32 s[70:71], 0, v135
    s_nop 0
    v_cndmask_b32 v136, v136, v138, vcc
    v_cndmask_b32 v137, v137, v139, s[70:71]
    v_pk_add_f32 v[136:137], v[136:137], s[76:77]
    v_cvt_pk_bf16_f32 v83, v136, v137
    v_cvt_pk_bf16_f32 v128, v12, v13
    v_and_b32 v129, 0xffff0000, v128
    v_lshlrev_b32_e64 v128, 16, v128
    v_pk_mul_f32 v[130:131], v[128:129], s[74:75]
    v_exp_f32 v130, v130
    v_exp_f32 v131, v131
    v_pk_add_f32 v[132:133], v[128:129], s[78:79]
    v_cmp_lt_f32_e64 vcc, 0, v128
    v_cmp_lt_f32 s[70:71], 0, v129
    s_nop 0
    v_cndmask_b32 v130, v130, v132, vcc
    v_cndmask_b32 v131, v131, v133, s[70:71]
    v_pk_add_f32 v[130:131], v[130:131], s[76:77]
    v_cvt_pk_bf16_f32 v84, v130, v131
    v_cvt_pk_bf16_f32 v134, v14, v15
    v_and_b32 v135, 0xffff0000, v134
    v_lshlrev_b32_e64 v134, 16, v134
    v_pk_mul_f32 v[136:137], v[134:135], s[74:75]
    v_exp_f32 v136, v136
    v_exp_f32 v137, v137
    v_pk_add_f32 v[138:139], v[134:135], s[78:79]
    v_cmp_lt_f32_e64 vcc, 0, v134
    v_cmp_lt_f32 s[70:71], 0, v135
    s_nop 0
    v_cndmask_b32 v136, v136, v138, vcc
    v_cndmask_b32 v137, v137, v139, s[70:71]
    v_pk_add_f32 v[136:137], v[136:137], s[76:77]
    v_cvt_pk_bf16_f32 v85, v136, v137
    v_cvt_pk_bf16_f32 v128, v16, v17
    v_and_b32 v129, 0xffff0000, v128
    v_lshlrev_b32_e64 v128, 16, v128
    v_pk_mul_f32 v[130:131], v[128:129], s[74:75]
    v_exp_f32 v130, v130
    v_exp_f32 v131, v131
    v_pk_add_f32 v[132:133], v[128:129], s[78:79]
    v_cmp_lt_f32_e64 vcc, 0, v128
    v_cmp_lt_f32 s[70:71], 0, v129
    s_nop 0
    v_cndmask_b32 v130, v130, v132, vcc
    v_cndmask_b32 v131, v131, v133, s[70:71]
    v_pk_add_f32 v[130:131], v[130:131], s[76:77]
    v_cvt_pk_bf16_f32 v86, v130, v131
    v_cvt_pk_bf16_f32 v134, v18, v19
    v_and_b32 v135, 0xffff0000, v134
    v_lshlrev_b32_e64 v134, 16, v134
    v_pk_mul_f32 v[136:137], v[134:135], s[74:75]
    v_exp_f32 v136, v136
    v_exp_f32 v137, v137
    v_pk_add_f32 v[138:139], v[134:135], s[78:79]
    v_cmp_lt_f32_e64 vcc, 0, v134
    v_cmp_lt_f32 s[70:71], 0, v135
    s_nop 0
    v_cndmask_b32 v136, v136, v138, vcc
    v_cndmask_b32 v137, v137, v139, s[70:71]
    v_pk_add_f32 v[136:137], v[136:137], s[76:77]
    v_cvt_pk_bf16_f32 v87, v136, v137
    v_cvt_pk_bf16_f32 v128, v20, v21
    v_and_b32 v129, 0xffff0000, v128
    v_lshlrev_b32_e64 v128, 16, v128
    v_pk_mul_f32 v[130:131], v[128:129], s[74:75]
    v_exp_f32 v130, v130
    v_exp_f32 v131, v131
    v_pk_add_f32 v[132:133], v[128:129], s[78:79]
    v_cmp_lt_f32_e64 vcc, 0, v128
    v_cmp_lt_f32 s[70:71], 0, v129
    s_nop 0
    v_cndmask_b32 v130, v130, v132, vcc
    v_cndmask_b32 v131, v131, v133, s[70:71]
    v_pk_add_f32 v[130:131], v[130:131], s[76:77]
    v_cvt_pk_bf16_f32 v88, v130, v131
    v_cvt_pk_bf16_f32 v134, v22, v23
    v_and_b32 v135, 0xffff0000, v134
    v_lshlrev_b32_e64 v134, 16, v134
    v_pk_mul_f32 v[136:137], v[134:135], s[74:75]
    v_exp_f32 v136, v136
    v_exp_f32 v137, v137
    v_pk_add_f32 v[138:139], v[134:135], s[78:79]
    v_cmp_lt_f32_e64 vcc, 0, v134
    v_cmp_lt_f32 s[70:71], 0, v135
    s_nop 0
    v_cndmask_b32 v136, v136, v138, vcc
    v_cndmask_b32 v137, v137, v139, s[70:71]
    v_pk_add_f32 v[136:137], v[136:137], s[76:77]
    v_cvt_pk_bf16_f32 v89, v136, v137
    v_cvt_pk_bf16_f32 v128, v24, v25
    v_and_b32 v129, 0xffff0000, v128
    v_lshlrev_b32_e64 v128, 16, v128
    v_pk_mul_f32 v[130:131], v[128:129], s[74:75]
    v_exp_f32 v130, v130
    v_exp_f32 v131, v131
    v_pk_add_f32 v[132:133], v[128:129], s[78:79]
    v_cmp_lt_f32_e64 vcc, 0, v128
    v_cmp_lt_f32 s[70:71], 0, v129
    s_nop 0
    v_cndmask_b32 v130, v130, v132, vcc
    v_cndmask_b32 v131, v131, v133, s[70:71]
    v_pk_add_f32 v[130:131], v[130:131], s[76:77]
    v_cvt_pk_bf16_f32 v90, v130, v131
    v_cvt_pk_bf16_f32 v134, v26, v27
    v_and_b32 v135, 0xffff0000, v134
    v_lshlrev_b32_e64 v134, 16, v134
    v_pk_mul_f32 v[136:137], v[134:135], s[74:75]
    v_exp_f32 v136, v136
    v_exp_f32 v137, v137
    v_pk_add_f32 v[138:139], v[134:135], s[78:79]
    v_cmp_lt_f32_e64 vcc, 0, v134
    v_cmp_lt_f32 s[70:71], 0, v135
    s_nop 0
    v_cndmask_b32 v136, v136, v138, vcc
    v_cndmask_b32 v137, v137, v139, s[70:71]
    v_pk_add_f32 v[136:137], v[136:137], s[76:77]
    v_cvt_pk_bf16_f32 v91, v136, v137
    v_cvt_pk_bf16_f32 v128, v28, v29
    v_and_b32 v129, 0xffff0000, v128
    v_lshlrev_b32_e64 v128, 16, v128
    v_pk_mul_f32 v[130:131], v[128:129], s[74:75]
    v_exp_f32 v130, v130
    v_exp_f32 v131, v131
    v_pk_add_f32 v[132:133], v[128:129], s[78:79]
    v_cmp_lt_f32_e64 vcc, 0, v128
    v_cmp_lt_f32 s[70:71], 0, v129
    s_nop 0
    v_cndmask_b32 v130, v130, v132, vcc
    v_cndmask_b32 v131, v131, v133, s[70:71]
    v_pk_add_f32 v[130:131], v[130:131], s[76:77]
    v_cvt_pk_bf16_f32 v92, v130, v131
    v_cvt_pk_bf16_f32 v134, v30, v31
    v_and_b32 v135, 0xffff0000, v134
    v_lshlrev_b32_e64 v134, 16, v134
    v_pk_mul_f32 v[136:137], v[134:135], s[74:75]
    v_exp_f32 v136, v136
    v_exp_f32 v137, v137
    v_pk_add_f32 v[138:139], v[134:135], s[78:79]
    v_cmp_lt_f32_e64 vcc, 0, v134
    v_cmp_lt_f32 s[70:71], 0, v135
    s_nop 0
    v_cndmask_b32 v136, v136, v138, vcc
    v_cndmask_b32 v137, v137, v139, s[70:71]
    v_pk_add_f32 v[136:137], v[136:137], s[76:77]
    v_cvt_pk_bf16_f32 v93, v136, v137
    v_cvt_pk_bf16_f32 v128, v32, v33
    v_and_b32 v129, 0xffff0000, v128
    v_lshlrev_b32_e64 v128, 16, v128
    v_pk_mul_f32 v[130:131], v[128:129], s[74:75]
    v_exp_f32 v130, v130
    v_exp_f32 v131, v131
    v_pk_add_f32 v[132:133], v[128:129], s[78:79]
    v_cmp_lt_f32_e64 vcc, 0, v128
    v_cmp_lt_f32 s[70:71], 0, v129
    s_nop 0
    v_cndmask_b32 v130, v130, v132, vcc
    v_cndmask_b32 v131, v131, v133, s[70:71]
    v_pk_add_f32 v[130:131], v[130:131], s[76:77]
    v_cvt_pk_bf16_f32 v94, v130, v131
    v_cvt_pk_bf16_f32 v134, v34, v35
    v_and_b32 v135, 0xffff0000, v134
    v_lshlrev_b32_e64 v134, 16, v134
    v_pk_mul_f32 v[136:137], v[134:135], s[74:75]
    v_exp_f32 v136, v136
    v_exp_f32 v137, v137
    v_pk_add_f32 v[138:139], v[134:135], s[78:79]
    v_cmp_lt_f32_e64 vcc, 0, v134
    v_cmp_lt_f32 s[70:71], 0, v135
    s_nop 0
    v_cndmask_b32 v136, v136, v138, vcc
    v_cndmask_b32 v137, v137, v139, s[70:71]
    v_pk_add_f32 v[136:137], v[136:137], s[76:77]
    v_cvt_pk_bf16_f32 v95, v136, v137
    s_add_u32 s50, s58, 32768
    buffer_store_dwordx4 v[80:83], v72, s[40:43], s58 offen offset:0 sc1
    buffer_store_dwordx4 v[84:87], v72, s[40:43], s58 offen offset:1024 sc1
    buffer_store_dwordx4 v[88:91], v72, s[40:43], s50 offen offset:0 sc1
    buffer_store_dwordx4 v[92:95], v72, s[40:43], s50 offen offset:1024 sc1
    s_add_u32 s58, s58, 262144
    s_mov_b32 s59, s52
    s_add_u32 s60, s60, 1
    s_cmp_le_u32 s60, s63
    s_cbranch_scc1 wsg_loop_55
    s_branch bq_fin_54
bq_fin_54:
    s_waitcnt vmcnt(0)
    v_mov_b32_e64 v73, 16
    v_mov_b32 v74, s61
    s_mov_b64 exec, 1
    buffer_store_dword v73, v74, s[44:47], 0 offen sc1
    s_mov_b64 exec, -1
    s_waitcnt vmcnt(0)
    s_barrier
    s_branch k_b3
k_b3:
    s_waitcnt vmcnt(0) lgkmcnt(0)
    s_barrier
    s_mov_b32 s32, s20
    s_mov_b32 s33, s21
    s_and_b32 s33, s33, 0xffff
    s_mov_b32 s34, 0xc8000
    s_mov_b32 s35, 0x20000
    s_add_u32 s36, s26, 0x5800000
    s_addc_u32 s37, s27, 0
    s_and_b32 s37, s37, 0xffff
    s_mov_b32 s38, 0x400000
    s_mov_b32 s39, 0x20000
    s_add_u32 s40, s26, 0x6400000
    s_addc_u32 s41, s27, 0
    s_and_b32 s41, s41, 0xffff
    s_mov_b32 s42, 0x40000
    s_mov_b32 s43, 0x20000
    s_mov_b32 s44, s22
    s_mov_b32 s45, s23
    s_and_b32 s45, s45, 0xffff
    s_mov_b32 s46, 0x500000
    s_mov_b32 s47, 0x20000
    s_add_u32 s48, s26, 0x5500000
    s_addc_u32 s49, s27, 0
    s_and_b32 s49, s49, 0xffff
    s_mov_b32 s50, 0x8000
    s_mov_b32 s51, 0x20000
    s_mul_hi_u32 s63, s29, 429496730
    s_mul_i32 s52, s63, 10
    s_sub_u32 s62, s29, s52
    v_lshlrev_b32 v1, 4, v0
    v_cmp_gt_u32 s[70:71], 16, v0
    s_mov_b32 s72, 0x358637bd
    s_mov_b32 s73, 0x358637bd
    v_lshrrev_b32_e64 v4, 3, v0
    v_mul_u32_u24 v4, 1280, v4
    v_and_b32_e64 v5, 7, v0
    v_lshl_add_u32 v4, v5, 4, v4
    s_mul_i32 s52, s28, 204800
    s_lshl_b32 s53, s62, 7
    s_add_u32 s52, s52, s53
    s_mul_i32 s53, s28, 24576
    s_mov_b32 m0, s53
    s_add_u32 s53, s53, 1024
    buffer_load_dwordx4 v4, s[32:35], s52 offen lds
    s_add_u32 s52, s52, 10240
    s_mov_b32 m0, s53
    s_add_u32 s53, s53, 1024
    buffer_load_dwordx4 v4, s[32:35], s52 offen lds
    s_add_u32 s52, s52, 10240
    s_mov_b32 m0, s53
    s_add_u32 s53, s53, 1024
    buffer_load_dwordx4 v4, s[32:35], s52 offen lds
    s_add_u32 s52, s52, 10240
    s_mov_b32 m0, s53
    s_add_u32 s53, s53, 1024
    buffer_load_dwordx4 v4, s[32:35], s52 offen lds
    s_add_u32 s52, s52, 10240
    s_mov_b32 m0, s53
    s_add_u32 s53, s53, 1024
    buffer_load_dwordx4 v4, s[32:35], s52 offen lds
    s_add_u32 s52, s52, 10240
    s_mov_b32 m0, s53
    s_add_u32 s53, s53, 1024
    buffer_load_dwordx4 v4, s[32:35], s52 offen lds
    s_add_u32 s52, s52, 10240
    s_mov_b32 m0, s53
    s_add_u32 s53, s53, 1024
    buffer_load_dwordx4 v4, s[32:35], s52 offen lds
    s_add_u32 s52, s52, 10240
    s_mov_b32 m0, s53
    s_add_u32 s53, s53, 1024
    buffer_load_dwordx4 v4, s[32:35], s52 offen lds
    s_add_u32 s52, s52, 10240
    s_mov_b32 m0, s53
    s_add_u32 s53, s53, 1024
    buffer_load_dwordx4 v4, s[32:35], s52 offen lds
    s_add_u32 s52, s52, 10240
    s_mov_b32 m0, s53
    s_add_u32 s53, s53, 1024
    buffer_load_dwordx4 v4, s[32:35], s52 offen lds
    s_add_u32 s52, s52, 10240
    s_mov_b32 m0, s53
    s_add_u32 s53, s53, 1024
    buffer_load_dwordx4 v4, s[32:35], s52 offen lds
    s_add_u32 s52, s52, 10240
    s_mov_b32 m0, s53
    s_add_u32 s53, s53, 1024
    buffer_load_dwordx4 v4, s[32:35], s52 offen lds
    s_add_u32 s52, s52, 10240
    s_mov_b32 m0, s53
    s_add_u32 s53, s53, 1024
    buffer_load_dwordx4 v4, s[32:35], s52 offen lds
    s_add_u32 s52, s52, 10240
    s_mov_b32 m0, s53
    s_add_u32 s53, s53, 1024
    buffer_load_dwordx4 v4, s[32:35], s52 offen lds
    s_add_u32 s52, s52, 10240
    s_mov_b32 m0, s53
    s_add_u32 s53, s53, 1024
    buffer_load_dwordx4 v4, s[32:35], s52 offen lds
    s_add_u32 s52, s52, 10240
    s_mov_b32 m0, s53
    s_add_u32 s53, s53, 1024
    buffer_load_dwordx4 v4, s[32:35], s52 offen lds
    s_add_u32 s52, s52, 10240
    s_mov_b32 m0, s53
    s_add_u32 s53, s53, 1024
    buffer_load_dwordx4 v4, s[32:35], s52 offen lds
    s_add_u32 s52, s52, 10240
    s_mov_b32 m0, s53
    s_add_u32 s53, s53, 1024
    buffer_load_dwordx4 v4, s[32:35], s52 offen lds
    s_add_u32 s52, s52, 10240
    s_mov_b32 m0, s53
    s_add_u32 s53, s53, 1024
    buffer_load_dwordx4 v4, s[32:35], s52 offen lds
    s_add_u32 s52, s52, 10240
    s_mov_b32 m0, s53
    s_add_u32 s53, s53, 1024
    buffer_load_dwordx4 v4, s[32:35], s52 offen lds
    s_add_u32 s52, s52, 10240
    v_lshrrev_b32_e64 v5, 4, v0
    v_bfe_u32 v6, v0, 2, 2
    v_lshl_add_u32 v5, v5, 2, v6
    v_lshlrev_b32 v5, 7, v5
    v_and_b32 v6, 3, v0
    v_lshl_add_u32 v2, v6, 5, v5
    s_mul_i32 s52, s28, 24576
    v_add_u32 v2, s52, v2
    s_waitcnt vmcnt(0)
    ds_read_b64_tr_b16 a[0:1], v2 offset:0
    ds_read_b64_tr_b16 v[128:129], v2 offset:2048
    ds_read_b64_tr_b16 a[32:33], v2 offset:8
    ds_read_b64_tr_b16 v[130:131], v2 offset:2056
    ds_read_b64_tr_b16 a[64:65], v2 offset:16
    ds_read_b64_tr_b16 v[132:133], v2 offset:2064
    ds_read_b64_tr_b16 a[96:97], v2 offset:24
    ds_read_b64_tr_b16 v[134:135], v2 offset:2072
    s_waitcnt lgkmcnt(0)
    s_nop 0
    v_cndmask_b32 v128, 0, v128, s[70:71]
    v_accvgpr_write_b32 a2, v128
    v_cndmask_b32 v129, 0, v129, s[70:71]
    v_accvgpr_write_b32 a3, v129
    v_cndmask_b32 v130, 0, v130, s[70:71]
    v_accvgpr_write_b32 a34, v130
    v_cndmask_b32 v131, 0, v131, s[70:71]
    v_accvgpr_write_b32 a35, v131
    v_cndmask_b32 v132, 0, v132, s[70:71]
    v_accvgpr_write_b32 a66, v132
    v_cndmask_b32 v133, 0, v133, s[70:71]
    v_accvgpr_write_b32 a67, v133
    v_cndmask_b32 v134, 0, v134, s[70:71]
    v_accvgpr_write_b32 a98, v134
    v_cndmask_b32 v135, 0, v135, s[70:71]
    v_accvgpr_write_b32 a99, v135
    ds_read_b64_tr_b16 a[4:5], v2 offset:2560
    ds_read_b64_tr_b16 v[128:129], v2 offset:4608
    ds_read_b64_tr_b16 a[36:37], v2 offset:2568
    ds_read_b64_tr_b16 v[130:131], v2 offset:4616
    ds_read_b64_tr_b16 a[68:69], v2 offset:2576
    ds_read_b64_tr_b16 v[132:133], v2 offset:4624
    ds_read_b64_tr_b16 a[100:101], v2 offset:2584
    ds_read_b64_tr_b16 v[134:135], v2 offset:4632
    s_waitcnt lgkmcnt(0)
    s_nop 0
    v_cndmask_b32 v128, 0, v128, s[70:71]
    v_accvgpr_write_b32 a6, v128
    v_cndmask_b32 v129, 0, v129, s[70:71]
    v_accvgpr_write_b32 a7, v129
    v_cndmask_b32 v130, 0, v130, s[70:71]
    v_accvgpr_write_b32 a38, v130
    v_cndmask_b32 v131, 0, v131, s[70:71]
    v_accvgpr_write_b32 a39, v131
    v_cndmask_b32 v132, 0, v132, s[70:71]
    v_accvgpr_write_b32 a70, v132
    v_cndmask_b32 v133, 0, v133, s[70:71]
    v_accvgpr_write_b32 a71, v133
    v_cndmask_b32 v134, 0, v134, s[70:71]
    v_accvgpr_write_b32 a102, v134
    v_cndmask_b32 v135, 0, v135, s[70:71]
    v_accvgpr_write_b32 a103, v135
    ds_read_b64_tr_b16 a[8:9], v2 offset:5120
    ds_read_b64_tr_b16 v[128:129], v2 offset:7168
    ds_read_b64_tr_b16 a[40:41], v2 offset:5128
    ds_read_b64_tr_b16 v[130:131], v2 offset:7176
    ds_read_b64_tr_b16 a[72:73], v2 offset:5136
    ds_read_b64_tr_b16 v[132:133], v2 offset:7184
    ds_read_b64_tr_b16 a[104:105], v2 offset:5144
    ds_read_b64_tr_b16 v[134:135], v2 offset:7192
    s_waitcnt lgkmcnt(0)
    s_nop 0
    v_cndmask_b32 v128, 0, v128, s[70:71]
    v_accvgpr_write_b32 a10, v128
    v_cndmask_b32 v129, 0, v129, s[70:71]
    v_accvgpr_write_b32 a11, v129
    v_cndmask_b32 v130, 0, v130, s[70:71]
    v_accvgpr_write_b32 a42, v130
    v_cndmask_b32 v131, 0, v131, s[70:71]
    v_accvgpr_write_b32 a43, v131
    v_cndmask_b32 v132, 0, v132, s[70:71]
    v_accvgpr_write_b32 a74, v132
    v_cndmask_b32 v133, 0, v133, s[70:71]
    v_accvgpr_write_b32 a75, v133
    v_cndmask_b32 v134, 0, v134, s[70:71]
    v_accvgpr_write_b32 a106, v134
    v_cndmask_b32 v135, 0, v135, s[70:71]
    v_accvgpr_write_b32 a107, v135
    ds_read_b64_tr_b16 a[12:13], v2 offset:7680
    ds_read_b64_tr_b16 v[128:129], v2 offset:9728
    ds_read_b64_tr_b16 a[44:45], v2 offset:7688
    ds_read_b64_tr_b16 v[130:131], v2 offset:9736
    ds_read_b64_tr_b16 a[76:77], v2 offset:7696
    ds_read_b64_tr_b16 v[132:133], v2 offset:9744
    ds_read_b64_tr_b16 a[108:109], v2 offset:7704
    ds_read_b64_tr_b16 v[134:135], v2 offset:9752
    s_waitcnt lgkmcnt(0)
    s_nop 0
    v_cndmask_b32 v128, 0, v128, s[70:71]
    v_accvgpr_write_b32 a14, v128
    v_cndmask_b32 v129, 0, v129, s[70:71]
    v_accvgpr_write_b32 a15, v129
    v_cndmask_b32 v130, 0, v130, s[70:71]
    v_accvgpr_write_b32 a46, v130
    v_cndmask_b32 v131, 0, v131, s[70:71]
    v_accvgpr_write_b32 a47, v131
    v_cndmask_b32 v132, 0, v132, s[70:71]
    v_accvgpr_write_b32 a78, v132
    v_cndmask_b32 v133, 0, v133, s[70:71]
    v_accvgpr_write_b32 a79, v133
    v_cndmask_b32 v134, 0, v134, s[70:71]
    v_accvgpr_write_b32 a110, v134
    v_cndmask_b32 v135, 0, v135, s[70:71]
    v_accvgpr_write_b32 a111, v135
    ds_read_b64_tr_b16 a[16:17], v2 offset:10240
    ds_read_b64_tr_b16 v[128:129], v2 offset:12288
    ds_read_b64_tr_b16 a[48:49], v2 offset:10248
    ds_read_b64_tr_b16 v[130:131], v2 offset:12296
    ds_read_b64_tr_b16 a[80:81], v2 offset:10256
    ds_read_b64_tr_b16 v[132:133], v2 offset:12304
    ds_read_b64_tr_b16 a[112:113], v2 offset:10264
    ds_read_b64_tr_b16 v[134:135], v2 offset:12312
    s_waitcnt lgkmcnt(0)
    s_nop 0
    v_cndmask_b32 v128, 0, v128, s[70:71]
    v_accvgpr_write_b32 a18, v128
    v_cndmask_b32 v129, 0, v129, s[70:71]
    v_accvgpr_write_b32 a19, v129
    v_cndmask_b32 v130, 0, v130, s[70:71]
    v_accvgpr_write_b32 a50, v130
    v_cndmask_b32 v131, 0, v131, s[70:71]
    v_accvgpr_write_b32 a51, v131
    v_cndmask_b32 v132, 0, v132, s[70:71]
    v_accvgpr_write_b32 a82, v132
    v_cndmask_b32 v133, 0, v133, s[70:71]
    v_accvgpr_write_b32 a83, v133
    v_cndmask_b32 v134, 0, v134, s[70:71]
    v_accvgpr_write_b32 a114, v134
    v_cndmask_b32 v135, 0, v135, s[70:71]
    v_accvgpr_write_b32 a115, v135
    ds_read_b64_tr_b16 a[20:21], v2 offset:12800
    ds_read_b64_tr_b16 v[128:129], v2 offset:14848
    ds_read_b64_tr_b16 a[52:53], v2 offset:12808
    ds_read_b64_tr_b16 v[130:131], v2 offset:14856
    ds_read_b64_tr_b16 a[84:85], v2 offset:12816
    ds_read_b64_tr_b16 v[132:133], v2 offset:14864
    ds_read_b64_tr_b16 a[116:117], v2 offset:12824
    ds_read_b64_tr_b16 v[134:135], v2 offset:14872
    s_waitcnt lgkmcnt(0)
    s_nop 0
    v_cndmask_b32 v128, 0, v128, s[70:71]
    v_accvgpr_write_b32 a22, v128
    v_cndmask_b32 v129, 0, v129, s[70:71]
    v_accvgpr_write_b32 a23, v129
    v_cndmask_b32 v130, 0, v130, s[70:71]
    v_accvgpr_write_b32 a54, v130
    v_cndmask_b32 v131, 0, v131, s[70:71]
    v_accvgpr_write_b32 a55, v131
    v_cndmask_b32 v132, 0, v132, s[70:71]
    v_accvgpr_write_b32 a86, v132
    v_cndmask_b32 v133, 0, v133, s[70:71]
    v_accvgpr_write_b32 a87, v133
    v_cndmask_b32 v134, 0, v134, s[70:71]
    v_accvgpr_write_b32 a118, v134
    v_cndmask_b32 v135, 0, v135, s[70:71]
    v_accvgpr_write_b32 a119, v135
    ds_read_b64_tr_b16 a[24:25], v2 offset:15360
    ds_read_b64_tr_b16 v[128:129], v2 offset:17408
    ds_read_b64_tr_b16 a[56:57], v2 offset:15368
    ds_read_b64_tr_b16 v[130:131], v2 offset:17416
    ds_read_b64_tr_b16 a[88:89], v2 offset:15376
    ds_read_b64_tr_b16 v[132:133], v2 offset:17424
    ds_read_b64_tr_b16 a[120:121], v2 offset:15384
    ds_read_b64_tr_b16 v[134:135], v2 offset:17432
    s_waitcnt lgkmcnt(0)
    s_nop 0
    v_cndmask_b32 v128, 0, v128, s[70:71]
    v_accvgpr_write_b32 a26, v128
    v_cndmask_b32 v129, 0, v129, s[70:71]
    v_accvgpr_write_b32 a27, v129
    v_cndmask_b32 v130, 0, v130, s[70:71]
    v_accvgpr_write_b32 a58, v130
    v_cndmask_b32 v131, 0, v131, s[70:71]
    v_accvgpr_write_b32 a59, v131
    v_cndmask_b32 v132, 0, v132, s[70:71]
    v_accvgpr_write_b32 a90, v132
    v_cndmask_b32 v133, 0, v133, s[70:71]
    v_accvgpr_write_b32 a91, v133
    v_cndmask_b32 v134, 0, v134, s[70:71]
    v_accvgpr_write_b32 a122, v134
    v_cndmask_b32 v135, 0, v135, s[70:71]
    v_accvgpr_write_b32 a123, v135
    ds_read_b64_tr_b16 a[28:29], v2 offset:17920
    ds_read_b64_tr_b16 v[128:129], v2 offset:19968
    ds_read_b64_tr_b16 a[60:61], v2 offset:17928
    ds_read_b64_tr_b16 v[130:131], v2 offset:19976
    ds_read_b64_tr_b16 a[92:93], v2 offset:17936
    ds_read_b64_tr_b16 v[132:133], v2 offset:19984
    ds_read_b64_tr_b16 a[124:125], v2 offset:17944
    ds_read_b64_tr_b16 v[134:135], v2 offset:19992
    s_waitcnt lgkmcnt(0)
    s_nop 0
    v_cndmask_b32 v128, 0, v128, s[70:71]
    v_accvgpr_write_b32 a30, v128
    v_cndmask_b32 v129, 0, v129, s[70:71]
    v_accvgpr_write_b32 a31, v129
    v_cndmask_b32 v130, 0, v130, s[70:71]
    v_accvgpr_write_b32 a62, v130
    v_cndmask_b32 v131, 0, v131, s[70:71]
    v_accvgpr_write_b32 a63, v131
    v_cndmask_b32 v132, 0, v132, s[70:71]
    v_accvgpr_write_b32 a94, v132
    v_cndmask_b32 v133, 0, v133, s[70:71]
    v_accvgpr_write_b32 a95, v133
    v_cndmask_b32 v134, 0, v134, s[70:71]
    v_accvgpr_write_b32 a126, v134
    v_cndmask_b32 v135, 0, v135, s[70:71]
    v_accvgpr_write_b32 a127, v135
    v_lshlrev_b32 v4, 2, v0
    s_mov_b32 s68, 0
    s_mov_b32 s52, 12288
    s_mov_b32 s53, 12544
b3p_56:
    buffer_load_dword v5, v4, s[48:51], s52 offen sc1
    buffer_load_dword v6, v4, s[48:51], s53 offen sc1
    s_waitcnt vmcnt(0)
    v_cmp_ne_u32 vcc, 1, v5
    v_cmp_ne_u32 s[54:55], 16, v6
    s_or_b64 vcc, vcc, s[54:55]
    s_cbranch_vccz b3ok_57
    s_add_u32 s68, s68, 1
    s_cmp_lt_u32 s68, 400000
    s_cbranch_scc0 k_fail
    s_sleep 8
    s_branch b3p_56
b3ok_57:
    s_lshl_b32 s52, s28, 16
    s_add_u32 s52, s52, 0
    s_add_u32 s53, s52, 4096
    buffer_load_dwordx4 v[128:131], v1, s[40:43], s52 offen offset:0 sc1
    buffer_load_dwordx4 v[144:147], v1, s[40:43], s53 offen offset:0 sc1
    buffer_load_dwordx4 v[132:135], v1, s[40:43], s52 offen offset:1024 sc1
    buffer_load_dwordx4 v[148:151], v1, s[40:43], s53 offen offset:1024 sc1
    buffer_load_dwordx4 v[136:139], v1, s[40:43], s52 offen offset:2048 sc1
    buffer_load_dwordx4 v[152:155], v1, s[40:43], s53 offen offset:2048 sc1
    buffer_load_dwordx4 v[140:143], v1, s[40:43], s52 offen offset:3072 sc1
    buffer_load_dwordx4 v[156:159], v1, s[40:43], s53 offen offset:3072 sc1
    s_waitcnt vmcnt(0)
    v_add_f32 v128, v128, v144
    v_add_f32 v129, v129, v145
    v_add_f32 v130, v130, v146
    v_add_f32 v131, v131, v147
    v_add_f32 v132, v132, v148
    v_add_f32 v133, v133, v149
    v_add_f32 v134, v134, v150
    v_add_f32 v135, v135, v151
    v_add_f32 v136, v136, v152
    v_add_f32 v137, v137, v153
    v_add_f32 v138, v138, v154
    v_add_f32 v139, v139, v155
    v_add_f32 v140, v140, v156
    v_add_f32 v141, v141, v157
    v_add_f32 v142, v142, v158
    v_add_f32_e64 v143, v143, v159
    v_cvt_pk_bf16_f32 v144, v128, v129
    v_cvt_pk_bf16_f32 v145, v130, v131
    v_cvt_pk_bf16_f32 v146, v136, v137
    v_cvt_pk_bf16_f32 v147, v138, v139
    v_cndmask_b32 v146, 0, v146, s[70:71]
    v_cndmask_b32 v147, 0, v147, s[70:71]
    v_accvgpr_write_b32 a128, v144
    v_accvgpr_write_b32 a129, v145
    v_accvgpr_write_b32 a130, v146
    v_accvgpr_write_b32 a131, v147
    v_cvt_pk_bf16_f32 v144, v132, v133
    v_cvt_pk_bf16_f32 v145, v134, v135
    v_cvt_pk_bf16_f32 v146, v140, v141
    v_cvt_pk_bf16_f32 v147, v142, v143
    v_cndmask_b32 v146, 0, v146, s[70:71]
    v_cndmask_b32 v147, 0, v147, s[70:71]
    v_accvgpr_write_b32 a132, v144
    v_accvgpr_write_b32 a133, v145
    v_accvgpr_write_b32 a134, v146
    v_accvgpr_write_b32 a135, v147
    v_mov_b32_dpp v148, v132 row_newbcast:4 row_mask:0xf bank_mask:0xf
    v_mov_b32_dpp v152, v140 row_newbcast:4 row_mask:0xf bank_mask:0xf
    v_mov_b32_dpp v149, v133 row_newbcast:4 row_mask:0xf bank_mask:0xf
    v_mov_b32_dpp v153, v141 row_newbcast:4 row_mask:0xf bank_mask:0xf
    v_mov_b32_dpp v150, v134 row_newbcast:4 row_mask:0xf bank_mask:0xf
    v_mov_b32_dpp v154, v142 row_newbcast:4 row_mask:0xf bank_mask:0xf
    v_mov_b32_dpp v151, v135 row_newbcast:4 row_mask:0xf bank_mask:0xf
    v_mov_b32_dpp v155, v143 row_newbcast:4 row_mask:0xf bank_mask:0xf
    v_cvt_pk_bf16_f32 v144, v148, v149
    v_cvt_pk_bf16_f32 v145, v150, v151
    v_cvt_pk_bf16_f32 v146, v152, v153
    v_cvt_pk_bf16_f32 v147, v154, v155
    v_cndmask_b32 v146, 0, v146, s[70:71]
    v_cndmask_b32 v147, 0, v147, s[70:71]
    v_accvgpr_write_b32 a136, v144
    v_accvgpr_write_b32 a137, v145
    v_accvgpr_write_b32 a138, v146
    v_accvgpr_write_b32 a139, v147
    s_lshl_b32 s52, s28, 16
    s_add_u32 s52, s52, 8192
    s_add_u32 s53, s52, 4096
    buffer_load_dwordx4 v[128:131], v1, s[40:43], s52 offen offset:0 sc1
    buffer_load_dwordx4 v[144:147], v1, s[40:43], s53 offen offset:0 sc1
    buffer_load_dwordx4 v[132:135], v1, s[40:43], s52 offen offset:1024 sc1
    buffer_load_dwordx4 v[148:151], v1, s[40:43], s53 offen offset:1024 sc1
    buffer_load_dwordx4 v[136:139], v1, s[40:43], s52 offen offset:2048 sc1
    buffer_load_dwordx4 v[152:155], v1, s[40:43], s53 offen offset:2048 sc1
    buffer_load_dwordx4 v[140:143], v1, s[40:43], s52 offen offset:3072 sc1
    buffer_load_dwordx4 v[156:159], v1, s[40:43], s53 offen offset:3072 sc1
    s_waitcnt vmcnt(0)
    v_add_f32 v128, v128, v144
    v_add_f32 v129, v129, v145
    v_add_f32 v130, v130, v146
    v_add_f32 v131, v131, v147
    v_add_f32 v132, v132, v148
    v_add_f32 v133, v133, v149
    v_add_f32 v134, v134, v150
    v_add_f32 v135, v135, v151
    v_add_f32 v136, v136, v152
    v_add_f32 v137, v137, v153
    v_add_f32 v138, v138, v154
    v_add_f32 v139, v139, v155
    v_add_f32 v140, v140, v156
    v_add_f32 v141, v141, v157
    v_add_f32 v142, v142, v158
    v_add_f32 v143, v143, v159
    v_cvt_pk_bf16_f32 v144, v128, v129
    v_cvt_pk_bf16_f32 v145, v130, v131
    v_cvt_pk_bf16_f32 v146, v136, v137
    v_cvt_pk_bf16_f32 v147, v138, v139
    v_cndmask_b32 v146, 0, v146, s[70:71]
    v_cndmask_b32 v147, 0, v147, s[70:71]
    v_accvgpr_write_b32 a140, v144
    v_accvgpr_write_b32 a141, v145
    v_accvgpr_write_b32 a142, v146
    v_accvgpr_write_b32 a143, v147
    v_cvt_pk_bf16_f32 v144, v132, v133
    v_cvt_pk_bf16_f32 v145, v134, v135
    v_cvt_pk_bf16_f32 v146, v140, v141
    v_cvt_pk_bf16_f32 v147, v142, v143
    v_cndmask_b32 v146, 0, v146, s[70:71]
    v_cndmask_b32 v147, 0, v147, s[70:71]
    v_accvgpr_write_b32 a144, v144
    v_accvgpr_write_b32 a145, v145
    v_accvgpr_write_b32 a146, v146
    v_accvgpr_write_b32 a147, v147
    v_mov_b32_dpp v148, v132 row_newbcast:4 row_mask:0xf bank_mask:0xf
    v_mov_b32_dpp v152, v140 row_newbcast:4 row_mask:0xf bank_mask:0xf
    v_mov_b32_dpp v149, v133 row_newbcast:4 row_mask:0xf bank_mask:0xf
    v_mov_b32_dpp v153, v141 row_newbcast:4 row_mask:0xf bank_mask:0xf
    v_mov_b32_dpp v150, v134 row_newbcast:4 row_mask:0xf bank_mask:0xf
    v_mov_b32_dpp v154, v142 row_newbcast:4 row_mask:0xf bank_mask:0xf
    v_mov_b32_dpp v151, v135 row_newbcast:4 row_mask:0xf bank_mask:0xf
    v_mov_b32_dpp v155, v143 row_newbcast:4 row_mask:0xf bank_mask:0xf
    v_cvt_pk_bf16_f32 v144, v148, v149
    v_cvt_pk_bf16_f32 v145, v150, v151
    v_cvt_pk_bf16_f32 v146, v152, v153
    v_cvt_pk_bf16_f32 v147, v154, v155
    v_cndmask_b32 v146, 0, v146, s[70:71]
    v_cndmask_b32 v147, 0, v147, s[70:71]
    v_accvgpr_write_b32 a148, v144
    v_accvgpr_write_b32 a149, v145
    v_accvgpr_write_b32 a150, v146
    v_accvgpr_write_b32 a151, v147
    s_lshl_b32 s52, s28, 16
    s_add_u32 s52, s52, 16384
    s_add_u32 s53, s52, 4096
    buffer_load_dwordx4 v[128:131], v1, s[40:43], s52 offen offset:0 sc1
    buffer_load_dwordx4 v[144:147], v1, s[40:43], s53 offen offset:0 sc1
    buffer_load_dwordx4 v[132:135], v1, s[40:43], s52 offen offset:1024 sc1
    buffer_load_dwordx4 v[148:151], v1, s[40:43], s53 offen offset:1024 sc1
    buffer_load_dwordx4 v[136:139], v1, s[40:43], s52 offen offset:2048 sc1
    buffer_load_dwordx4 v[152:155], v1, s[40:43], s53 offen offset:2048 sc1
    buffer_load_dwordx4 v[140:143], v1, s[40:43], s52 offen offset:3072 sc1
    buffer_load_dwordx4 v[156:159], v1, s[40:43], s53 offen offset:3072 sc1
    s_waitcnt vmcnt(0)
    v_add_f32 v128, v128, v144
    v_add_f32 v129, v129, v145
    v_add_f32 v130, v130, v146
    v_add_f32 v131, v131, v147
    v_add_f32 v132, v132, v148
    v_add_f32 v133, v133, v149
    v_add_f32 v134, v134, v150
    v_add_f32 v135, v135, v151
    v_add_f32 v136, v136, v152
    v_add_f32 v137, v137, v153
    v_add_f32 v138, v138, v154
    v_add_f32 v139, v139, v155
    v_add_f32 v140, v140, v156
    v_add_f32 v141, v141, v157
    v_add_f32 v142, v142, v158
    v_add_f32 v143, v143, v159
    v_cvt_pk_bf16_f32 v144, v128, v129
    v_cvt_pk_bf16_f32 v145, v130, v131
    v_cvt_pk_bf16_f32 v146, v136, v137
    v_cvt_pk_bf16_f32 v147, v138, v139
    v_cndmask_b32 v146, 0, v146, s[70:71]
    v_cndmask_b32 v147, 0, v147, s[70:71]
    v_accvgpr_write_b32 a152, v144
    v_accvgpr_write_b32 a153, v145
    v_accvgpr_write_b32 a154, v146
    v_accvgpr_write_b32 a155, v147
    v_cvt_pk_bf16_f32 v144, v132, v133
    v_cvt_pk_bf16_f32 v145, v134, v135
    v_cvt_pk_bf16_f32 v146, v140, v141
    v_cvt_pk_bf16_f32 v147, v142, v143
    v_cndmask_b32 v146, 0, v146, s[70:71]
    v_cndmask_b32 v147, 0, v147, s[70:71]
    v_accvgpr_write_b32 a156, v144
    v_accvgpr_write_b32 a157, v145
    v_accvgpr_write_b32 a158, v146
    v_accvgpr_write_b32 a159, v147
    v_mov_b32_dpp v148, v132 row_newbcast:4 row_mask:0xf bank_mask:0xf
    v_mov_b32_dpp v152, v140 row_newbcast:4 row_mask:0xf bank_mask:0xf
    v_mov_b32_dpp v149, v133 row_newbcast:4 row_mask:0xf bank_mask:0xf
    v_mov_b32_dpp v153, v141 row_newbcast:4 row_mask:0xf bank_mask:0xf
    v_mov_b32_dpp v150, v134 row_newbcast:4 row_mask:0xf bank_mask:0xf
    v_mov_b32_dpp v154, v142 row_newbcast:4 row_mask:0xf bank_mask:0xf
    v_mov_b32_dpp v151, v135 row_newbcast:4 row_mask:0xf bank_mask:0xf
    v_mov_b32_dpp v155, v143 row_newbcast:4 row_mask:0xf bank_mask:0xf
    v_cvt_pk_bf16_f32 v144, v148, v149
    v_cvt_pk_bf16_f32 v145, v150, v151
    v_cvt_pk_bf16_f32 v146, v152, v153
    v_cvt_pk_bf16_f32 v147, v154, v155
    v_cndmask_b32 v146, 0, v146, s[70:71]
    v_cndmask_b32 v147, 0, v147, s[70:71]
    v_accvgpr_write_b32 a160, v144
    v_accvgpr_write_b32 a161, v145
    v_accvgpr_write_b32 a162, v146
    v_accvgpr_write_b32 a163, v147
    s_lshl_b32 s52, s28, 16
    s_add_u32 s52, s52, 24576
    s_add_u32 s53, s52, 4096
    buffer_load_dwordx4 v[128:131], v1, s[40:43], s52 offen offset:0 sc1
    buffer_load_dwordx4 v[144:147], v1, s[40:43], s53 offen offset:0 sc1
    buffer_load_dwordx4 v[132:135], v1, s[40:43], s52 offen offset:1024 sc1
    buffer_load_dwordx4 v[148:151], v1, s[40:43], s53 offen offset:1024 sc1
    buffer_load_dwordx4 v[136:139], v1, s[40:43], s52 offen offset:2048 sc1
    buffer_load_dwordx4 v[152:155], v1, s[40:43], s53 offen offset:2048 sc1
    buffer_load_dwordx4 v[140:143], v1, s[40:43], s52 offen offset:3072 sc1
    buffer_load_dwordx4 v[156:159], v1, s[40:43], s53 offen offset:3072 sc1
    s_waitcnt vmcnt(0)
    v_add_f32 v128, v128, v144
    v_add_f32 v129, v129, v145
    v_add_f32 v130, v130, v146
    v_add_f32 v131, v131, v147
    v_add_f32 v132, v132, v148
    v_add_f32 v133, v133, v149
    v_add_f32 v134, v134, v150
    v_add_f32 v135, v135, v151
    v_add_f32 v136, v136, v152
    v_add_f32 v137, v137, v153
    v_add_f32 v138, v138, v154
    v_add_f32 v139, v139, v155
    v_add_f32 v140, v140, v156
    v_add_f32 v141, v141, v157
    v_add_f32 v142, v142, v158
    v_add_f32 v143, v143, v159
    v_cvt_pk_bf16_f32 v144, v128, v129
    v_cvt_pk_bf16_f32 v145, v130, v131
    v_cvt_pk_bf16_f32 v146, v136, v137
    v_cvt_pk_bf16_f32 v147, v138, v139
    v_cndmask_b32 v146, 0, v146, s[70:71]
    v_cndmask_b32 v147, 0, v147, s[70:71]
    v_accvgpr_write_b32 a164, v144
    v_accvgpr_write_b32 a165, v145
    v_accvgpr_write_b32 a166, v146
    v_accvgpr_write_b32 a167, v147
    v_cvt_pk_bf16_f32 v144, v132, v133
    v_cvt_pk_bf16_f32 v145, v134, v135
    v_cvt_pk_bf16_f32 v146, v140, v141
    v_cvt_pk_bf16_f32 v147, v142, v143
    v_cndmask_b32 v146, 0, v146, s[70:71]
    v_cndmask_b32 v147, 0, v147, s[70:71]
    v_accvgpr_write_b32 a168, v144
    v_accvgpr_write_b32 a169, v145
    v_accvgpr_write_b32 a170, v146
    v_accvgpr_write_b32 a171, v147
    v_mov_b32_dpp v148, v132 row_newbcast:4 row_mask:0xf bank_mask:0xf
    v_mov_b32_dpp v152, v140 row_newbcast:4 row_mask:0xf bank_mask:0xf
    v_mov_b32_dpp v149, v133 row_newbcast:4 row_mask:0xf bank_mask:0xf
    v_mov_b32_dpp v153, v141 row_newbcast:4 row_mask:0xf bank_mask:0xf
    v_mov_b32_dpp v150, v134 row_newbcast:4 row_mask:0xf bank_mask:0xf
    v_mov_b32_dpp v154, v142 row_newbcast:4 row_mask:0xf bank_mask:0xf
    v_mov_b32_dpp v151, v135 row_newbcast:4 row_mask:0xf bank_mask:0xf
    v_mov_b32_dpp v155, v143 row_newbcast:4 row_mask:0xf bank_mask:0xf
    v_cvt_pk_bf16_f32 v144, v148, v149
    v_cvt_pk_bf16_f32 v145, v150, v151
    v_cvt_pk_bf16_f32 v146, v152, v153
    v_cvt_pk_bf16_f32 v147, v154, v155
    v_cndmask_b32 v146, 0, v146, s[70:71]
    v_cndmask_b32 v147, 0, v147, s[70:71]
    v_accvgpr_write_b32 a172, v144
    v_accvgpr_write_b32 a173, v145
    v_accvgpr_write_b32 a174, v146
    v_accvgpr_write_b32 a175, v147
    s_lshl_b32 s52, s28, 16
    s_add_u32 s52, s52, 32768
    s_add_u32 s53, s52, 4096
    buffer_load_dwordx4 v[128:131], v1, s[40:43], s52 offen offset:0 sc1
    buffer_load_dwordx4 v[144:147], v1, s[40:43], s53 offen offset:0 sc1
    buffer_load_dwordx4 v[132:135], v1, s[40:43], s52 offen offset:1024 sc1
    buffer_load_dwordx4 v[148:151], v1, s[40:43], s53 offen offset:1024 sc1
    buffer_load_dwordx4 v[136:139], v1, s[40:43], s52 offen offset:2048 sc1
    buffer_load_dwordx4 v[152:155], v1, s[40:43], s53 offen offset:2048 sc1
    buffer_load_dwordx4 v[140:143], v1, s[40:43], s52 offen offset:3072 sc1
    buffer_load_dwordx4 v[156:159], v1, s[40:43], s53 offen offset:3072 sc1
    s_waitcnt vmcnt(0)
    v_add_f32 v128, v128, v144
    v_add_f32 v129, v129, v145
    v_add_f32 v130, v130, v146
    v_add_f32 v131, v131, v147
    v_add_f32 v132, v132, v148
    v_add_f32 v133, v133, v149
    v_add_f32 v134, v134, v150
    v_add_f32 v135, v135, v151
    v_add_f32 v136, v136, v152
    v_add_f32 v137, v137, v153
    v_add_f32 v138, v138, v154
    v_add_f32 v139, v139, v155
    v_add_f32 v140, v140, v156
    v_add_f32 v141, v141, v157
    v_add_f32 v142, v142, v158
    v_add_f32 v143, v143, v159
    v_cvt_pk_bf16_f32 v144, v128, v129
    v_cvt_pk_bf16_f32 v145, v130, v131
    v_cvt_pk_bf16_f32 v146, v136, v137
    v_cvt_pk_bf16_f32 v147, v138, v139
    v_cndmask_b32 v146, 0, v146, s[70:71]
    v_cndmask_b32 v147, 0, v147, s[70:71]
    v_accvgpr_write_b32 a176, v144
    v_accvgpr_write_b32 a177, v145
    v_accvgpr_write_b32 a178, v146
    v_accvgpr_write_b32 a179, v147
    v_cvt_pk_bf16_f32 v144, v132, v133
    v_cvt_pk_bf16_f32 v145, v134, v135
    v_cvt_pk_bf16_f32 v146, v140, v141
    v_cvt_pk_bf16_f32 v147, v142, v143
    v_cndmask_b32 v146, 0, v146, s[70:71]
    v_cndmask_b32 v147, 0, v147, s[70:71]
    v_accvgpr_write_b32 a180, v144
    v_accvgpr_write_b32 a181, v145
    v_accvgpr_write_b32 a182, v146
    v_accvgpr_write_b32 a183, v147
    v_mov_b32_dpp v148, v132 row_newbcast:4 row_mask:0xf bank_mask:0xf
    v_mov_b32_dpp v152, v140 row_newbcast:4 row_mask:0xf bank_mask:0xf
    v_mov_b32_dpp v149, v133 row_newbcast:4 row_mask:0xf bank_mask:0xf
    v_mov_b32_dpp v153, v141 row_newbcast:4 row_mask:0xf bank_mask:0xf
    v_mov_b32_dpp v150, v134 row_newbcast:4 row_mask:0xf bank_mask:0xf
    v_mov_b32_dpp v154, v142 row_newbcast:4 row_mask:0xf bank_mask:0xf
    v_mov_b32_dpp v151, v135 row_newbcast:4 row_mask:0xf bank_mask:0xf
    v_mov_b32_dpp v155, v143 row_newbcast:4 row_mask:0xf bank_mask:0xf
    v_cvt_pk_bf16_f32 v144, v148, v149
    v_cvt_pk_bf16_f32 v145, v150, v151
    v_cvt_pk_bf16_f32 v146, v152, v153
    v_cvt_pk_bf16_f32 v147, v154, v155
    v_cndmask_b32 v146, 0, v146, s[70:71]
    v_cndmask_b32 v147, 0, v147, s[70:71]
    v_accvgpr_write_b32 a184, v144
    v_accvgpr_write_b32 a185, v145
    v_accvgpr_write_b32 a186, v146
    v_accvgpr_write_b32 a187, v147
    s_lshl_b32 s52, s28, 16
    s_add_u32 s52, s52, 40960
    s_add_u32 s53, s52, 4096
    buffer_load_dwordx4 v[128:131], v1, s[40:43], s52 offen offset:0 sc1
    buffer_load_dwordx4 v[144:147], v1, s[40:43], s53 offen offset:0 sc1
    buffer_load_dwordx4 v[132:135], v1, s[40:43], s52 offen offset:1024 sc1
    buffer_load_dwordx4 v[148:151], v1, s[40:43], s53 offen offset:1024 sc1
    buffer_load_dwordx4 v[136:139], v1, s[40:43], s52 offen offset:2048 sc1
    buffer_load_dwordx4 v[152:155], v1, s[40:43], s53 offen offset:2048 sc1
    buffer_load_dwordx4 v[140:143], v1, s[40:43], s52 offen offset:3072 sc1
    buffer_load_dwordx4 v[156:159], v1, s[40:43], s53 offen offset:3072 sc1
    s_waitcnt vmcnt(0)
    v_add_f32 v128, v128, v144
    v_add_f32 v129, v129, v145
    v_add_f32 v130, v130, v146
    v_add_f32 v131, v131, v147
    v_add_f32 v132, v132, v148
    v_add_f32 v133, v133, v149
    v_add_f32 v134, v134, v150
    v_add_f32 v135, v135, v151
    v_add_f32 v136, v136, v152
    v_add_f32 v137, v137, v153
    v_add_f32 v138, v138, v154
    v_add_f32 v139, v139, v155
    v_add_f32 v140, v140, v156
    v_add_f32 v141, v141, v157
    v_add_f32 v142, v142, v158
    v_add_f32 v143, v143, v159
    v_cvt_pk_bf16_f32 v144, v128, v129
    v_cvt_pk_bf16_f32 v145, v130, v131
    v_cvt_pk_bf16_f32 v146, v136, v137
    v_cvt_pk_bf16_f32 v147, v138, v139
    v_cndmask_b32 v146, 0, v146, s[70:71]
    v_cndmask_b32 v147, 0, v147, s[70:71]
    v_accvgpr_write_b32 a188, v144
    v_accvgpr_write_b32 a189, v145
    v_accvgpr_write_b32 a190, v146
    v_accvgpr_write_b32 a191, v147
    v_cvt_pk_bf16_f32 v144, v132, v133
    v_cvt_pk_bf16_f32 v145, v134, v135
    v_cvt_pk_bf16_f32 v146, v140, v141
    v_cvt_pk_bf16_f32 v147, v142, v143
    v_cndmask_b32 v146, 0, v146, s[70:71]
    v_cndmask_b32 v147, 0, v147, s[70:71]
    v_accvgpr_write_b32 a192, v144
    v_accvgpr_write_b32 a193, v145
    v_accvgpr_write_b32 a194, v146
    v_accvgpr_write_b32 a195, v147
    v_mov_b32_dpp v148, v132 row_newbcast:4 row_mask:0xf bank_mask:0xf
    v_mov_b32_dpp v152, v140 row_newbcast:4 row_mask:0xf bank_mask:0xf
    v_mov_b32_dpp v149, v133 row_newbcast:4 row_mask:0xf bank_mask:0xf
    v_mov_b32_dpp v153, v141 row_newbcast:4 row_mask:0xf bank_mask:0xf
    v_mov_b32_dpp v150, v134 row_newbcast:4 row_mask:0xf bank_mask:0xf
    v_mov_b32_dpp v154, v142 row_newbcast:4 row_mask:0xf bank_mask:0xf
    v_mov_b32_dpp v151, v135 row_newbcast:4 row_mask:0xf bank_mask:0xf
    v_mov_b32_dpp v155, v143 row_newbcast:4 row_mask:0xf bank_mask:0xf
    v_cvt_pk_bf16_f32 v144, v148, v149
    v_cvt_pk_bf16_f32 v145, v150, v151
    v_cvt_pk_bf16_f32 v146, v152, v153
    v_cvt_pk_bf16_f32 v147, v154, v155
    v_cndmask_b32 v146, 0, v146, s[70:71]
    v_cndmask_b32 v147, 0, v147, s[70:71]
    v_accvgpr_write_b32 a196, v144
    v_accvgpr_write_b32 a197, v145
    v_accvgpr_write_b32 a198, v146
    v_accvgpr_write_b32 a199, v147
    s_lshl_b32 s52, s28, 16
    s_add_u32 s52, s52, 49152
    s_add_u32 s53, s52, 4096
    buffer_load_dwordx4 v[128:131], v1, s[40:43], s52 offen offset:0 sc1
    buffer_load_dwordx4 v[144:147], v1, s[40:43], s53 offen offset:0 sc1
    buffer_load_dwordx4 v[132:135], v1, s[40:43], s52 offen offset:1024 sc1
    buffer_load_dwordx4 v[148:151], v1, s[40:43], s53 offen offset:1024 sc1
    buffer_load_dwordx4 v[136:139], v1, s[40:43], s52 offen offset:2048 sc1
    buffer_load_dwordx4 v[152:155], v1, s[40:43], s53 offen offset:2048 sc1
    buffer_load_dwordx4 v[140:143], v1, s[40:43], s52 offen offset:3072 sc1
    buffer_load_dwordx4 v[156:159], v1, s[40:43], s53 offen offset:3072 sc1
    s_waitcnt vmcnt(0)
    v_add_f32 v128, v128, v144
    v_add_f32 v129, v129, v145
    v_add_f32 v130, v130, v146
    v_add_f32 v131, v131, v147
    v_add_f32 v132, v132, v148
    v_add_f32 v133, v133, v149
    v_add_f32 v134, v134, v150
    v_add_f32 v135, v135, v151
    v_add_f32 v136, v136, v152
    v_add_f32 v137, v137, v153
    v_add_f32 v138, v138, v154
    v_add_f32 v139, v139, v155
    v_add_f32 v140, v140, v156
    v_add_f32 v141, v141, v157
    v_add_f32 v142, v142, v158
    v_add_f32 v143, v143, v159
    v_cvt_pk_bf16_f32 v144, v128, v129
    v_cvt_pk_bf16_f32 v145, v130, v131
    v_cvt_pk_bf16_f32 v146, v136, v137
    v_cvt_pk_bf16_f32 v147, v138, v139
    v_cndmask_b32 v146, 0, v146, s[70:71]
    v_cndmask_b32 v147, 0, v147, s[70:71]
    v_accvgpr_write_b32 a200, v144
    v_accvgpr_write_b32 a201, v145
    v_accvgpr_write_b32 a202, v146
    v_accvgpr_write_b32 a203, v147
    v_cvt_pk_bf16_f32 v144, v132, v133
    v_cvt_pk_bf16_f32 v145, v134, v135
    v_cvt_pk_bf16_f32 v146, v140, v141
    v_cvt_pk_bf16_f32 v147, v142, v143
    v_cndmask_b32 v146, 0, v146, s[70:71]
    v_cndmask_b32 v147, 0, v147, s[70:71]
    v_accvgpr_write_b32 a204, v144
    v_accvgpr_write_b32 a205, v145
    v_accvgpr_write_b32 a206, v146
    v_accvgpr_write_b32 a207, v147
    v_mov_b32_dpp v148, v132 row_newbcast:4 row_mask:0xf bank_mask:0xf
    v_mov_b32_dpp v152, v140 row_newbcast:4 row_mask:0xf bank_mask:0xf
    v_mov_b32_dpp v149, v133 row_newbcast:4 row_mask:0xf bank_mask:0xf
    v_mov_b32_dpp v153, v141 row_newbcast:4 row_mask:0xf bank_mask:0xf
    v_mov_b32_dpp v150, v134 row_newbcast:4 row_mask:0xf bank_mask:0xf
    v_mov_b32_dpp v154, v142 row_newbcast:4 row_mask:0xf bank_mask:0xf
    v_mov_b32_dpp v151, v135 row_newbcast:4 row_mask:0xf bank_mask:0xf
    v_mov_b32_dpp v155, v143 row_newbcast:4 row_mask:0xf bank_mask:0xf
    v_cvt_pk_bf16_f32 v144, v148, v149
    v_cvt_pk_bf16_f32 v145, v150, v151
    v_cvt_pk_bf16_f32 v146, v152, v153
    v_cvt_pk_bf16_f32 v147, v154, v155
    v_cndmask_b32 v146, 0, v146, s[70:71]
    v_cndmask_b32 v147, 0, v147, s[70:71]
    v_accvgpr_write_b32 a208, v144
    v_accvgpr_write_b32 a209, v145
    v_accvgpr_write_b32 a210, v146
    v_accvgpr_write_b32 a211, v147
    s_lshl_b32 s52, s28, 16
    s_add_u32 s52, s52, 57344
    s_add_u32 s53, s52, 4096
    buffer_load_dwordx4 v[128:131], v1, s[40:43], s52 offen offset:0 sc1
    buffer_load_dwordx4 v[144:147], v1, s[40:43], s53 offen offset:0 sc1
    buffer_load_dwordx4 v[132:135], v1, s[40:43], s52 offen offset:1024 sc1
    buffer_load_dwordx4 v[148:151], v1, s[40:43], s53 offen offset:1024 sc1
    buffer_load_dwordx4 v[136:139], v1, s[40:43], s52 offen offset:2048 sc1
    buffer_load_dwordx4 v[152:155], v1, s[40:43], s53 offen offset:2048 sc1
    buffer_load_dwordx4 v[140:143], v1, s[40:43], s52 offen offset:3072 sc1
    buffer_load_dwordx4 v[156:159], v1, s[40:43], s53 offen offset:3072 sc1
    s_waitcnt vmcnt(0)
    v_add_f32 v128, v128, v144
    v_add_f32 v129, v129, v145
    v_add_f32 v130, v130, v146
    v_add_f32 v131, v131, v147
    v_add_f32 v132, v132, v148
    v_add_f32 v133, v133, v149
    v_add_f32 v134, v134, v150
    v_add_f32 v135, v135, v151
    v_add_f32 v136, v136, v152
    v_add_f32 v137, v137, v153
    v_add_f32 v138, v138, v154
    v_add_f32 v139, v139, v155
    v_add_f32 v140, v140, v156
    v_add_f32 v141, v141, v157
    v_add_f32 v142, v142, v158
    v_add_f32 v143, v143, v159
    v_cvt_pk_bf16_f32 v144, v128, v129
    v_cvt_pk_bf16_f32 v145, v130, v131
    v_cvt_pk_bf16_f32 v146, v136, v137
    v_cvt_pk_bf16_f32 v147, v138, v139
    v_cndmask_b32 v146, 0, v146, s[70:71]
    v_cndmask_b32 v147, 0, v147, s[70:71]
    v_accvgpr_write_b32 a212, v144
    v_accvgpr_write_b32 a213, v145
    v_accvgpr_write_b32 a214, v146
    v_accvgpr_write_b32 a215, v147
    v_cvt_pk_bf16_f32 v144, v132, v133
    v_cvt_pk_bf16_f32 v145, v134, v135
    v_cvt_pk_bf16_f32 v146, v140, v141
    v_cvt_pk_bf16_f32 v147, v142, v143
    v_cndmask_b32 v146, 0, v146, s[70:71]
    v_cndmask_b32 v147, 0, v147, s[70:71]
    v_accvgpr_write_b32 a216, v144
    v_accvgpr_write_b32 a217, v145
    v_accvgpr_write_b32 a218, v146
    v_accvgpr_write_b32 a219, v147
    v_mov_b32_dpp v148, v132 row_newbcast:4 row_mask:0xf bank_mask:0xf
    v_mov_b32_dpp v152, v140 row_newbcast:4 row_mask:0xf bank_mask:0xf
    v_mov_b32_dpp v149, v133 row_newbcast:4 row_mask:0xf bank_mask:0xf
    v_mov_b32_dpp v153, v141 row_newbcast:4 row_mask:0xf bank_mask:0xf
    v_mov_b32_dpp v150, v134 row_newbcast:4 row_mask:0xf bank_mask:0xf
    v_mov_b32_dpp v154, v142 row_newbcast:4 row_mask:0xf bank_mask:0xf
    v_mov_b32_dpp v151, v135 row_newbcast:4 row_mask:0xf bank_mask:0xf
    v_mov_b32_dpp v155, v143 row_newbcast:4 row_mask:0xf bank_mask:0xf
    v_cvt_pk_bf16_f32 v144, v148, v149
    v_cvt_pk_bf16_f32 v145, v150, v151
    v_cvt_pk_bf16_f32 v146, v152, v153
    v_cvt_pk_bf16_f32 v147, v154, v155
    v_cndmask_b32 v146, 0, v146, s[70:71]
    v_cndmask_b32 v147, 0, v147, s[70:71]
    v_accvgpr_write_b32 a220, v144
    v_accvgpr_write_b32 a221, v145
    v_accvgpr_write_b32 a222, v146
    v_accvgpr_write_b32 a223, v147
    s_barrier
    v_and_b32 v4, 15, v0
    v_mul_u32_u24 v4, 2560, v4
    v_lshrrev_b32_e64 v5, 4, v0
    v_lshl_add_u32 v3, v5, 5, v4
    s_and_b32 s52, s28, 1
    s_lshl_b32 s52, s52, 4
    s_lshl_b32 s53, s62, 7
    s_add_u32 s67, s52, s53
    s_add_u32 s67, s67, 1280
    s_lshl_b32 s52, s28, 12
    v_add_u32 v12, s52, v1
    s_lshl_b32 s64, s63, 4
    s_mov_b32 s65, 0
    s_mov_b32 s66, 0
    s_lshl_b32 s52, s64, 15
    s_lshl_b32 s53, s28, 13
    s_add_u32 s52, s52, s53
    s_add_u32 s53, s52, 4096
    buffer_load_dwordx4 v[16:19], v1, s[36:39], s52 offen offset:0 sc1
    buffer_load_dwordx4 v[20:23], v1, s[36:39], s52 offen offset:1024 sc1
    buffer_load_dwordx4 v[24:27], v1, s[36:39], s52 offen offset:2048 sc1
    buffer_load_dwordx4 v[28:31], v1, s[36:39], s52 offen offset:3072 sc1
    buffer_load_dwordx4 v[32:35], v1, s[36:39], s53 offen offset:0 sc1
    buffer_load_dwordx4 v[36:39], v1, s[36:39], s53 offen offset:1024 sc1
    buffer_load_dwordx4 v[40:43], v1, s[36:39], s53 offen offset:2048 sc1
    buffer_load_dwordx4 v[44:47], v1, s[36:39], s53 offen offset:3072 sc1
b3loop_58:
    s_add_u32 s56, s64, 1
    s_min_u32 s56, s56, 127
    s_lshl_b32 s52, s56, 15
    s_lshl_b32 s53, s28, 13
    s_add_u32 s52, s52, s53
    s_add_u32 s53, s52, 4096
    buffer_load_dwordx4 v[48:51], v1, s[36:39], s52 offen offset:0 sc1
    buffer_load_dwordx4 v[52:55], v1, s[36:39], s52 offen offset:1024 sc1
    buffer_load_dwordx4 v[56:59], v1, s[36:39], s52 offen offset:2048 sc1
    buffer_load_dwordx4 v[60:63], v1, s[36:39], s52 offen offset:3072 sc1
    buffer_load_dwordx4 v[64:67], v1, s[36:39], s53 offen offset:0 sc1
    buffer_load_dwordx4 v[68:71], v1, s[36:39], s53 offen offset:1024 sc1
    buffer_load_dwordx4 v[72:75], v1, s[36:39], s53 offen offset:2048 sc1
    buffer_load_dwordx4 v[76:79], v1, s[36:39], s53 offen offset:3072 sc1
    s_waitcnt vmcnt(8)
    v_mfma_f32_16x16x32_bf16 v[104:107], a[136:139], v[16:19], 0
    v_mfma_f32_16x16x32_bf16 v[96:99], a[128:131], v[16:19], 0
    v_mfma_f32_16x16x32_bf16 v[100:103], a[132:135], v[16:19], 0
    v_mfma_f32_16x16x32_bf16 v[116:119], a[148:151], v[20:23], 0
    v_mfma_f32_16x16x32_bf16 v[108:111], a[140:143], v[20:23], 0
    v_mfma_f32_16x16x32_bf16 v[112:115], a[144:147], v[20:23], 0
    s_nop 2
    v_add_f32_e64 v4, s72, v104
    v_rcp_f32 v4, v4
    s_nop 0
    v_pk_mul_f32 v[96:97], v[96:97], v[4:5] op_sel_hi:[1,0]
    v_pk_mul_f32 v[98:99], v[98:99], v[4:5] op_sel_hi:[1,0]
    v_pk_mul_f32 v[100:101], v[100:101], v[4:5] op_sel_hi:[1,0]
    v_pk_mul_f32 v[102:103], v[102:103], v[4:5] op_sel_hi:[1,0]
    v_cvt_pk_bf16_f32 v120, v96, v97
    v_cvt_pk_bf16_f32 v121, v98, v99
    v_cvt_pk_bf16_f32 v122, v100, v101
    v_cvt_pk_bf16_f32 v123, v102, v103
    s_nop 1
    v_mfma_f32_16x16x32_bf16 v[80:83], a[0:3], v[120:123], 0
    v_mfma_f32_16x16x32_bf16 v[84:87], a[32:35], v[120:123], 0
    v_mfma_f32_16x16x32_bf16 v[88:91], a[64:67], v[120:123], 0
    v_mfma_f32_16x16x32_bf16 v[92:95], a[96:99], v[120:123], 0
    v_mfma_f32_16x16x32_bf16 v[104:107], a[160:163], v[24:27], 0
    v_mfma_f32_16x16x32_bf16 v[96:99], a[152:155], v[24:27], 0
    v_mfma_f32_16x16x32_bf16 v[100:103], a[156:159], v[24:27], 0
    v_add_f32 v4, s72, v116
    v_rcp_f32 v4, v4
    s_nop 0
    v_pk_mul_f32 v[108:109], v[108:109], v[4:5] op_sel_hi:[1,0]
    v_pk_mul_f32 v[110:111], v[110:111], v[4:5] op_sel_hi:[1,0]
    v_pk_mul_f32 v[112:113], v[112:113], v[4:5] op_sel_hi:[1,0]
    v_pk_mul_f32 v[114:115], v[114:115], v[4:5] op_sel_hi:[1,0]
    v_cvt_pk_bf16_f32 v124, v108, v109
    v_cvt_pk_bf16_f32 v125, v110, v111
    v_cvt_pk_bf16_f32 v126, v112, v113
    v_cvt_pk_bf16_f32 v127, v114, v115
    s_nop 1
    v_mfma_f32_16x16x32_bf16 v[80:83], a[4:7], v[124:127], v[80:83]
    v_mfma_f32_16x16x32_bf16 v[84:87], a[36:39], v[124:127], v[84:87]
    v_mfma_f32_16x16x32_bf16 v[88:91], a[68:71], v[124:127], v[88:91]
    v_mfma_f32_16x16x32_bf16 v[92:95], a[100:103], v[124:127], v[92:95]
    v_mfma_f32_16x16x32_bf16 v[116:119], a[172:175], v[28:31], 0
    v_mfma_f32_16x16x32_bf16 v[108:111], a[164:167], v[28:31], 0
    v_mfma_f32_16x16x32_bf16 v[112:115], a[168:171], v[28:31], 0
    v_add_f32 v4, s72, v104
    v_rcp_f32 v4, v4
    s_nop 0
    v_pk_mul_f32 v[96:97], v[96:97], v[4:5] op_sel_hi:[1,0]
    v_pk_mul_f32 v[98:99], v[98:99], v[4:5] op_sel_hi:[1,0]
    v_pk_mul_f32 v[100:101], v[100:101], v[4:5] op_sel_hi:[1,0]
    v_pk_mul_f32 v[102:103], v[102:103], v[4:5] op_sel_hi:[1,0]
    v_cvt_pk_bf16_f32 v120, v96, v97
    v_cvt_pk_bf16_f32 v121, v98, v99
    v_cvt_pk_bf16_f32 v122, v100, v101
    v_cvt_pk_bf16_f32 v123, v102, v103
    s_nop 1
    v_mfma_f32_16x16x32_bf16 v[80:83], a[8:11], v[120:123], v[80:83]
    v_mfma_f32_16x16x32_bf16 v[84:87], a[40:43], v[120:123], v[84:87]
    v_mfma_f32_16x16x32_bf16 v[88:91], a[72:75], v[120:123], v[88:91]
    v_mfma_f32_16x16x32_bf16 v[92:95], a[104:107], v[120:123], v[92:95]
    v_mfma_f32_16x16x32_bf16 v[104:107], a[184:187], v[32:35], 0
    v_mfma_f32_16x16x32_bf16 v[96:99], a[176:179], v[32:35], 0
    v_mfma_f32_16x16x32_bf16 v[100:103], a[180:183], v[32:35], 0
    v_add_f32 v4, s72, v116
    v_rcp_f32 v4, v4
    s_nop 0
    v_pk_mul_f32 v[108:109], v[108:109], v[4:5] op_sel_hi:[1,0]
    v_pk_mul_f32 v[110:111], v[110:111], v[4:5] op_sel_hi:[1,0]
    v_pk_mul_f32 v[112:113], v[112:113], v[4:5] op_sel_hi:[1,0]
    v_pk_mul_f32 v[114:115], v[114:115], v[4:5] op_sel_hi:[1,0]
    v_cvt_pk_bf16_f32 v124, v108, v109
    v_cvt_pk_bf16_f32 v125, v110, v111
    v_cvt_pk_bf16_f32 v126, v112, v113
    v_cvt_pk_bf16_f32 v127, v114, v115
    s_nop 1
    v_mfma_f32_16x16x32_bf16 v[80:83], a[12:15], v[124:127], v[80:83]
    v_mfma_f32_16x16x32_bf16 v[84:87], a[44:47], v[124:127], v[84:87]
    v_mfma_f32_16x16x32_bf16 v[88:91], a[76:79], v[124:127], v[88:91]
    v_mfma_f32_16x16x32_bf16 v[92:95], a[108:111], v[124:127], v[92:95]
    v_mfma_f32_16x16x32_bf16 v[116:119], a[196:199], v[36:39], 0
    v_mfma_f32_16x16x32_bf16 v[108:111], a[188:191], v[36:39], 0
    v_mfma_f32_16x16x32_bf16 v[112:115], a[192:195], v[36:39], 0
    v_add_f32 v4, s72, v104
    v_rcp_f32 v4, v4
    s_nop 0
    v_pk_mul_f32 v[96:97], v[96:97], v[4:5] op_sel_hi:[1,0]
    v_pk_mul_f32 v[98:99], v[98:99], v[4:5] op_sel_hi:[1,0]
    v_pk_mul_f32 v[100:101], v[100:101], v[4:5] op_sel_hi:[1,0]
    v_pk_mul_f32 v[102:103], v[102:103], v[4:5] op_sel_hi:[1,0]
    v_cvt_pk_bf16_f32 v120, v96, v97
    v_cvt_pk_bf16_f32 v121, v98, v99
    v_cvt_pk_bf16_f32 v122, v100, v101
    v_cvt_pk_bf16_f32 v123, v102, v103
    s_nop 1
    v_mfma_f32_16x16x32_bf16 v[80:83], a[16:19], v[120:123], v[80:83]
    v_mfma_f32_16x16x32_bf16 v[84:87], a[48:51], v[120:123], v[84:87]
    v_mfma_f32_16x16x32_bf16 v[88:91], a[80:83], v[120:123], v[88:91]
    v_mfma_f32_16x16x32_bf16 v[92:95], a[112:115], v[120:123], v[92:95]
    v_mfma_f32_16x16x32_bf16 v[104:107], a[208:211], v[40:43], 0
    v_mfma_f32_16x16x32_bf16 v[96:99], a[200:203], v[40:43], 0
    v_mfma_f32_16x16x32_bf16 v[100:103], a[204:207], v[40:43], 0
    v_add_f32 v4, s72, v116
    v_rcp_f32 v4, v4
    s_nop 0
    v_pk_mul_f32 v[108:109], v[108:109], v[4:5] op_sel_hi:[1,0]
    v_pk_mul_f32 v[110:111], v[110:111], v[4:5] op_sel_hi:[1,0]
    v_pk_mul_f32 v[112:113], v[112:113], v[4:5] op_sel_hi:[1,0]
    v_pk_mul_f32 v[114:115], v[114:115], v[4:5] op_sel_hi:[1,0]
    v_cvt_pk_bf16_f32 v124, v108, v109
    v_cvt_pk_bf16_f32 v125, v110, v111
    v_cvt_pk_bf16_f32 v126, v112, v113
    v_cvt_pk_bf16_f32 v127, v114, v115
    s_nop 1
    v_mfma_f32_16x16x32_bf16 v[80:83], a[20:23], v[124:127], v[80:83]
    v_mfma_f32_16x16x32_bf16 v[84:87], a[52:55], v[124:127], v[84:87]
    v_mfma_f32_16x16x32_bf16 v[88:91], a[84:87], v[124:127], v[88:91]
    v_mfma_f32_16x16x32_bf16 v[92:95], a[116:119], v[124:127], v[92:95]
    v_mfma_f32_16x16x32_bf16 v[116:119], a[220:223], v[44:47], 0
    v_mfma_f32_16x16x32_bf16 v[108:111], a[212:215], v[44:47], 0
    v_mfma_f32_16x16x32_bf16 v[112:115], a[216:219], v[44:47], 0
    v_add_f32 v4, s72, v104
    v_rcp_f32 v4, v4
    s_nop 0
    v_pk_mul_f32 v[96:97], v[96:97], v[4:5] op_sel_hi:[1,0]
    v_pk_mul_f32 v[98:99], v[98:99], v[4:5] op_sel_hi:[1,0]
    v_pk_mul_f32 v[100:101], v[100:101], v[4:5] op_sel_hi:[1,0]
    v_pk_mul_f32 v[102:103], v[102:103], v[4:5] op_sel_hi:[1,0]
    v_cvt_pk_bf16_f32 v120, v96, v97
    v_cvt_pk_bf16_f32 v121, v98, v99
    v_cvt_pk_bf16_f32 v122, v100, v101
    v_cvt_pk_bf16_f32 v123, v102, v103
    s_nop 1
    v_mfma_f32_16x16x32_bf16 v[80:83], a[24:27], v[120:123], v[80:83]
    v_mfma_f32_16x16x32_bf16 v[84:87], a[56:59], v[120:123], v[84:87]
    v_mfma_f32_16x16x32_bf16 v[88:91], a[88:91], v[120:123], v[88:91]
    v_mfma_f32_16x16x32_bf16 v[92:95], a[120:123], v[120:123], v[92:95]
    v_add_f32 v4, s72, v116
    v_rcp_f32 v4, v4
    s_nop 0
    v_pk_mul_f32 v[108:109], v[108:109], v[4:5] op_sel_hi:[1,0]
    v_pk_mul_f32 v[110:111], v[110:111], v[4:5] op_sel_hi:[1,0]
    v_pk_mul_f32 v[112:113], v[112:113], v[4:5] op_sel_hi:[1,0]
    v_pk_mul_f32 v[114:115], v[114:115], v[4:5] op_sel_hi:[1,0]
    v_cvt_pk_bf16_f32 v124, v108, v109
    v_cvt_pk_bf16_f32 v125, v110, v111
    v_cvt_pk_bf16_f32 v126, v112, v113
    v_cvt_pk_bf16_f32 v127, v114, v115
    s_nop 1
    v_mfma_f32_16x16x32_bf16 v[80:83], a[28:31], v[124:127], v[80:83]
    v_mfma_f32_16x16x32_bf16 v[84:87], a[60:63], v[124:127], v[84:87]
    v_mfma_f32_16x16x32_bf16 v[88:91], a[92:95], v[124:127], v[88:91]
    v_mfma_f32_16x16x32_bf16 v[92:95], a[124:127], v[124:127], v[92:95]
    v_add_u32_e64 v4, s66, v12
    s_nop 3
    ds_write_b128 v4, v[80:83] offset:0
    ds_write_b128 v4, v[84:87] offset:1024
    ds_write_b128 v4, v[88:91] offset:2048
    ds_write_b128 v4, v[92:95] offset:3072
    s_waitcnt lgkmcnt(0)
    s_barrier
    s_cmp_ge_u32 s28, 2
    s_cbranch_scc1 b3skip_59
    s_lshl_b32 s52, s28, 11
    s_add_u32 s52, s52, s66
    v_add_u32_e64 v4, s52, v1
    ds_read_b128 v[128:131], v4 offset:0
    ds_read_b128 v[132:135], v4 offset:1024
    ds_read_b128 v[136:139], v4 offset:4096
    ds_read_b128 v[140:143], v4 offset:5120
    ds_read_b128 v[144:147], v4 offset:8192
    ds_read_b128 v[148:151], v4 offset:9216
    ds_read_b128 v[152:155], v4 offset:12288
    ds_read_b128 v[156:159], v4 offset:13312
    s_waitcnt lgkmcnt(0)
    v_add_f32 v128, v128, v136
    v_add_f32 v144, v144, v152
    v_add_f32 v129, v129, v137
    v_add_f32 v145, v145, v153
    v_add_f32 v130, v130, v138
    v_add_f32 v146, v146, v154
    v_add_f32 v131, v131, v139
    v_add_f32 v147, v147, v155
    v_add_f32 v132, v132, v140
    v_add_f32 v148, v148, v156
    v_add_f32 v133, v133, v141
    v_add_f32 v149, v149, v157
    v_add_f32 v134, v134, v142
    v_add_f32 v150, v150, v158
    v_add_f32 v135, v135, v143
    v_add_f32 v151, v151, v159
    v_add_f32 v128, v128, v144
    v_add_f32 v129, v129, v145
    v_add_f32 v130, v130, v146
    v_add_f32 v131, v131, v147
    v_add_f32 v132, v132, v148
    v_add_f32 v133, v133, v149
    v_add_f32 v134, v134, v150
    v_add_f32_e64 v135, v135, v151
    v_cvt_pk_bf16_f32 v136, v128, v129
    v_cvt_pk_bf16_f32 v137, v130, v131
    v_cvt_pk_bf16_f32 v138, v132, v133
    v_cvt_pk_bf16_f32 v139, v134, v135
    s_mul_i32 s52, s64, 40960
    s_add_u32 s52, s52, s67
    buffer_store_dwordx4 v[136:139], v3, s[44:47], s52 offen
    s_waitcnt vmcnt(0)
b3skip_59:
    s_xor_b32 s66, s66, 16384
    s_add_u32 s64, s64, 1
    s_add_u32 s56, s64, 1
    s_min_u32 s56, s56, 127
    s_lshl_b32 s52, s56, 15
    s_lshl_b32 s53, s28, 13
    s_add_u32 s52, s52, s53
    s_add_u32 s53, s52, 4096
    buffer_load_dwordx4 v[16:19], v1, s[36:39], s52 offen offset:0 sc1
    buffer_load_dwordx4 v[20:23], v1, s[36:39], s52 offen offset:1024 sc1
    buffer_load_dwordx4 v[24:27], v1, s[36:39], s52 offen offset:2048 sc1
    buffer_load_dwordx4 v[28:31], v1, s[36:39], s52 offen offset:3072 sc1
    buffer_load_dwordx4 v[32:35], v1, s[36:39], s53 offen offset:0 sc1
    buffer_load_dwordx4 v[36:39], v1, s[36:39], s53 offen offset:1024 sc1
    buffer_load_dwordx4 v[40:43], v1, s[36:39], s53 offen offset:2048 sc1
    buffer_load_dwordx4 v[44:47], v1, s[36:39], s53 offen offset:3072 sc1
    s_waitcnt vmcnt(8)
    v_mfma_f32_16x16x32_bf16 v[104:107], a[136:139], v[48:51], 0
    v_mfma_f32_16x16x32_bf16 v[96:99], a[128:131], v[48:51], 0
    v_mfma_f32_16x16x32_bf16 v[100:103], a[132:135], v[48:51], 0
    v_mfma_f32_16x16x32_bf16 v[116:119], a[148:151], v[52:55], 0
    v_mfma_f32_16x16x32_bf16 v[108:111], a[140:143], v[52:55], 0
    v_mfma_f32_16x16x32_bf16 v[112:115], a[144:147], v[52:55], 0
    s_nop 2
    v_add_f32 v4, s72, v104
    v_rcp_f32 v4, v4
    s_nop 0
    v_pk_mul_f32 v[96:97], v[96:97], v[4:5] op_sel_hi:[1,0]
    v_pk_mul_f32 v[98:99], v[98:99], v[4:5] op_sel_hi:[1,0]
    v_pk_mul_f32 v[100:101], v[100:101], v[4:5] op_sel_hi:[1,0]
    v_pk_mul_f32 v[102:103], v[102:103], v[4:5] op_sel_hi:[1,0]
    v_cvt_pk_bf16_f32 v120, v96, v97
    v_cvt_pk_bf16_f32 v121, v98, v99
    v_cvt_pk_bf16_f32 v122, v100, v101
    v_cvt_pk_bf16_f32 v123, v102, v103
    s_nop 1
    v_mfma_f32_16x16x32_bf16 v[80:83], a[0:3], v[120:123], 0
    v_mfma_f32_16x16x32_bf16 v[84:87], a[32:35], v[120:123], 0
    v_mfma_f32_16x16x32_bf16 v[88:91], a[64:67], v[120:123], 0
    v_mfma_f32_16x16x32_bf16 v[92:95], a[96:99], v[120:123], 0
    v_mfma_f32_16x16x32_bf16 v[104:107], a[160:163], v[56:59], 0
    v_mfma_f32_16x16x32_bf16 v[96:99], a[152:155], v[56:59], 0
    v_mfma_f32_16x16x32_bf16 v[100:103], a[156:159], v[56:59], 0
    v_add_f32 v4, s72, v116
    v_rcp_f32 v4, v4
    s_nop 0
    v_pk_mul_f32 v[108:109], v[108:109], v[4:5] op_sel_hi:[1,0]
    v_pk_mul_f32 v[110:111], v[110:111], v[4:5] op_sel_hi:[1,0]
    v_pk_mul_f32 v[112:113], v[112:113], v[4:5] op_sel_hi:[1,0]
    v_pk_mul_f32 v[114:115], v[114:115], v[4:5] op_sel_hi:[1,0]
    v_cvt_pk_bf16_f32 v124, v108, v109
    v_cvt_pk_bf16_f32 v125, v110, v111
    v_cvt_pk_bf16_f32 v126, v112, v113
    v_cvt_pk_bf16_f32 v127, v114, v115
    s_nop 1
    v_mfma_f32_16x16x32_bf16 v[80:83], a[4:7], v[124:127], v[80:83]
    v_mfma_f32_16x16x32_bf16 v[84:87], a[36:39], v[124:127], v[84:87]
    v_mfma_f32_16x16x32_bf16 v[88:91], a[68:71], v[124:127], v[88:91]
    v_mfma_f32_16x16x32_bf16 v[92:95], a[100:103], v[124:127], v[92:95]
    v_mfma_f32_16x16x32_bf16 v[116:119], a[172:175], v[60:63], 0
    v_mfma_f32_16x16x32_bf16 v[108:111], a[164:167], v[60:63], 0
    v_mfma_f32_16x16x32_bf16 v[112:115], a[168:171], v[60:63], 0
    v_add_f32 v4, s72, v104
    v_rcp_f32 v4, v4
    s_nop 0
    v_pk_mul_f32 v[96:97], v[96:97], v[4:5] op_sel_hi:[1,0]
    v_pk_mul_f32 v[98:99], v[98:99], v[4:5] op_sel_hi:[1,0]
    v_pk_mul_f32 v[100:101], v[100:101], v[4:5] op_sel_hi:[1,0]
    v_pk_mul_f32 v[102:103], v[102:103], v[4:5] op_sel_hi:[1,0]
    v_cvt_pk_bf16_f32 v120, v96, v97
    v_cvt_pk_bf16_f32 v121, v98, v99
    v_cvt_pk_bf16_f32 v122, v100, v101
    v_cvt_pk_bf16_f32 v123, v102, v103
    s_nop 1
    v_mfma_f32_16x16x32_bf16 v[80:83], a[8:11], v[120:123], v[80:83]
    v_mfma_f32_16x16x32_bf16 v[84:87], a[40:43], v[120:123], v[84:87]
    v_mfma_f32_16x16x32_bf16 v[88:91], a[72:75], v[120:123], v[88:91]
    v_mfma_f32_16x16x32_bf16 v[92:95], a[104:107], v[120:123], v[92:95]
    v_mfma_f32_16x16x32_bf16 v[104:107], a[184:187], v[64:67], 0
    v_mfma_f32_16x16x32_bf16 v[96:99], a[176:179], v[64:67], 0
    v_mfma_f32_16x16x32_bf16 v[100:103], a[180:183], v[64:67], 0
    v_add_f32 v4, s72, v116
    v_rcp_f32 v4, v4
    s_nop 0
    v_pk_mul_f32 v[108:109], v[108:109], v[4:5] op_sel_hi:[1,0]
    v_pk_mul_f32 v[110:111], v[110:111], v[4:5] op_sel_hi:[1,0]
    v_pk_mul_f32 v[112:113], v[112:113], v[4:5] op_sel_hi:[1,0]
    v_pk_mul_f32 v[114:115], v[114:115], v[4:5] op_sel_hi:[1,0]
    v_cvt_pk_bf16_f32 v124, v108, v109
    v_cvt_pk_bf16_f32 v125, v110, v111
    v_cvt_pk_bf16_f32 v126, v112, v113
    v_cvt_pk_bf16_f32 v127, v114, v115
    s_nop 1
    v_mfma_f32_16x16x32_bf16 v[80:83], a[12:15], v[124:127], v[80:83]
    v_mfma_f32_16x16x32_bf16 v[84:87], a[44:47], v[124:127], v[84:87]
    v_mfma_f32_16x16x32_bf16 v[88:91], a[76:79], v[124:127], v[88:91]
    v_mfma_f32_16x16x32_bf16 v[92:95], a[108:111], v[124:127], v[92:95]
    v_mfma_f32_16x16x32_bf16 v[116:119], a[196:199], v[68:71], 0
    v_mfma_f32_16x16x32_bf16 v[108:111], a[188:191], v[68:71], 0
    v_mfma_f32_16x16x32_bf16 v[112:115], a[192:195], v[68:71], 0
    v_add_f32 v4, s72, v104
    v_rcp_f32 v4, v4
    s_nop 0
    v_pk_mul_f32 v[96:97], v[96:97], v[4:5] op_sel_hi:[1,0]
    v_pk_mul_f32 v[98:99], v[98:99], v[4:5] op_sel_hi:[1,0]
    v_pk_mul_f32 v[100:101], v[100:101], v[4:5] op_sel_hi:[1,0]
    v_pk_mul_f32 v[102:103], v[102:103], v[4:5] op_sel_hi:[1,0]
    v_cvt_pk_bf16_f32 v120, v96, v97
    v_cvt_pk_bf16_f32 v121, v98, v99
    v_cvt_pk_bf16_f32 v122, v100, v101
    v_cvt_pk_bf16_f32 v123, v102, v103
    s_nop 1
    v_mfma_f32_16x16x32_bf16 v[80:83], a[16:19], v[120:123], v[80:83]
    v_mfma_f32_16x16x32_bf16 v[84:87], a[48:51], v[120:123], v[84:87]
    v_mfma_f32_16x16x32_bf16 v[88:91], a[80:83], v[120:123], v[88:91]
    v_mfma_f32_16x16x32_bf16 v[92:95], a[112:115], v[120:123], v[92:95]
    v_mfma_f32_16x16x32_bf16 v[104:107], a[208:211], v[72:75], 0
    v_mfma_f32_16x16x32_bf16 v[96:99], a[200:203], v[72:75], 0
    v_mfma_f32_16x16x32_bf16 v[100:103], a[204:207], v[72:75], 0
    v_add_f32 v4, s72, v116
    v_rcp_f32 v4, v4
    s_nop 0
    v_pk_mul_f32 v[108:109], v[108:109], v[4:5] op_sel_hi:[1,0]
    v_pk_mul_f32 v[110:111], v[110:111], v[4:5] op_sel_hi:[1,0]
    v_pk_mul_f32 v[112:113], v[112:113], v[4:5] op_sel_hi:[1,0]
    v_pk_mul_f32 v[114:115], v[114:115], v[4:5] op_sel_hi:[1,0]
    v_cvt_pk_bf16_f32 v124, v108, v109
    v_cvt_pk_bf16_f32 v125, v110, v111
    v_cvt_pk_bf16_f32 v126, v112, v113
    v_cvt_pk_bf16_f32 v127, v114, v115
    s_nop 1
    v_mfma_f32_16x16x32_bf16 v[80:83], a[20:23], v[124:127], v[80:83]
    v_mfma_f32_16x16x32_bf16 v[84:87], a[52:55], v[124:127], v[84:87]
    v_mfma_f32_16x16x32_bf16 v[88:91], a[84:87], v[124:127], v[88:91]
    v_mfma_f32_16x16x32_bf16 v[92:95], a[116:119], v[124:127], v[92:95]
    v_mfma_f32_16x16x32_bf16 v[116:119], a[220:223], v[76:79], 0
    v_mfma_f32_16x16x32_bf16 v[108:111], a[212:215], v[76:79], 0
    v_mfma_f32_16x16x32_bf16 v[112:115], a[216:219], v[76:79], 0
    v_add_f32 v4, s72, v104
    v_rcp_f32 v4, v4
    s_nop 0
    v_pk_mul_f32 v[96:97], v[96:97], v[4:5] op_sel_hi:[1,0]
    v_pk_mul_f32 v[98:99], v[98:99], v[4:5] op_sel_hi:[1,0]
    v_pk_mul_f32 v[100:101], v[100:101], v[4:5] op_sel_hi:[1,0]
    v_pk_mul_f32 v[102:103], v[102:103], v[4:5] op_sel_hi:[1,0]
    v_cvt_pk_bf16_f32 v120, v96, v97
    v_cvt_pk_bf16_f32 v121, v98, v99
    v_cvt_pk_bf16_f32 v122, v100, v101
    v_cvt_pk_bf16_f32 v123, v102, v103
    s_nop 1
    v_mfma_f32_16x16x32_bf16 v[80:83], a[24:27], v[120:123], v[80:83]
    v_mfma_f32_16x16x32_bf16 v[84:87], a[56:59], v[120:123], v[84:87]
    v_mfma_f32_16x16x32_bf16 v[88:91], a[88:91], v[120:123], v[88:91]
    v_mfma_f32_16x16x32_bf16 v[92:95], a[120:123], v[120:123], v[92:95]
    v_add_f32 v4, s72, v116
    v_rcp_f32 v4, v4
    s_nop 0
    v_pk_mul_f32 v[108:109], v[108:109], v[4:5] op_sel_hi:[1,0]
    v_pk_mul_f32 v[110:111], v[110:111], v[4:5] op_sel_hi:[1,0]
    v_pk_mul_f32 v[112:113], v[112:113], v[4:5] op_sel_hi:[1,0]
    v_pk_mul_f32 v[114:115], v[114:115], v[4:5] op_sel_hi:[1,0]
    v_cvt_pk_bf16_f32 v124, v108, v109
    v_cvt_pk_bf16_f32 v125, v110, v111
    v_cvt_pk_bf16_f32 v126, v112, v113
    v_cvt_pk_bf16_f32 v127, v114, v115
    s_nop 1
    v_mfma_f32_16x16x32_bf16 v[80:83], a[28:31], v[124:127], v[80:83]
    v_mfma_f32_16x16x32_bf16 v[84:87], a[60:63], v[124:127], v[84:87]
    v_mfma_f32_16x16x32_bf16 v[88:91], a[92:95], v[124:127], v[88:91]
    v_mfma_f32_16x16x32_bf16 v[92:95], a[124:127], v[124:127], v[92:95]
    v_add_u32_e64 v4, s66, v12
    s_nop 3
    ds_write_b128 v4, v[80:83] offset:0
    ds_write_b128 v4, v[84:87] offset:1024
    ds_write_b128 v4, v[88:91] offset:2048
    ds_write_b128 v4, v[92:95] offset:3072
    s_waitcnt lgkmcnt(0)
    s_barrier
    s_cmp_ge_u32 s28, 2
    s_cbranch_scc1 b3skip_60
    s_lshl_b32 s52, s28, 11
    s_add_u32 s52, s52, s66
    v_add_u32_e64 v4, s52, v1
    ds_read_b128 v[128:131], v4 offset:0
    ds_read_b128 v[132:135], v4 offset:1024
    ds_read_b128 v[136:139], v4 offset:4096
    ds_read_b128 v[140:143], v4 offset:5120
    ds_read_b128 v[144:147], v4 offset:8192
    ds_read_b128 v[148:151], v4 offset:9216
    ds_read_b128 v[152:155], v4 offset:12288
    ds_read_b128 v[156:159], v4 offset:13312
    s_waitcnt lgkmcnt(0)
    v_add_f32 v128, v128, v136
    v_add_f32 v144, v144, v152
    v_add_f32 v129, v129, v137
    v_add_f32 v145, v145, v153
    v_add_f32 v130, v130, v138
    v_add_f32 v146, v146, v154
    v_add_f32 v131, v131, v139
    v_add_f32 v147, v147, v155
    v_add_f32 v132, v132, v140
    v_add_f32 v148, v148, v156
    v_add_f32 v133, v133, v141
    v_add_f32 v149, v149, v157
    v_add_f32 v134, v134, v142
    v_add_f32 v150, v150, v158
    v_add_f32 v135, v135, v143
    v_add_f32 v151, v151, v159
    v_add_f32 v128, v128, v144
    v_add_f32 v129, v129, v145
    v_add_f32 v130, v130, v146
    v_add_f32 v131, v131, v147
    v_add_f32 v132, v132, v148
    v_add_f32 v133, v133, v149
    v_add_f32 v134, v134, v150
    v_add_f32_e64 v135, v135, v151
    v_cvt_pk_bf16_f32 v136, v128, v129
    v_cvt_pk_bf16_f32 v137, v130, v131
    v_cvt_pk_bf16_f32 v138, v132, v133
    v_cvt_pk_bf16_f32 v139, v134, v135
    s_mul_i32 s52, s64, 40960
    s_add_u32 s52, s52, s67
    buffer_store_dwordx4 v[136:139], v3, s[44:47], s52 offen
    s_waitcnt vmcnt(0)
b3skip_60:
    s_xor_b32 s66, s66, 16384
    s_add_u32 s64, s64, 1
    s_add_u32 s65, s65, 1
    s_cmp_lt_u32 s65, 8
    s_cbranch_scc1 b3loop_58
    s_waitcnt vmcnt(0)
    s_branch k_exit
k_w5:
    s_add_u32 s32, s26, 0x1000000
    s_addc_u32 s33, s27, 0
    s_and_b32 s33, s33, 0xffff
    s_mov_b32 s34, 0x1000000
    s_mov_b32 s35, 0x20000
    s_mov_b32 s36, s26
    s_mov_b32 s37, s27
    s_and_b32 s37, s37, 0xffff
    s_mov_b32 s38, 0x1000000
    s_mov_b32 s39, 0x20000
    s_add_u32 s40, s26, 0x2000000
    s_addc_u32 s41, s27, 0
    s_and_b32 s41, s41, 0xffff
    s_mov_b32 s42, 0x1000000
    s_mov_b32 s43, 0x20000
    s_add_u32 s44, s26, 0x4000000
    s_addc_u32 s45, s27, 0
    s_and_b32 s45, s45, 0xffff
    s_mov_b32 s46, 0x800000
    s_mov_b32 s47, 0x20000
    s_add_u32 s48, s26, 0x4800000
    s_addc_u32 s49, s27, 0
    s_and_b32 s49, s49, 0xffff
    s_mov_b32 s50, 0x400000
    s_mov_b32 s51, 0x20000
    s_add_u32 s52, s26, 0x3000000
    s_addc_u32 s53, s27, 0
    s_and_b32 s53, s53, 0xffff
    s_mov_b32 s54, 0x1000000
    s_mov_b32 s55, 0x20000
    s_add_u32 s56, s26, 0x5500000
    s_addc_u32 s57, s27, 0
    s_and_b32 s57, s57, 0xffff
    s_mov_b32 s58, 0x8000
    s_mov_b32 s59, 0x20000
    v_lshlrev_b32 v1, 4, v0
    v_lshrrev_b32 v4, 4, v0
    v_and_b32 v5, 15, v0
    v_lshlrev_b32 v2, 4, v5
    v_lshl_add_u32 v2, v4, 2, v2
    v_lshl_add_u32 v6, v4, 2, 0
    v_cmp_le_u32 s[80:81], v6, v5
    v_lshl_add_u32 v6, v4, 2, 1
    v_cmp_le_u32 s[82:83], v6, v5
    v_lshl_add_u32 v6, v4, 2, 2
    v_cmp_le_u32 s[84:85], v6, v5
    v_lshl_add_u32 v6, v4, 2, 3
    v_cmp_le_u32 s[86:87], v6, v5
    v_mov_b32 v12, 0x3f803f80
    v_mov_b32 v13, 0x3f803f80
    v_mov_b32 v14, 0x3f803f80
    v_mov_b32 v15, 0x3f803f80
    v_mov_b32 v129, 0
    v_mov_b32 v131, 0
    v_mov_b32 v133, 0
    v_mov_b32 v135, 0
    v_mov_b32 v137, 0
    v_mov_b32 v139, 0
    v_mov_b32 v141, 0
    v_mov_b32 v143, 0
    v_mov_b32 v169, 0
    v_mov_b32 v175, 0
    v_mov_b32 v166, 0
    v_mov_b32 v167, 0
    s_mov_b32 s76, 0x3e0293ee
    s_mov_b32 s77, 0x3e0293ee
    s_mov_b32 s70, s28
    s_mov_b32 s71, 0
    s_lshl_b32 s75, s29, 2
    s_add_u32 s75, s75, s28
    s_lshl_b32 s75, s75, 2
    s_add_u32 s75, s75, 8192
    s_lshl_b32 s60, s28, 12
    v_add_u32_e64 v3, s60, v1
    v_bfe_u32 v6, v0, 2, 2
    v_lshrrev_b32_e64 v7, 4, v0
    v_lshl_add_u32 v6, v7, 2, v6
    v_lshlrev_b32 v6, 5, v6
    v_and_b32 v7, 3, v0
    v_lshl_add_u32 v6, v7, 3, v6
    v_add_u32 v10, s60, v6
w5loop_61:
    s_lshr_b32 s60, s70, 2
    s_add_u32 s60, s60, 1
    s_lshl_b32 s61, s29, 5
    s_lshl_b32 s62, s28, 2
    s_add_u32 s61, s61, s62
    s_add_u32 s61, s61, 0
    v_lshrrev_b32 v4, 1, v0
    v_lshlrev_b32 v4, 10, v4
    v_and_b32 v5, 1, v0
    v_lshl_add_u32 v4, v5, 4, v4
    s_mov_b32 s78, 0
w5p1_62:
    s_mov_b64 exec, 0x3f
    buffer_load_dword v5, v4, s[56:59], s61 offen sc1
    s_waitcnt vmcnt(0)
    v_cmp_gt_u32 vcc, s60, v5
    s_mov_b64 exec, -1
    s_cbranch_vccz w5p1ok_63
    s_add_u32 s78, s78, 1
    s_cmp_lt_u32 s78, 400000
    s_cbranch_scc0 k_fail
    s_sleep 4
    s_branch w5p1_62
w5p1ok_63:
    s_lshl_b32 s72, s70, 5
    s_add_u32 s72, s72, s29
    s_lshl_b32 s73, s72, 12
    s_lshl_b32 s74, s72, 11
    s_lshl_b32 s72, s72, 13
    s_add_u32 s62, s72, 4096
    buffer_load_dwordx4 v[16:19], v1, s[32:35], s72 offen offset:0 sc1
    buffer_load_dwordx4 v[48:51], v1, s[36:39], s72 offen offset:0 sc1
    buffer_load_dwordx4 v[20:23], v1, s[32:35], s72 offen offset:1024 sc1
    buffer_load_dwordx4 v[52:55], v1, s[36:39], s72 offen offset:1024 sc1
    buffer_load_dwordx4 v[24:27], v1, s[32:35], s72 offen offset:2048 sc1
    buffer_load_dwordx4 v[56:59], v1, s[36:39], s72 offen offset:2048 sc1
    buffer_load_dwordx4 v[28:31], v1, s[32:35], s72 offen offset:3072 sc1
    buffer_load_dwordx4 v[60:63], v1, s[36:39], s72 offen offset:3072 sc1
    buffer_load_dwordx4 v[32:35], v1, s[32:35], s62 offen offset:0 sc1
    buffer_load_dwordx4 v[64:67], v1, s[36:39], s62 offen offset:0 sc1
    buffer_load_dwordx4 v[36:39], v1, s[32:35], s62 offen offset:1024 sc1
    buffer_load_dwordx4 v[68:71], v1, s[36:39], s62 offen offset:1024 sc1
    buffer_load_dwordx4 v[40:43], v1, s[32:35], s62 offen offset:2048 sc1
    buffer_load_dwordx4 v[72:75], v1, s[36:39], s62 offen offset:2048 sc1
    buffer_load_dwordx4 v[44:47], v1, s[32:35], s62 offen offset:3072 sc1
    buffer_load_dwordx4 v[76:79], v1, s[36:39], s62 offen offset:3072 sc1
    buffer_load_dwordx4 v[96:99], v1, s[40:43], s72 offen offset:0 sc1
    buffer_load_dwordx4 v[100:103], v1, s[40:43], s72 offen offset:1024 sc1
    buffer_load_dwordx4 v[104:107], v1, s[40:43], s72 offen offset:2048 sc1
    buffer_load_dwordx4 v[108:111], v1, s[40:43], s72 offen offset:3072 sc1
    buffer_load_dwordx4 v[112:115], v1, s[40:43], s62 offen offset:0 sc1
    buffer_load_dwordx4 v[116:119], v1, s[40:43], s62 offen offset:1024 sc1
    buffer_load_dwordx4 v[120:123], v1, s[40:43], s62 offen offset:2048 sc1
    buffer_load_dwordx4 v[124:127], v1, s[40:43], s62 offen offset:3072 sc1
    s_waitcnt vmcnt(8)
    v_mfma_f32_16x16x32_bf16 v[152:155], v[48:51], v[16:19], 0
    v_mfma_f32_16x16x32_bf16 v[156:159], v[48:51], v[20:23], 0
    v_mfma_f32_16x16x32_bf16 v[160:163], v[52:55], v[20:23], 0
    v_mfma_f32_16x16x32_bf16 v[152:155], v[56:59], v[24:27], v[152:155]
    v_mfma_f32_16x16x32_bf16 v[156:159], v[56:59], v[28:31], v[156:159]
    v_mfma_f32_16x16x32_bf16 v[160:163], v[60:63], v[28:31], v[160:163]
    v_mfma_f32_16x16x32_bf16 v[152:155], v[64:67], v[32:35], v[152:155]
    v_mfma_f32_16x16x32_bf16 v[156:159], v[64:67], v[36:39], v[156:159]
    v_mfma_f32_16x16x32_bf16 v[160:163], v[68:71], v[36:39], v[160:163]
    v_mfma_f32_16x16x32_bf16 v[152:155], v[72:75], v[40:43], v[152:155]
    v_mfma_f32_16x16x32_bf16 v[156:159], v[72:75], v[44:47], v[156:159]
    v_mfma_f32_16x16x32_bf16 v[160:163], v[76:79], v[44:47], v[160:163]
    s_add_u32 s60, s70, 1
    s_lshr_b32 s61, s29, 4
    s_lshl_b32 s61, s61, 7
    s_add_u32 s61, s61, 16384
    s_lshl_b32 s62, s29, 5
    s_add_u32 s62, s62, 17392
    v_lshlrev_b32 v4, 4, v0
    v_add_u32 v4, s62, v4
    v_mov_b32 v5, s61
    v_cmp_eq_u32 vcc, 0, v0
    s_nop 1
    v_cndmask_b32 v4, v4, v5, vcc
    s_mov_b32 s78, 0
w5c_64:
    s_mov_b64 exec, 7
    buffer_load_dword v5, v4, s[56:59], 0 offen sc1
    s_waitcnt vmcnt(0)
    s_mov_b64 exec, -1
    v_readlane_b32 s61, v5, 0
    v_readlane_b32 s62, v5, 1
    v_readlane_b32 s63, v5, 2
    s_min_u32 s62, s62, s63
    s_max_u32 s61, s61, s62
    s_cmp_ge_u32 s61, s60
    s_cbranch_scc1 w5cok_65
    s_add_u32 s78, s78, 1
    s_cmp_lt_u32 s78, 400000
    s_cbranch_scc0 k_fail
    s_cmp_ge_u32 s70, 56
    s_cbranch_scc0 w5long_66
    s_sleep 1
    s_branch w5c_64
w5long_66:
    s_sleep 16
    s_branch w5c_64
w5cok_65:
    buffer_load_dwordx4 v[80:83], v1, s[44:47], s73 offen offset:0 sc1
    buffer_load_dwordx4 v[84:87], v1, s[44:47], s73 offen offset:1024 sc1
    buffer_load_dwordx4 v[88:91], v1, s[44:47], s73 offen offset:2048 sc1
    buffer_load_dwordx4 v[92:95], v1, s[44:47], s73 offen offset:3072 sc1
    buffer_load_dword v128, v2, s[48:51], s74 offen offset:0 sc1
    buffer_load_dword v130, v2, s[48:51], s74 offen offset:256 sc1
    buffer_load_dword v132, v2, s[48:51], s74 offen offset:512 sc1
    buffer_load_dword v134, v2, s[48:51], s74 offen offset:768 sc1
    buffer_load_dword v136, v2, s[48:51], s74 offen offset:1024 sc1
    buffer_load_dword v138, v2, s[48:51], s74 offen offset:1280 sc1
    buffer_load_dword v140, v2, s[48:51], s74 offen offset:1536 sc1
    buffer_load_dword v142, v2, s[48:51], s74 offen offset:1792 sc1
    s_waitcnt vmcnt(8)
    ds_write_b128 v3, v[80:83] offset:0
    ds_write_b128 v3, v[84:87] offset:1024
    ds_write_b128 v3, v[88:91] offset:2048
    ds_write_b128 v3, v[92:95] offset:3072
    s_waitcnt lgkmcnt(0)
    ds_read_b64_tr_b16 v[80:81], v10 offset:0
    ds_read_b64_tr_b16 v[82:83], v10 offset:512
    ds_read_b64_tr_b16 v[84:85], v10 offset:1024
    ds_read_b64_tr_b16 v[86:87], v10 offset:1536
    ds_read_b64_tr_b16 v[88:89], v10 offset:2048
    ds_read_b64_tr_b16 v[90:91], v10 offset:2560
    ds_read_b64_tr_b16 v[92:93], v10 offset:3072
    ds_read_b64_tr_b16 v[94:95], v10 offset:3584
    s_waitcnt lgkmcnt(0)
    s_nop 0
    v_mfma_f32_16x16x32_bf16 v[144:147], v[80:83], v[16:19], 0
    v_mfma_f32_16x16x32_bf16 v[148:151], v[80:83], v[20:23], 0
    v_mfma_f32_16x16x32_bf16 v[144:147], v[84:87], v[24:27], v[144:147]
    v_mfma_f32_16x16x32_bf16 v[148:151], v[84:87], v[28:31], v[148:151]
    v_mfma_f32_16x16x32_bf16 v[144:147], v[88:91], v[32:35], v[144:147]
    v_mfma_f32_16x16x32_bf16 v[148:151], v[88:91], v[36:39], v[148:151]
    v_mfma_f32_16x16x32_bf16 v[144:147], v[92:95], v[40:43], v[144:147]
    v_mfma_f32_16x16x32_bf16 v[148:151], v[92:95], v[44:47], v[148:151]
    v_mov_b32 v11, 0xf149f2ca
    v_cndmask_b32 v152, v11, v152, s[80:81]
    v_cndmask_b32 v153, v11, v153, s[82:83]
    v_cndmask_b32 v154, v11, v154, s[84:85]
    v_cndmask_b32 v155, v11, v155, s[86:87]
    v_cndmask_b32 v160, v11, v160, s[80:81]
    v_cndmask_b32 v161, v11, v161, s[82:83]
    v_cndmask_b32 v162, v11, v162, s[84:85]
    v_cndmask_b32 v163, v11, v163, s[86:87]
    v_max3_f32 v4, v144, v145, v152
    v_max3_f32 v4, v153, v154, v4
    v_max_f32 v4, v155, v4
    v_mov_b32 v5, v4
    s_nop 1
    v_permlane16_swap_b32 v4, v5
    v_max_f32 v4, v4, v5
    v_mov_b32 v5, v4
    s_nop 1
    v_permlane32_swap_b32 v4, v5
    v_max_f32 v4, v4, v5
    v_mul_f32 v4, s76, v4
    v_fma_f32 v144, v144, s76, -v4
    v_fma_f32 v145, v145, s76, -v4
    v_fma_f32 v152, v152, s76, -v4
    v_fma_f32 v153, v153, s76, -v4
    v_fma_f32 v154, v154, s76, -v4
    v_fma_f32 v155, v155, s76, -v4
    v_exp_f32 v144, v144
    v_exp_f32 v145, v145
    v_exp_f32 v152, v152
    v_exp_f32 v153, v153
    v_exp_f32 v154, v154
    v_exp_f32 v155, v155
    v_cvt_pk_bf16_f32 v164, v152, v153
    v_cvt_pk_bf16_f32 v165, v154, v155
    v_cvt_pk_bf16_f32 v168, v144, v145
    v_max3_f32 v4, v148, v149, v156
    v_max3_f32 v4, v157, v158, v4
    v_max3_f32 v4, v159, v160, v4
    v_max3_f32 v4, v161, v162, v4
    v_max_f32 v4, v163, v4
    v_mov_b32 v5, v4
    s_nop 1
    v_permlane16_swap_b32 v4, v5
    v_max_f32 v4, v4, v5
    v_mov_b32 v5, v4
    s_nop 1
    v_permlane32_swap_b32 v4, v5
    v_max_f32 v4, v4, v5
    v_mul_f32 v4, s76, v4
    v_fma_f32 v148, v148, s76, -v4
    v_fma_f32 v149, v149, s76, -v4
    v_fma_f32 v156, v156, s76, -v4
    v_fma_f32 v157, v157, s76, -v4
    v_fma_f32 v158, v158, s76, -v4
    v_fma_f32 v159, v159, s76, -v4
    v_fma_f32 v160, v160, s76, -v4
    v_fma_f32 v161, v161, s76, -v4
    v_fma_f32 v162, v162, s76, -v4
    v_fma_f32 v163, v163, s76, -v4
    v_exp_f32 v148, v148
    v_exp_f32 v149, v149
    v_exp_f32 v156, v156
    v_exp_f32 v157, v157
    v_exp_f32 v158, v158
    v_exp_f32 v159, v159
    v_exp_f32 v160, v160
    v_exp_f32 v161, v161
    v_exp_f32 v162, v162
    v_exp_f32 v163, v163
    v_cvt_pk_bf16_f32 v170, v156, v157
    v_cvt_pk_bf16_f32 v171, v158, v159
    v_cvt_pk_bf16_f32 v172, v160, v161
    v_cvt_pk_bf16_f32 v173, v162, v163
    v_cvt_pk_bf16_f32 v174, v148, v149
    s_waitcnt vmcnt(0)
    v_mfma_f32_16x16x32_bf16 v[176:179], v[12:15], v[164:167], 0
    v_mfma_f32_16x16x32_bf16 v[184:187], v[96:99], v[164:167], 0
    v_mfma_f32_16x16x32_bf16 v[188:191], v[100:103], v[164:167], 0
    v_mfma_f32_16x16x32_bf16 v[192:195], v[104:107], v[164:167], 0
    v_mfma_f32_16x16x32_bf16 v[196:199], v[108:111], v[164:167], 0
    v_mfma_f32_16x16x32_bf16 v[200:203], v[112:115], v[164:167], 0
    v_mfma_f32_16x16x32_bf16 v[204:207], v[116:119], v[164:167], 0
    v_mfma_f32_16x16x32_bf16 v[208:211], v[120:123], v[164:167], 0
    v_mfma_f32_16x16x32_bf16 v[212:215], v[124:127], v[164:167], 0
    v_mfma_f32_16x16x16_bf16 v[176:179], v[12:13], v[168:169], v[176:179]
    v_mfma_f32_16x16x16_bf16 v[184:187], v[128:129], v[168:169], v[184:187]
    v_mfma_f32_16x16x16_bf16 v[188:191], v[130:131], v[168:169], v[188:191]
    v_mfma_f32_16x16x16_bf16 v[192:195], v[132:133], v[168:169], v[192:195]
    v_mfma_f32_16x16x16_bf16 v[196:199], v[134:135], v[168:169], v[196:199]
    v_mfma_f32_16x16x16_bf16 v[200:203], v[136:137], v[168:169], v[200:203]
    v_mfma_f32_16x16x16_bf16 v[204:207], v[138:139], v[168:169], v[204:207]
    v_mfma_f32_16x16x16_bf16 v[208:211], v[140:141], v[168:169], v[208:211]
    v_mfma_f32_16x16x16_bf16 v[212:215], v[142:143], v[168:169], v[212:215]
    v_mfma_f32_16x16x32_bf16 v[180:183], v[12:15], v[170:173], 0
    v_mfma_f32_16x16x32_bf16 v[216:219], v[96:99], v[170:173], 0
    v_mfma_f32_16x16x32_bf16 v[220:223], v[100:103], v[170:173], 0
    v_mfma_f32_16x16x32_bf16 v[224:227], v[104:107], v[170:173], 0
    v_mfma_f32_16x16x32_bf16 v[228:231], v[108:111], v[170:173], 0
    v_mfma_f32_16x16x32_bf16 v[232:235], v[112:115], v[170:173], 0
    v_mfma_f32_16x16x32_bf16 v[236:239], v[116:119], v[170:173], 0
    v_mfma_f32_16x16x32_bf16 v[240:243], v[120:123], v[170:173], 0
    v_mfma_f32_16x16x32_bf16 v[244:247], v[124:127], v[170:173], 0
    v_mfma_f32_16x16x16_bf16 v[180:183], v[12:13], v[174:175], v[180:183]
    v_mfma_f32_16x16x16_bf16 v[216:219], v[128:129], v[174:175], v[216:219]
    v_mfma_f32_16x16x16_bf16 v[220:223], v[130:131], v[174:175], v[220:223]
    v_mfma_f32_16x16x16_bf16 v[224:227], v[132:133], v[174:175], v[224:227]
    v_mfma_f32_16x16x16_bf16 v[228:231], v[134:135], v[174:175], v[228:231]
    v_mfma_f32_16x16x16_bf16 v[232:235], v[136:137], v[174:175], v[232:235]
    v_mfma_f32_16x16x16_bf16 v[236:239], v[138:139], v[174:175], v[236:239]
    v_mfma_f32_16x16x16_bf16 v[240:243], v[140:141], v[174:175], v[240:243]
    v_mfma_f32_16x16x16_bf16 v[244:247], v[142:143], v[174:175], v[244:247]
    s_add_u32 s62, s72, 4096
    v_rcp_f32_e64 v4, v176
    s_nop 0
    v_pk_mul_f32 v[184:185], v[184:185], v[4:5] op_sel_hi:[1,0]
    v_pk_mul_f32 v[186:187], v[186:187], v[4:5] op_sel_hi:[1,0]
    v_pk_mul_f32 v[188:189], v[188:189], v[4:5] op_sel_hi:[1,0]
    v_pk_mul_f32 v[190:191], v[190:191], v[4:5] op_sel_hi:[1,0]
    v_cvt_pk_bf16_f32 v248, v184, v185
    v_cvt_pk_bf16_f32 v249, v186, v187
    v_cvt_pk_bf16_f32 v250, v188, v189
    v_cvt_pk_bf16_f32 v251, v190, v191
    buffer_store_dwordx4 v[248:251], v1, s[52:55], s72 offen offset:0 sc1
    v_pk_mul_f32 v[192:193], v[192:193], v[4:5] op_sel_hi:[1,0]
    v_pk_mul_f32 v[194:195], v[194:195], v[4:5] op_sel_hi:[1,0]
    v_pk_mul_f32 v[196:197], v[196:197], v[4:5] op_sel_hi:[1,0]
    v_pk_mul_f32 v[198:199], v[198:199], v[4:5] op_sel_hi:[1,0]
    v_cvt_pk_bf16_f32 v252, v192, v193
    v_cvt_pk_bf16_f32 v253, v194, v195
    v_cvt_pk_bf16_f32 v254, v196, v197
    v_cvt_pk_bf16_f32 v255, v198, v199
    buffer_store_dwordx4 v[252:255], v1, s[52:55], s72 offen offset:1024 sc1
    v_pk_mul_f32 v[200:201], v[200:201], v[4:5] op_sel_hi:[1,0]
    v_pk_mul_f32 v[202:203], v[202:203], v[4:5] op_sel_hi:[1,0]
    v_pk_mul_f32 v[204:205], v[204:205], v[4:5] op_sel_hi:[1,0]
    v_pk_mul_f32 v[206:207], v[206:207], v[4:5] op_sel_hi:[1,0]
    v_cvt_pk_bf16_f32 v248, v200, v201
    v_cvt_pk_bf16_f32 v249, v202, v203
    v_cvt_pk_bf16_f32 v250, v204, v205
    v_cvt_pk_bf16_f32 v251, v206, v207
    buffer_store_dwordx4 v[248:251], v1, s[52:55], s72 offen offset:2048 sc1
    v_pk_mul_f32 v[208:209], v[208:209], v[4:5] op_sel_hi:[1,0]
    v_pk_mul_f32 v[210:211], v[210:211], v[4:5] op_sel_hi:[1,0]
    v_pk_mul_f32 v[212:213], v[212:213], v[4:5] op_sel_hi:[1,0]
    v_pk_mul_f32 v[214:215], v[214:215], v[4:5] op_sel_hi:[1,0]
    v_cvt_pk_bf16_f32 v252, v208, v209
    v_cvt_pk_bf16_f32 v253, v210, v211
    v_cvt_pk_bf16_f32 v254, v212, v213
    v_cvt_pk_bf16_f32 v255, v214, v215
    buffer_store_dwordx4 v[252:255], v1, s[52:55], s72 offen offset:3072 sc1
    v_rcp_f32 v4, v180
    s_nop 0
    v_pk_mul_f32 v[216:217], v[216:217], v[4:5] op_sel_hi:[1,0]
    v_pk_mul_f32 v[218:219], v[218:219], v[4:5] op_sel_hi:[1,0]
    v_pk_mul_f32 v[220:221], v[220:221], v[4:5] op_sel_hi:[1,0]
    v_pk_mul_f32 v[222:223], v[222:223], v[4:5] op_sel_hi:[1,0]
    v_cvt_pk_bf16_f32 v248, v216, v217
    v_cvt_pk_bf16_f32 v249, v218, v219
    v_cvt_pk_bf16_f32 v250, v220, v221
    v_cvt_pk_bf16_f32 v251, v222, v223
    buffer_store_dwordx4 v[248:251], v1, s[52:55], s62 offen offset:0 sc1
    v_pk_mul_f32 v[224:225], v[224:225], v[4:5] op_sel_hi:[1,0]
    v_pk_mul_f32 v[226:227], v[226:227], v[4:5] op_sel_hi:[1,0]
    v_pk_mul_f32 v[228:229], v[228:229], v[4:5] op_sel_hi:[1,0]
    v_pk_mul_f32 v[230:231], v[230:231], v[4:5] op_sel_hi:[1,0]
    v_cvt_pk_bf16_f32 v252, v224, v225
    v_cvt_pk_bf16_f32 v253, v226, v227
    v_cvt_pk_bf16_f32 v254, v228, v229
    v_cvt_pk_bf16_f32 v255, v230, v231
    buffer_store_dwordx4 v[252:255], v1, s[52:55], s62 offen offset:1024 sc1
    v_pk_mul_f32 v[232:233], v[232:233], v[4:5] op_sel_hi:[1,0]
    v_pk_mul_f32 v[234:235], v[234:235], v[4:5] op_sel_hi:[1,0]
    v_pk_mul_f32 v[236:237], v[236:237], v[4:5] op_sel_hi:[1,0]
    v_pk_mul_f32 v[238:239], v[238:239], v[4:5] op_sel_hi:[1,0]
    v_cvt_pk_bf16_f32 v248, v232, v233
    v_cvt_pk_bf16_f32 v249, v234, v235
    v_cvt_pk_bf16_f32 v250, v236, v237
    v_cvt_pk_bf16_f32 v251, v238, v239
    buffer_store_dwordx4 v[248:251], v1, s[52:55], s62 offen offset:2048 sc1
    v_pk_mul_f32 v[240:241], v[240:241], v[4:5] op_sel_hi:[1,0]
    v_pk_mul_f32 v[242:243], v[242:243], v[4:5] op_sel_hi:[1,0]
    v_pk_mul_f32 v[244:245], v[244:245], v[4:5] op_sel_hi:[1,0]
    v_pk_mul_f32 v[246:247], v[246:247], v[4:5] op_sel_hi:[1,0]
    v_cvt_pk_bf16_f32 v252, v240, v241
    v_cvt_pk_bf16_f32 v253, v242, v243
    v_cvt_pk_bf16_f32 v254, v244, v245
    v_cvt_pk_bf16_f32 v255, v246, v247
    buffer_store_dwordx4 v[252:255], v1, s[52:55], s62 offen offset:3072 sc1
    s_waitcnt vmcnt(0)
    s_add_u32 s71, s71, 1
    v_mov_b32_e64 v4, s71
    v_mov_b32 v5, s75
    s_mov_b64 exec, 1
    buffer_store_dword v4, v5, s[56:59], 0 offen sc1
    s_mov_b64 exec, -1
    s_add_u32 s70, s70, 4
    s_cmp_lt_u32 s71, 16
    s_cbranch_scc1 w5loop_61
    s_waitcnt vmcnt(0)
    s_branch k_exit
k_w6:
    s_sub_u32 s29, s29, 32
    s_mov_b32 s32, s14
    s_mov_b32 s33, s15
    s_and_b32 s33, s33, 0xffff
    s_mov_b32 s34, 0x500000
    s_mov_b32 s35, 0x20000
    s_add_u32 s36, s26, 0x3000000
    s_addc_u32 s37, s27, 0
    s_and_b32 s37, s37, 0xffff
    s_mov_b32 s38, 0x1000000
    s_mov_b32 s39, 0x20000
    s_mov_b32 s40, s22
    s_mov_b32 s41, s23
    s_and_b32 s41, s41, 0xffff
    s_mov_b32 s42, 0x500000
    s_mov_b32 s43, 0x20000
    s_add_u32 s44, s26, 0x5500000
    s_addc_u32 s45, s27, 0
    s_and_b32 s45, s45, 0xffff
    s_mov_b32 s46, 0x8000
    s_mov_b32 s47, 0x20000
    s_mul_hi_u32 s61, s29, 214748365
    s_mul_i32 s48, s61, 20
    s_sub_u32 s60, s29, s48
    v_lshlrev_b32 v1, 4, v0
    v_lshrrev_b32_e64 v4, 2, v0
    v_mul_u32_u24 v4, 1280, v4
    v_and_b32_e64 v5, 3, v0
    v_lshl_add_u32 v4, v5, 4, v4
    v_lshrrev_b32_e64 v5, 4, v0
    v_bfe_u32 v6, v0, 2, 2
    v_lshl_add_u32 v5, v5, 2, v6
    v_lshlrev_b32 v5, 6, v5
    v_and_b32 v6, 3, v0
    v_lshl_add_u32 v2, v6, 4, v5
    s_lshl_b32 s48, s28, 15
    v_add_u32 v2, s48, v2
    s_mul_i32 s49, s28, 1310720
    s_lshl_b32 s50, s60, 6
    s_add_u32 s49, s49, s50
    s_lshl_b32 s50, s28, 15
    s_mov_b32 m0, s50
    s_add_u32 s50, s50, 1024
    buffer_load_dwordx4 v4, s[32:35], s49 offen lds
    s_add_u32 s49, s49, 20480
    s_mov_b32 m0, s50
    s_add_u32 s50, s50, 1024
    buffer_load_dwordx4 v4, s[32:35], s49 offen lds
    s_add_u32 s49, s49, 20480
    s_mov_b32 m0, s50
    s_add_u32 s50, s50, 1024
    buffer_load_dwordx4 v4, s[32:35], s49 offen lds
    s_add_u32 s49, s49, 20480
    s_mov_b32 m0, s50
    s_add_u32 s50, s50, 1024
    buffer_load_dwordx4 v4, s[32:35], s49 offen lds
    s_add_u32 s49, s49, 20480
    s_mov_b32 m0, s50
    s_add_u32 s50, s50, 1024
    buffer_load_dwordx4 v4, s[32:35], s49 offen lds
    s_add_u32 s49, s49, 20480
    s_mov_b32 m0, s50
    s_add_u32 s50, s50, 1024
    buffer_load_dwordx4 v4, s[32:35], s49 offen lds
    s_add_u32 s49, s49, 20480
    s_mov_b32 m0, s50
    s_add_u32 s50, s50, 1024
    buffer_load_dwordx4 v4, s[32:35], s49 offen lds
    s_add_u32 s49, s49, 20480
    s_mov_b32 m0, s50
    s_add_u32 s50, s50, 1024
    buffer_load_dwordx4 v4, s[32:35], s49 offen lds
    s_add_u32 s49, s49, 20480
    s_mov_b32 m0, s50
    s_add_u32 s50, s50, 1024
    buffer_load_dwordx4 v4, s[32:35], s49 offen lds
    s_add_u32 s49, s49, 20480
    s_mov_b32 m0, s50
    s_add_u32 s50, s50, 1024
    buffer_load_dwordx4 v4, s[32:35], s49 offen lds
    s_add_u32 s49, s49, 20480
    s_mov_b32 m0, s50
    s_add_u32 s50, s50, 1024
    buffer_load_dwordx4 v4, s[32:35], s49 offen lds
    s_add_u32 s49, s49, 20480
    s_mov_b32 m0, s50
    s_add_u32 s50, s50, 1024
    buffer_load_dwordx4 v4, s[32:35], s49 offen lds
    s_add_u32 s49, s49, 20480
    s_mov_b32 m0, s50
    s_add_u32 s50, s50, 1024
    buffer_load_dwordx4 v4, s[32:35], s49 offen lds
    s_add_u32 s49, s49, 20480
    s_mov_b32 m0, s50
    s_add_u32 s50, s50, 1024
    buffer_load_dwordx4 v4, s[32:35], s49 offen lds
    s_add_u32 s49, s49, 20480
    s_mov_b32 m0, s50
    s_add_u32 s50, s50, 1024
    buffer_load_dwordx4 v4, s[32:35], s49 offen lds
    s_add_u32 s49, s49, 20480
    s_mov_b32 m0, s50
    s_add_u32 s50, s50, 1024
    buffer_load_dwordx4 v4, s[32:35], s49 offen lds
    s_add_u32 s49, s49, 20480
    s_mov_b32 m0, s50
    s_add_u32 s50, s50, 1024
    buffer_load_dwordx4 v4, s[32:35], s49 offen lds
    s_add_u32 s49, s49, 20480
    s_mov_b32 m0, s50
    s_add_u32 s50, s50, 1024
    buffer_load_dwordx4 v4, s[32:35], s49 offen lds
    s_add_u32 s49, s49, 20480
    s_mov_b32 m0, s50
    s_add_u32 s50, s50, 1024
    buffer_load_dwordx4 v4, s[32:35], s49 offen lds
    s_add_u32 s49, s49, 20480
    s_mov_b32 m0, s50
    s_add_u32 s50, s50, 1024
    buffer_load_dwordx4 v4, s[32:35], s49 offen lds
    s_add_u32 s49, s49, 20480
    s_mov_b32 m0, s50
    s_add_u32 s50, s50, 1024
    buffer_load_dwordx4 v4, s[32:35], s49 offen lds
    s_add_u32 s49, s49, 20480
    s_mov_b32 m0, s50
    s_add_u32 s50, s50, 1024
    buffer_load_dwordx4 v4, s[32:35], s49 offen lds
    s_add_u32 s49, s49, 20480
    s_mov_b32 m0, s50
    s_add_u32 s50, s50, 1024
    buffer_load_dwordx4 v4, s[32:35], s49 offen lds
    s_add_u32 s49, s49, 20480
    s_mov_b32 m0, s50
    s_add_u32 s50, s50, 1024
    buffer_load_dwordx4 v4, s[32:35], s49 offen lds
    s_add_u32 s49, s49, 20480
    s_mov_b32 m0, s50
    s_add_u32 s50, s50, 1024
    buffer_load_dwordx4 v4, s[32:35], s49 offen lds
    s_add_u32 s49, s49, 20480
    s_mov_b32 m0, s50
    s_add_u32 s50, s50, 1024
    buffer_load_dwordx4 v4, s[32:35], s49 offen lds
    s_add_u32 s49, s49, 20480
    s_mov_b32 m0, s50
    s_add_u32 s50, s50, 1024
    buffer_load_dwordx4 v4, s[32:35], s49 offen lds
    s_add_u32 s49, s49, 20480
    s_mov_b32 m0, s50
    s_add_u32 s50, s50, 1024
    buffer_load_dwordx4 v4, s[32:35], s49 offen lds
    s_add_u32 s49, s49, 20480
    s_mov_b32 m0, s50
    s_add_u32 s50, s50, 1024
    buffer_load_dwordx4 v4, s[32:35], s49 offen lds
    s_add_u32 s49, s49, 20480
    s_mov_b32 m0, s50
    s_add_u32 s50, s50, 1024
    buffer_load_dwordx4 v4, s[32:35], s49 offen lds
    s_add_u32 s49, s49, 20480
    s_mov_b32 m0, s50
    s_add_u32 s50, s50, 1024
    buffer_load_dwordx4 v4, s[32:35], s49 offen lds
    s_add_u32 s49, s49, 20480
    s_mov_b32 m0, s50
    s_add_u32 s50, s50, 1024
    buffer_load_dwordx4 v4, s[32:35], s49 offen lds
    s_add_u32 s49, s49, 20480
    s_waitcnt vmcnt(0)
    ds_read_b64_tr_b16 a[0:1], v2 offset:0
    ds_read_b64_tr_b16 a[2:3], v2 offset:1024
    ds_read_b64_tr_b16 a[128:129], v2 offset:8
    ds_read_b64_tr_b16 a[130:131], v2 offset:1032
    ds_read_b64_tr_b16 a[4:5], v2 offset:2048
    ds_read_b64_tr_b16 a[6:7], v2 offset:3072
    ds_read_b64_tr_b16 a[132:133], v2 offset:2056
    ds_read_b64_tr_b16 a[134:135], v2 offset:3080
    ds_read_b64_tr_b16 a[8:9], v2 offset:4096
    ds_read_b64_tr_b16 a[10:11], v2 offset:5120
    ds_read_b64_tr_b16 a[136:137], v2 offset:4104
    ds_read_b64_tr_b16 a[138:139], v2 offset:5128
    ds_read_b64_tr_b16 a[12:13], v2 offset:6144
    ds_read_b64_tr_b16 a[14:15], v2 offset:7168
    ds_read_b64_tr_b16 a[140:141], v2 offset:6152
    ds_read_b64_tr_b16 a[142:143], v2 offset:7176
    s_waitcnt lgkmcnt(0)
    ds_read_b64_tr_b16 a[16:17], v2 offset:8192
    ds_read_b64_tr_b16 a[18:19], v2 offset:9216
    ds_read_b64_tr_b16 a[144:145], v2 offset:8200
    ds_read_b64_tr_b16 a[146:147], v2 offset:9224
    ds_read_b64_tr_b16 a[20:21], v2 offset:10240
    ds_read_b64_tr_b16 a[22:23], v2 offset:11264
    ds_read_b64_tr_b16 a[148:149], v2 offset:10248
    ds_read_b64_tr_b16 a[150:151], v2 offset:11272
    ds_read_b64_tr_b16 a[24:25], v2 offset:12288
    ds_read_b64_tr_b16 a[26:27], v2 offset:13312
    ds_read_b64_tr_b16 a[152:153], v2 offset:12296
    ds_read_b64_tr_b16 a[154:155], v2 offset:13320
    ds_read_b64_tr_b16 a[28:29], v2 offset:14336
    ds_read_b64_tr_b16 a[30:31], v2 offset:15360
    ds_read_b64_tr_b16 a[156:157], v2 offset:14344
    ds_read_b64_tr_b16 a[158:159], v2 offset:15368
    s_waitcnt lgkmcnt(0)
    ds_read_b64_tr_b16 a[32:33], v2 offset:16384
    ds_read_b64_tr_b16 a[34:35], v2 offset:17408
    ds_read_b64_tr_b16 a[160:161], v2 offset:16392
    ds_read_b64_tr_b16 a[162:163], v2 offset:17416
    ds_read_b64_tr_b16 a[36:37], v2 offset:18432
    ds_read_b64_tr_b16 a[38:39], v2 offset:19456
    ds_read_b64_tr_b16 a[164:165], v2 offset:18440
    ds_read_b64_tr_b16 a[166:167], v2 offset:19464
    ds_read_b64_tr_b16 a[40:41], v2 offset:20480
    ds_read_b64_tr_b16 a[42:43], v2 offset:21504
    ds_read_b64_tr_b16 a[168:169], v2 offset:20488
    ds_read_b64_tr_b16 a[170:171], v2 offset:21512
    ds_read_b64_tr_b16 a[44:45], v2 offset:22528
    ds_read_b64_tr_b16 a[46:47], v2 offset:23552
    ds_read_b64_tr_b16 a[172:173], v2 offset:22536
    ds_read_b64_tr_b16 a[174:175], v2 offset:23560
    s_waitcnt lgkmcnt(0)
    ds_read_b64_tr_b16 a[48:49], v2 offset:24576
    ds_read_b64_tr_b16 a[50:51], v2 offset:25600
    ds_read_b64_tr_b16 a[176:177], v2 offset:24584
    ds_read_b64_tr_b16 a[178:179], v2 offset:25608
    ds_read_b64_tr_b16 a[52:53], v2 offset:26624
    ds_read_b64_tr_b16 a[54:55], v2 offset:27648
    ds_read_b64_tr_b16 a[180:181], v2 offset:26632
    ds_read_b64_tr_b16 a[182:183], v2 offset:27656
    ds_read_b64_tr_b16 a[56:57], v2 offset:28672
    ds_read_b64_tr_b16 a[58:59], v2 offset:29696
    ds_read_b64_tr_b16 a[184:185], v2 offset:28680
    ds_read_b64_tr_b16 a[186:187], v2 offset:29704
    ds_read_b64_tr_b16 a[60:61], v2 offset:30720
    ds_read_b64_tr_b16 a[62:63], v2 offset:31744
    ds_read_b64_tr_b16 a[188:189], v2 offset:30728
    ds_read_b64_tr_b16 a[190:191], v2 offset:31752
    s_waitcnt lgkmcnt(0)
    s_mul_i32 s49, s28, 1310720
    s_lshl_b32 s50, s60, 6
    s_add_u32 s49, s49, s50
    s_add_u32 s49, s49, 655360
    s_lshl_b32 s50, s28, 15
    s_mov_b32 m0, s50
    s_add_u32 s50, s50, 1024
    buffer_load_dwordx4 v4, s[32:35], s49 offen lds
    s_add_u32 s49, s49, 20480
    s_mov_b32 m0, s50
    s_add_u32 s50, s50, 1024
    buffer_load_dwordx4 v4, s[32:35], s49 offen lds
    s_add_u32 s49, s49, 20480
    s_mov_b32 m0, s50
    s_add_u32 s50, s50, 1024
    buffer_load_dwordx4 v4, s[32:35], s49 offen lds
    s_add_u32 s49, s49, 20480
    s_mov_b32 m0, s50
    s_add_u32 s50, s50, 1024
    buffer_load_dwordx4 v4, s[32:35], s49 offen lds
    s_add_u32 s49, s49, 20480
    s_mov_b32 m0, s50
    s_add_u32 s50, s50, 1024
    buffer_load_dwordx4 v4, s[32:35], s49 offen lds
    s_add_u32 s49, s49, 20480
    s_mov_b32 m0, s50
    s_add_u32 s50, s50, 1024
    buffer_load_dwordx4 v4, s[32:35], s49 offen lds
    s_add_u32 s49, s49, 20480
    s_mov_b32 m0, s50
    s_add_u32 s50, s50, 1024
    buffer_load_dwordx4 v4, s[32:35], s49 offen lds
    s_add_u32 s49, s49, 20480
    s_mov_b32 m0, s50
    s_add_u32 s50, s50, 1024
    buffer_load_dwordx4 v4, s[32:35], s49 offen lds
    s_add_u32 s49, s49, 20480
    s_mov_b32 m0, s50
    s_add_u32 s50, s50, 1024
    buffer_load_dwordx4 v4, s[32:35], s49 offen lds
    s_add_u32 s49, s49, 20480
    s_mov_b32 m0, s50
    s_add_u32 s50, s50, 1024
    buffer_load_dwordx4 v4, s[32:35], s49 offen lds
    s_add_u32 s49, s49, 20480
    s_mov_b32 m0, s50
    s_add_u32 s50, s50, 1024
    buffer_load_dwordx4 v4, s[32:35], s49 offen lds
    s_add_u32 s49, s49, 20480
    s_mov_b32 m0, s50
    s_add_u32 s50, s50, 1024
    buffer_load_dwordx4 v4, s[32:35], s49 offen lds
    s_add_u32 s49, s49, 20480
    s_mov_b32 m0, s50
    s_add_u32 s50, s50, 1024
    buffer_load_dwordx4 v4, s[32:35], s49 offen lds
    s_add_u32 s49, s49, 20480
    s_mov_b32 m0, s50
    s_add_u32 s50, s50, 1024
    buffer_load_dwordx4 v4, s[32:35], s49 offen lds
    s_add_u32 s49, s49, 20480
    s_mov_b32 m0, s50
    s_add_u32 s50, s50, 1024
    buffer_load_dwordx4 v4, s[32:35], s49 offen lds
    s_add_u32 s49, s49, 20480
    s_mov_b32 m0, s50
    s_add_u32 s50, s50, 1024
    buffer_load_dwordx4 v4, s[32:35], s49 offen lds
    s_add_u32 s49, s49, 20480
    s_mov_b32 m0, s50
    s_add_u32 s50, s50, 1024
    buffer_load_dwordx4 v4, s[32:35], s49 offen lds
    s_add_u32 s49, s49, 20480
    s_mov_b32 m0, s50
    s_add_u32 s50, s50, 1024
    buffer_load_dwordx4 v4, s[32:35], s49 offen lds
    s_add_u32 s49, s49, 20480
    s_mov_b32 m0, s50
    s_add_u32 s50, s50, 1024
    buffer_load_dwordx4 v4, s[32:35], s49 offen lds
    s_add_u32 s49, s49, 20480
    s_mov_b32 m0, s50
    s_add_u32 s50, s50, 1024
    buffer_load_dwordx4 v4, s[32:35], s49 offen lds
    s_add_u32 s49, s49, 20480
    s_mov_b32 m0, s50
    s_add_u32 s50, s50, 1024
    buffer_load_dwordx4 v4, s[32:35], s49 offen lds
    s_add_u32 s49, s49, 20480
    s_mov_b32 m0, s50
    s_add_u32 s50, s50, 1024
    buffer_load_dwordx4 v4, s[32:35], s49 offen lds
    s_add_u32 s49, s49, 20480
    s_mov_b32 m0, s50
    s_add_u32 s50, s50, 1024
    buffer_load_dwordx4 v4, s[32:35], s49 offen lds
    s_add_u32 s49, s49, 20480
    s_mov_b32 m0, s50
    s_add_u32 s50, s50, 1024
    buffer_load_dwordx4 v4, s[32:35], s49 offen lds
    s_add_u32 s49, s49, 20480
    s_mov_b32 m0, s50
    s_add_u32 s50, s50, 1024
    buffer_load_dwordx4 v4, s[32:35], s49 offen lds
    s_add_u32 s49, s49, 20480
    s_mov_b32 m0, s50
    s_add_u32 s50, s50, 1024
    buffer_load_dwordx4 v4, s[32:35], s49 offen lds
    s_add_u32 s49, s49, 20480
    s_mov_b32 m0, s50
    s_add_u32 s50, s50, 1024
    buffer_load_dwordx4 v4, s[32:35], s49 offen lds
    s_add_u32 s49, s49, 20480
    s_mov_b32 m0, s50
    s_add_u32 s50, s50, 1024
    buffer_load_dwordx4 v4, s[32:35], s49 offen lds
    s_add_u32 s49, s49, 20480
    s_mov_b32 m0, s50
    s_add_u32 s50, s50, 1024
    buffer_load_dwordx4 v4, s[32:35], s49 offen lds
    s_add_u32 s49, s49, 20480
    s_mov_b32 m0, s50
    s_add_u32 s50, s50, 1024
    buffer_load_dwordx4 v4, s[32:35], s49 offen lds
    s_add_u32 s49, s49, 20480
    s_mov_b32 m0, s50
    s_add_u32 s50, s50, 1024
    buffer_load_dwordx4 v4, s[32:35], s49 offen lds
    s_add_u32 s49, s49, 20480
    s_mov_b32 m0, s50
    s_add_u32 s50, s50, 1024
    buffer_load_dwordx4 v4, s[32:35], s49 offen lds
    s_add_u32 s49, s49, 20480
    s_waitcnt vmcnt(0)
    ds_read_b64_tr_b16 a[64:65], v2 offset:0
    ds_read_b64_tr_b16 a[66:67], v2 offset:1024
    ds_read_b64_tr_b16 a[192:193], v2 offset:8
    ds_read_b64_tr_b16 a[194:195], v2 offset:1032
    ds_read_b64_tr_b16 a[68:69], v2 offset:2048
    ds_read_b64_tr_b16 a[70:71], v2 offset:3072
    ds_read_b64_tr_b16 a[196:197], v2 offset:2056
    ds_read_b64_tr_b16 a[198:199], v2 offset:3080
    ds_read_b64_tr_b16 a[72:73], v2 offset:4096
    ds_read_b64_tr_b16 a[74:75], v2 offset:5120
    ds_read_b64_tr_b16 a[200:201], v2 offset:4104
    ds_read_b64_tr_b16 a[202:203], v2 offset:5128
    ds_read_b64_tr_b16 a[76:77], v2 offset:6144
    ds_read_b64_tr_b16 a[78:79], v2 offset:7168
    ds_read_b64_tr_b16 a[204:205], v2 offset:6152
    ds_read_b64_tr_b16 a[206:207], v2 offset:7176
    s_waitcnt lgkmcnt(0)
    ds_read_b64_tr_b16 a[80:81], v2 offset:8192
    ds_read_b64_tr_b16 a[82:83], v2 offset:9216
    ds_read_b64_tr_b16 a[208:209], v2 offset:8200
    ds_read_b64_tr_b16 a[210:211], v2 offset:9224
    ds_read_b64_tr_b16 a[84:85], v2 offset:10240
    ds_read_b64_tr_b16 a[86:87], v2 offset:11264
    ds_read_b64_tr_b16 a[212:213], v2 offset:10248
    ds_read_b64_tr_b16 a[214:215], v2 offset:11272
    ds_read_b64_tr_b16 a[88:89], v2 offset:12288
    ds_read_b64_tr_b16 a[90:91], v2 offset:13312
    ds_read_b64_tr_b16 a[216:217], v2 offset:12296
    ds_read_b64_tr_b16 a[218:219], v2 offset:13320
    ds_read_b64_tr_b16 a[92:93], v2 offset:14336
    ds_read_b64_tr_b16 a[94:95], v2 offset:15360
    ds_read_b64_tr_b16 a[220:221], v2 offset:14344
    ds_read_b64_tr_b16 a[222:223], v2 offset:15368
    s_waitcnt lgkmcnt(0)
    ds_read_b64_tr_b16 a[96:97], v2 offset:16384
    ds_read_b64_tr_b16 a[98:99], v2 offset:17408
    ds_read_b64_tr_b16 a[224:225], v2 offset:16392
    ds_read_b64_tr_b16 a[226:227], v2 offset:17416
    ds_read_b64_tr_b16 a[100:101], v2 offset:18432
    ds_read_b64_tr_b16 a[102:103], v2 offset:19456
    ds_read_b64_tr_b16 a[228:229], v2 offset:18440
    ds_read_b64_tr_b16 a[230:231], v2 offset:19464
    ds_read_b64_tr_b16 a[104:105], v2 offset:20480
    ds_read_b64_tr_b16 a[106:107], v2 offset:21504
    ds_read_b64_tr_b16 a[232:233], v2 offset:20488
    ds_read_b64_tr_b16 a[234:235], v2 offset:21512
    ds_read_b64_tr_b16 a[108:109], v2 offset:22528
    ds_read_b64_tr_b16 a[110:111], v2 offset:23552
    ds_read_b64_tr_b16 a[236:237], v2 offset:22536
    ds_read_b64_tr_b16 a[238:239], v2 offset:23560
    s_waitcnt lgkmcnt(0)
    ds_read_b64_tr_b16 a[112:113], v2 offset:24576
    ds_read_b64_tr_b16 a[114:115], v2 offset:25600
    ds_read_b64_tr_b16 a[240:241], v2 offset:24584
    ds_read_b64_tr_b16 a[242:243], v2 offset:25608
    ds_read_b64_tr_b16 a[116:117], v2 offset:26624
    ds_read_b64_tr_b16 a[118:119], v2 offset:27648
    ds_read_b64_tr_b16 a[244:245], v2 offset:26632
    ds_read_b64_tr_b16 a[246:247], v2 offset:27656
    ds_read_b64_tr_b16 a[120:121], v2 offset:28672
    ds_read_b64_tr_b16 a[122:123], v2 offset:29696
    ds_read_b64_tr_b16 a[248:249], v2 offset:28680
    ds_read_b64_tr_b16 a[250:251], v2 offset:29704
    ds_read_b64_tr_b16 a[124:125], v2 offset:30720
    ds_read_b64_tr_b16 a[126:127], v2 offset:31744
    ds_read_b64_tr_b16 a[252:253], v2 offset:30728
    ds_read_b64_tr_b16 a[254:255], v2 offset:31752
    s_waitcnt lgkmcnt(0)
    s_barrier
    v_and_b32 v4, 15, v0
    v_mul_u32_u24 v4, 2560, v4
    v_lshrrev_b32_e64 v5, 4, v0
    v_lshl_add_u32 v3, v5, 4, v4
    s_and_b32 s68, s61, 1
    s_mul_i32 s48, s68, 40960
    s_lshl_b32 s49, s60, 6
    s_add_u32 s67, s48, s49
    s_lshl_b32 s48, s28, 11
    v_add_u32 v12, s48, v1
    s_lshl_b32 s48, s28, 3
    v_add_u32 v13, s48, v0
    v_lshlrev_b32 v13, 4, v13
    v_add_u32 v13, 8192, v13
    s_lshr_b32 s62, s61, 1
    s_mov_b32 s63, 0
    s_mov_b32 s66, 0
w6loop_67:
    s_lshr_b32 s48, s62, 2
    s_add_u32 s48, s48, 1
    s_mov_b32 s65, 0
    s_and_b32 s49, s62, 3
    s_lshl_b32 s49, s49, 2
w6p_68:
    s_mov_b64 exec, 0xff
    buffer_load_dword v4, v13, s[44:47], s49 offen sc1
    s_waitcnt vmcnt(0)
    v_cmp_gt_u32 vcc, s48, v4
    s_mov_b64 exec, -1
    s_cbranch_vccz w6pok_69
    s_add_u32 s65, s65, 1
    s_cmp_lt_u32 s65, 400000
    s_cbranch_scc0 k_fail
    s_sleep 2
    s_branch w6p_68
w6pok_69:
    s_lshl_b32 s64, s62, 18
    s_lshl_b32 s48, s28, 16
    s_add_u32 s64, s64, s48
    s_lshl_b32 s48, s68, 12
    s_add_u32 s64, s64, s48
    s_add_u32 s50, s64, 0
    buffer_load_dwordx4 v[16:19], v1, s[36:39], s50 offen offset:0 sc1
    buffer_load_dwordx4 v[20:23], v1, s[36:39], s50 offen offset:1024 sc1
    buffer_load_dwordx4 v[24:27], v1, s[36:39], s50 offen offset:2048 sc1
    buffer_load_dwordx4 v[28:31], v1, s[36:39], s50 offen offset:3072 sc1
    s_add_u32 s51, s64, 8192
    buffer_load_dwordx4 v[32:35], v1, s[36:39], s51 offen offset:0 sc1
    buffer_load_dwordx4 v[36:39], v1, s[36:39], s51 offen offset:1024 sc1
    buffer_load_dwordx4 v[40:43], v1, s[36:39], s51 offen offset:2048 sc1
    buffer_load_dwordx4 v[44:47], v1, s[36:39], s51 offen offset:3072 sc1
    s_add_u32 s50, s64, 16384
    buffer_load_dwordx4 v[48:51], v1, s[36:39], s50 offen offset:0 sc1
    buffer_load_dwordx4 v[52:55], v1, s[36:39], s50 offen offset:1024 sc1
    buffer_load_dwordx4 v[56:59], v1, s[36:39], s50 offen offset:2048 sc1
    buffer_load_dwordx4 v[60:63], v1, s[36:39], s50 offen offset:3072 sc1
    s_add_u32 s51, s64, 24576
    buffer_load_dwordx4 v[64:67], v1, s[36:39], s51 offen offset:0 sc1
    buffer_load_dwordx4 v[68:71], v1, s[36:39], s51 offen offset:1024 sc1
    buffer_load_dwordx4 v[72:75], v1, s[36:39], s51 offen offset:2048 sc1
    buffer_load_dwordx4 v[76:79], v1, s[36:39], s51 offen offset:3072 sc1
    s_waitcnt vmcnt(15)
    v_mfma_f32_16x16x32_bf16 v[80:83], a[0:3], v[16:19], 0
    v_mfma_f32_16x16x32_bf16 v[84:87], a[128:131], v[16:19], 0
    s_add_u32 s50, s64, 32768
    buffer_load_dwordx4 v[16:19], v1, s[36:39], s50 offen offset:0 sc1
    s_waitcnt vmcnt(15)
    v_mfma_f32_16x16x32_bf16 v[80:83], a[4:7], v[20:23], v[80:83]
    v_mfma_f32_16x16x32_bf16 v[84:87], a[132:135], v[20:23], v[84:87]
    buffer_load_dwordx4 v[20:23], v1, s[36:39], s50 offen offset:1024 sc1
    s_waitcnt vmcnt(15)
    v_mfma_f32_16x16x32_bf16 v[80:83], a[8:11], v[24:27], v[80:83]
    v_mfma_f32_16x16x32_bf16 v[84:87], a[136:139], v[24:27], v[84:87]
    buffer_load_dwordx4 v[24:27], v1, s[36:39], s50 offen offset:2048 sc1
    s_waitcnt vmcnt(15)
    v_mfma_f32_16x16x32_bf16 v[80:83], a[12:15], v[28:31], v[80:83]
    v_mfma_f32_16x16x32_bf16 v[84:87], a[140:143], v[28:31], v[84:87]
    buffer_load_dwordx4 v[28:31], v1, s[36:39], s50 offen offset:3072 sc1
    s_waitcnt vmcnt(15)
    v_mfma_f32_16x16x32_bf16 v[80:83], a[16:19], v[32:35], v[80:83]
    v_mfma_f32_16x16x32_bf16 v[84:87], a[144:147], v[32:35], v[84:87]
    s_add_u32 s51, s64, 40960
    buffer_load_dwordx4 v[32:35], v1, s[36:39], s51 offen offset:0 sc1
    s_waitcnt vmcnt(15)
    v_mfma_f32_16x16x32_bf16 v[80:83], a[20:23], v[36:39], v[80:83]
    v_mfma_f32_16x16x32_bf16 v[84:87], a[148:151], v[36:39], v[84:87]
    buffer_load_dwordx4 v[36:39], v1, s[36:39], s51 offen offset:1024 sc1
    s_waitcnt vmcnt(15)
    v_mfma_f32_16x16x32_bf16 v[80:83], a[24:27], v[40:43], v[80:83]
    v_mfma_f32_16x16x32_bf16 v[84:87], a[152:155], v[40:43], v[84:87]
    buffer_load_dwordx4 v[40:43], v1, s[36:39], s51 offen offset:2048 sc1
    s_waitcnt vmcnt(15)
    v_mfma_f32_16x16x32_bf16 v[80:83], a[28:31], v[44:47], v[80:83]
    v_mfma_f32_16x16x32_bf16 v[84:87], a[156:159], v[44:47], v[84:87]
    buffer_load_dwordx4 v[44:47], v1, s[36:39], s51 offen offset:3072 sc1
    s_waitcnt vmcnt(15)
    v_mfma_f32_16x16x32_bf16 v[80:83], a[32:35], v[48:51], v[80:83]
    v_mfma_f32_16x16x32_bf16 v[84:87], a[160:163], v[48:51], v[84:87]
    s_add_u32 s50, s64, 49152
    buffer_load_dwordx4 v[48:51], v1, s[36:39], s50 offen offset:0 sc1
    s_waitcnt vmcnt(15)
    v_mfma_f32_16x16x32_bf16 v[80:83], a[36:39], v[52:55], v[80:83]
    v_mfma_f32_16x16x32_bf16 v[84:87], a[164:167], v[52:55], v[84:87]
    buffer_load_dwordx4 v[52:55], v1, s[36:39], s50 offen offset:1024 sc1
    s_waitcnt vmcnt(15)
    v_mfma_f32_16x16x32_bf16 v[80:83], a[40:43], v[56:59], v[80:83]
    v_mfma_f32_16x16x32_bf16 v[84:87], a[168:171], v[56:59], v[84:87]
    buffer_load_dwordx4 v[56:59], v1, s[36:39], s50 offen offset:2048 sc1
    s_waitcnt vmcnt(15)
    v_mfma_f32_16x16x32_bf16 v[80:83], a[44:47], v[60:63], v[80:83]
    v_mfma_f32_16x16x32_bf16 v[84:87], a[172:175], v[60:63], v[84:87]
    buffer_load_dwordx4 v[60:63], v1, s[36:39], s50 offen offset:3072 sc1
    s_waitcnt vmcnt(15)
    v_mfma_f32_16x16x32_bf16 v[80:83], a[48:51], v[64:67], v[80:83]
    v_mfma_f32_16x16x32_bf16 v[84:87], a[176:179], v[64:67], v[84:87]
    s_add_u32 s51, s64, 57344
    buffer_load_dwordx4 v[64:67], v1, s[36:39], s51 offen offset:0 sc1
    s_waitcnt vmcnt(15)
    v_mfma_f32_16x16x32_bf16 v[80:83], a[52:55], v[68:71], v[80:83]
    v_mfma_f32_16x16x32_bf16 v[84:87], a[180:183], v[68:71], v[84:87]
    buffer_load_dwordx4 v[68:71], v1, s[36:39], s51 offen offset:1024 sc1
    s_waitcnt vmcnt(15)
    v_mfma_f32_16x16x32_bf16 v[80:83], a[56:59], v[72:75], v[80:83]
    v_mfma_f32_16x16x32_bf16 v[84:87], a[184:187], v[72:75], v[84:87]
    buffer_load_dwordx4 v[72:75], v1, s[36:39], s51 offen offset:2048 sc1
    s_waitcnt vmcnt(15)
    v_mfma_f32_16x16x32_bf16 v[80:83], a[60:63], v[76:79], v[80:83]
    v_mfma_f32_16x16x32_bf16 v[84:87], a[188:191], v[76:79], v[84:87]
    buffer_load_dwordx4 v[76:79], v1, s[36:39], s51 offen offset:3072 sc1
    s_waitcnt vmcnt(15)
    v_mfma_f32_16x16x32_bf16 v[80:83], a[64:67], v[16:19], v[80:83]
    v_mfma_f32_16x16x32_bf16 v[84:87], a[192:195], v[16:19], v[84:87]
    s_waitcnt vmcnt(14)
    v_mfma_f32_16x16x32_bf16 v[80:83], a[68:71], v[20:23], v[80:83]
    v_mfma_f32_16x16x32_bf16 v[84:87], a[196:199], v[20:23], v[84:87]
    s_waitcnt vmcnt(13)
    v_mfma_f32_16x16x32_bf16 v[80:83], a[72:75], v[24:27], v[80:83]
    v_mfma_f32_16x16x32_bf16 v[84:87], a[200:203], v[24:27], v[84:87]
    s_waitcnt vmcnt(12)
    v_mfma_f32_16x16x32_bf16 v[80:83], a[76:79], v[28:31], v[80:83]
    v_mfma_f32_16x16x32_bf16 v[84:87], a[204:207], v[28:31], v[84:87]
    s_waitcnt vmcnt(11)
    v_mfma_f32_16x16x32_bf16 v[80:83], a[80:83], v[32:35], v[80:83]
    v_mfma_f32_16x16x32_bf16 v[84:87], a[208:211], v[32:35], v[84:87]
    s_waitcnt vmcnt(10)
    v_mfma_f32_16x16x32_bf16 v[80:83], a[84:87], v[36:39], v[80:83]
    v_mfma_f32_16x16x32_bf16 v[84:87], a[212:215], v[36:39], v[84:87]
    s_waitcnt vmcnt(9)
    v_mfma_f32_16x16x32_bf16 v[80:83], a[88:91], v[40:43], v[80:83]
    v_mfma_f32_16x16x32_bf16 v[84:87], a[216:219], v[40:43], v[84:87]
    s_waitcnt vmcnt(8)
    v_mfma_f32_16x16x32_bf16 v[80:83], a[92:95], v[44:47], v[80:83]
    v_mfma_f32_16x16x32_bf16 v[84:87], a[220:223], v[44:47], v[84:87]
    s_waitcnt vmcnt(7)
    v_mfma_f32_16x16x32_bf16 v[80:83], a[96:99], v[48:51], v[80:83]
    v_mfma_f32_16x16x32_bf16 v[84:87], a[224:227], v[48:51], v[84:87]
    s_waitcnt vmcnt(6)
    v_mfma_f32_16x16x32_bf16 v[80:83], a[100:103], v[52:55], v[80:83]
    v_mfma_f32_16x16x32_bf16 v[84:87], a[228:231], v[52:55], v[84:87]
    s_waitcnt vmcnt(5)
    v_mfma_f32_16x16x32_bf16 v[80:83], a[104:107], v[56:59], v[80:83]
    v_mfma_f32_16x16x32_bf16 v[84:87], a[232:235], v[56:59], v[84:87]
    s_waitcnt vmcnt(4)
    v_mfma_f32_16x16x32_bf16 v[80:83], a[108:111], v[60:63], v[80:83]
    v_mfma_f32_16x16x32_bf16 v[84:87], a[236:239], v[60:63], v[84:87]
    s_waitcnt vmcnt(3)
    v_mfma_f32_16x16x32_bf16 v[80:83], a[112:115], v[64:67], v[80:83]
    v_mfma_f32_16x16x32_bf16 v[84:87], a[240:243], v[64:67], v[84:87]
    s_waitcnt vmcnt(2)
    v_mfma_f32_16x16x32_bf16 v[80:83], a[116:119], v[68:71], v[80:83]
    v_mfma_f32_16x16x32_bf16 v[84:87], a[244:247], v[68:71], v[84:87]
    s_waitcnt vmcnt(1)
    v_mfma_f32_16x16x32_bf16 v[80:83], a[120:123], v[72:75], v[80:83]
    v_mfma_f32_16x16x32_bf16 v[84:87], a[248:251], v[72:75], v[84:87]
    s_waitcnt vmcnt(0)
    v_mfma_f32_16x16x32_bf16 v[80:83], a[124:127], v[76:79], v[80:83]
    v_mfma_f32_16x16x32_bf16 v[84:87], a[252:255], v[76:79], v[84:87]
    v_add_u32 v4, s66, v12
    s_nop 5
    ds_write_b128 v4, v[80:83] offset:0
    ds_write_b128 v4, v[84:87] offset:1024
    s_waitcnt lgkmcnt(0)
    s_barrier
    s_cmp_ge_u32 s28, 1
    s_cbranch_scc1 w6skip_70
    v_add_u32_e64 v4, s66, v1
    ds_read_b128 v[96:99], v4 offset:0
    ds_read_b128 v[100:103], v4 offset:1024
    ds_read_b128 v[104:107], v4 offset:2048
    ds_read_b128 v[108:111], v4 offset:3072
    ds_read_b128 v[112:115], v4 offset:4096
    ds_read_b128 v[116:119], v4 offset:5120
    ds_read_b128 v[120:123], v4 offset:6144
    ds_read_b128 v[124:127], v4 offset:7168
    s_waitcnt lgkmcnt(0)
    v_add_f32 v96, v96, v104
    v_add_f32 v112, v112, v120
    v_add_f32 v97, v97, v105
    v_add_f32 v113, v113, v121
    v_add_f32 v98, v98, v106
    v_add_f32 v114, v114, v122
    v_add_f32 v99, v99, v107
    v_add_f32 v115, v115, v123
    v_add_f32 v100, v100, v108
    v_add_f32 v116, v116, v124
    v_add_f32 v101, v101, v109
    v_add_f32 v117, v117, v125
    v_add_f32 v102, v102, v110
    v_add_f32 v118, v118, v126
    v_add_f32 v103, v103, v111
    v_add_f32 v119, v119, v127
    v_add_f32 v96, v96, v112
    v_add_f32 v97, v97, v113
    v_add_f32 v98, v98, v114
    v_add_f32 v99, v99, v115
    v_add_f32 v100, v100, v116
    v_add_f32 v101, v101, v117
    v_add_f32 v102, v102, v118
    v_add_f32_e64 v103, v103, v119
    v_cvt_pk_bf16_f32 v104, v96, v97
    v_cvt_pk_bf16_f32 v105, v98, v99
    v_cvt_pk_bf16_f32 v106, v100, v101
    v_cvt_pk_bf16_f32 v107, v102, v103
    s_mul_i32 s48, s62, 81920
    s_add_u32 s48, s48, s67
    buffer_store_dwordx4 v[104:107], v3, s[40:43], s48 offen
w6skip_70:
    s_xor_b32 s66, s66, 16384
    s_add_u32 s62, s62, 2
    s_add_u32 s63, s63, 1
    s_cmp_lt_u32 s63, 32
    s_cbranch_scc1 w6loop_67
    s_waitcnt vmcnt(0)
    s_branch k_exit
k_waitall:
    s_waitcnt vmcnt(0)
    s_barrier
    s_cmp_eq_u32 s98, 1
    s_cbranch_scc1 idone_71
    s_mov_b32 s98, 1
    s_cmp_eq_u32 s28, 0
    s_cbranch_scc0 idone_71
    s_lshl_b32 s90, s100, 5
    s_add_u32 s90, s90, 4
    v_mov_b32_e64 v6, s90
    v_mov_b32 v7, 1
    s_mov_b64 exec, 1
    global_atomic_add v6, v7, s[24:25] sc1
    s_mov_b64 exec, -1
idone_71:
    s_mov_b32 s42, 0
    v_and_b32 v4, 7, v0
    v_lshlrev_b32 v4, 5, v4
    v_lshrrev_b32_e64 v5, 3, v0
    v_lshl_add_u32 v4, v5, 2, v4
waitall_72:
    s_mov_b64 exec, 0xffff
    global_load_dword v5, v4, s[24:25] sc1
    s_waitcnt vmcnt(0)
    s_mov_b64 exec, -1
    s_mov_b32 s43, 0
    v_readlane_b32 s44, v5, 8
    s_add_u32 s43, s43, s44
    v_readlane_b32 s44, v5, 9
    s_add_u32 s43, s43, s44
    v_readlane_b32 s44, v5, 10
    s_add_u32 s43, s43, s44
    v_readlane_b32 s44, v5, 11
    s_add_u32 s43, s43, s44
    v_readlane_b32 s44, v5, 12
    s_add_u32 s43, s43, s44
    v_readlane_b32 s44, v5, 13
    s_add_u32 s43, s43, s44
    v_readlane_b32 s44, v5, 14
    s_add_u32 s43, s43, s44
    v_readlane_b32 s44, v5, 15
    s_add_u32 s43, s43, s44
    s_cmp_ge_u32 s43, 256
    s_cbranch_scc1 k_reassign
    s_add_u32 s42, s42, 1
    s_cmp_lt_u32 s42, 300000
    s_cbranch_scc0 k_fail
    s_sleep 1
    s_branch waitall_72
k_reassign:
    s_waitcnt vmcnt(0) lgkmcnt(0)
    s_barrier
    v_lshlrev_b32 v4, 5, v0
    s_mov_b64 exec, 0xff
    global_load_dword v5, v4, s[24:25] sc1
    s_waitcnt vmcnt(0)
    s_mov_b64 exec, -1
    s_mov_b32 s43, s101
    v_readlane_b32 s44, v5, 0
    s_cmp_gt_u32 s100, 0
    s_cselect_b32 s44, s44, 0
    s_add_u32 s43, s43, s44
    v_readlane_b32 s44, v5, 1
    s_cmp_gt_u32 s100, 1
    s_cselect_b32 s44, s44, 0
    s_add_u32 s43, s43, s44
    v_readlane_b32 s44, v5, 2
    s_cmp_gt_u32 s100, 2
    s_cselect_b32 s44, s44, 0
    s_add_u32 s43, s43, s44
    v_readlane_b32 s44, v5, 3
    s_cmp_gt_u32 s100, 3
    s_cselect_b32 s44, s44, 0
    s_add_u32 s43, s43, s44
    v_readlane_b32 s44, v5, 4
    s_cmp_gt_u32 s100, 4
    s_cselect_b32 s44, s44, 0
    s_add_u32 s43, s43, s44
    v_readlane_b32 s44, v5, 5
    s_cmp_gt_u32 s100, 5
    s_cselect_b32 s44, s44, 0
    s_add_u32 s43, s43, s44
    v_readlane_b32 s44, v5, 6
    s_cmp_gt_u32 s100, 6
    s_cselect_b32 s44, s44, 0
    s_add_u32 s43, s43, s44
    s_mov_b32 s3, 1
    s_cmp_lt_u32 s43, 64
    s_cbranch_scc1 k_chain_slow
    s_sub_u32 s29, s43, 64
    s_branch k_worker
k_chain_slow:
    s_lshr_b32 s30, s43, 5
    s_and_b32 s31, s43, 31
    s_lshr_b32 s88, s31, 1
    s_lshl_b32 s84, s30, 4
    s_add_u32 s84, s84, s88
    s_and_b32 s88, s31, 1
    s_lshl_b32 s73, s84, 1
    s_add_u32 s73, s73, s88
    s_mov_b32 s48, s6
    s_mov_b32 s49, s7
    s_and_b32 s49, s49, 0xffff
    s_mov_b32 s50, 0x2800
    s_mov_b32 s51, 0x20000
    s_lshl_b32 s88, s28, 6
    v_add_u32 v16, s88, v0
    v_add_u32 v17, 0, v16
    v_and_b32 v18, 7, v17
    v_mul_u32_u24 v18, 1280, v18
    v_lshrrev_b32_e64 v19, 5, v17
    v_lshl_add_u32 v18, v19, 6, v18
    v_bfe_u32 v19, v17, 3, 2
    v_lshl_add_u32 v18, v19, 3, v18
    buffer_load_dwordx2 v[124:125], v18, s[48:51], 0 offen
    buffer_load_dwordx2 v[126:127], v18, s[48:51], 0 offen offset:32
    v_add_u32 v17, 256, v16
    v_and_b32_e64 v18, 7, v17
    v_mul_u32_u24 v18, 1280, v18
    v_lshrrev_b32_e64 v19, 5, v17
    v_lshl_add_u32 v18, v19, 6, v18
    v_bfe_u32 v19, v17, 3, 2
    v_lshl_add_u32 v18, v19, 3, v18
    buffer_load_dwordx2 v[128:129], v18, s[48:51], 0 offen
    buffer_load_dwordx2 v[130:131], v18, s[48:51], 0 offen offset:32
    v_add_u32 v17, 512, v16
    v_and_b32_e64 v18, 7, v17
    v_mul_u32_u24 v18, 1280, v18
    v_lshrrev_b32_e64 v19, 5, v17
    v_lshl_add_u32 v18, v19, 6, v18
    v_bfe_u32 v19, v17, 3, 2
    v_lshl_add_u32 v18, v19, 3, v18
    buffer_load_dwordx2 v[132:133], v18, s[48:51], 0 offen
    buffer_load_dwordx2 v[134:135], v18, s[48:51], 0 offen offset:32
    s_mov_b32 s44, s8
    s_mov_b32 s45, s9
    s_and_b32 s45, s45, 0xffff
    s_mov_b32 s46, 0x500000
    s_mov_b32 s47, 0x20000
    s_lshl_b32 s94, s73, 7
    v_lshrrev_b32 v16, 5, v0
    s_and_b32 s88, s28, 2
    v_or_b32 v16, s88, v16
    v_lshlrev_b32 v16, 1, v16
    v_and_b32 v17, 7, v0
    v_xor_b32 v16, v16, v17
    v_lshlrev_b32 v16, 4, v16
    v_lshrrev_b32 v17, 3, v0
    v_lshlrev_b32 v17, 13, v17
    v_add_u32 v16, v16, v17
    s_lshl_b32 s88, s28, 16
    s_add_u32 s88, s88, s94
    s_lshl_b32 s89, s28, 10
    s_add_u32 s89, s89, 0
    s_mov_b32 m0, s89
    s_add_u32 s89, s89, 4096
    buffer_load_dwordx4 v16, s[44:47], s88 offen lds
    s_add_u32 s88, s88, 262144
    s_mov_b32 m0, s89
    s_add_u32 s89, s89, 4096
    buffer_load_dwordx4 v16, s[44:47], s88 offen lds
    s_add_u32 s88, s88, 262144
    s_mov_b32 m0, s89
    s_add_u32 s89, s89, 4096
    buffer_load_dwordx4 v16, s[44:47], s88 offen lds
    s_add_u32 s88, s88, 262144
    s_mov_b32 m0, s89
    s_add_u32 s89, s89, 4096
    buffer_load_dwordx4 v16, s[44:47], s88 offen lds
    s_add_u32 s88, s88, 262144
    s_mov_b32 m0, s89
    s_add_u32 s89, s89, 4096
    buffer_load_dwordx4 v16, s[44:47], s88 offen lds
    s_add_u32 s88, s88, 262144
    s_mov_b32 m0, s89
    s_add_u32 s89, s89, 4096
    buffer_load_dwordx4 v16, s[44:47], s88 offen lds
    s_add_u32 s88, s88, 262144
    s_mov_b32 m0, s89
    s_add_u32 s89, s89, 4096
    buffer_load_dwordx4 v16, s[44:47], s88 offen lds
    s_add_u32 s88, s88, 262144
    s_mov_b32 m0, s89
    s_add_u32 s89, s89, 4096
    buffer_load_dwordx4 v16, s[44:47], s88 offen lds
    s_add_u32 s88, s88, 262144
    s_mov_b32 m0, s89
    s_add_u32 s89, s89, 4096
    buffer_load_dwordx4 v16, s[44:47], s88 offen lds
    s_add_u32 s88, s88, 262144
    s_mov_b32 m0, s89
    s_add_u32 s89, s89, 4096
    buffer_load_dwordx4 v16, s[44:47], s88 offen lds
    s_add_u32 s88, s88, 262144
    s_mov_b32 s44, s8
    s_mov_b32 s45, s9
    s_and_b32 s45, s45, 0xffff
    s_mov_b32 s46, 0x500000
    s_mov_b32 s47, 0x20000
    s_lshl_b32 s94, s73, 7
    s_add_u32 s94, s94, 2621440
    v_lshrrev_b32 v16, 5, v0
    s_and_b32 s88, s28, 2
    v_or_b32 v16, s88, v16
    v_lshlrev_b32 v16, 1, v16
    v_and_b32 v17, 7, v0
    v_xor_b32 v16, v16, v17
    v_lshlrev_b32 v16, 4, v16
    v_lshrrev_b32 v17, 3, v0
    v_lshlrev_b32 v17, 13, v17
    v_add_u32 v16, v16, v17
    s_lshl_b32 s88, s28, 16
    s_add_u32 s88, s88, s94
    s_lshl_b32 s89, s28, 10
    s_add_u32 s89, s89, 40960
    s_mov_b32 m0, s89
    s_add_u32 s89, s89, 4096
    buffer_load_dwordx4 v16, s[44:47], s88 offen lds
    s_add_u32 s88, s88, 262144
    s_mov_b32 m0, s89
    s_add_u32 s89, s89, 4096
    buffer_load_dwordx4 v16, s[44:47], s88 offen lds
    s_add_u32 s88, s88, 262144
    s_mov_b32 m0, s89
    s_add_u32 s89, s89, 4096
    buffer_load_dwordx4 v16, s[44:47], s88 offen lds
    s_add_u32 s88, s88, 262144
    s_mov_b32 m0, s89
    s_add_u32 s89, s89, 4096
    buffer_load_dwordx4 v16, s[44:47], s88 offen lds
    s_add_u32 s88, s88, 262144
    s_mov_b32 m0, s89
    s_add_u32 s89, s89, 4096
    buffer_load_dwordx4 v16, s[44:47], s88 offen lds
    s_add_u32 s88, s88, 262144
    s_mov_b32 m0, s89
    s_add_u32 s89, s89, 4096
    buffer_load_dwordx4 v16, s[44:47], s88 offen lds
    s_add_u32 s88, s88, 262144
    s_mov_b32 m0, s89
    s_add_u32 s89, s89, 4096
    buffer_load_dwordx4 v16, s[44:47], s88 offen lds
    s_add_u32 s88, s88, 262144
    s_mov_b32 m0, s89
    s_add_u32 s89, s89, 4096
    buffer_load_dwordx4 v16, s[44:47], s88 offen lds
    s_add_u32 s88, s88, 262144
    s_mov_b32 m0, s89
    s_add_u32 s89, s89, 4096
    buffer_load_dwordx4 v16, s[44:47], s88 offen lds
    s_add_u32 s88, s88, 262144
    s_mov_b32 m0, s89
    s_add_u32 s89, s89, 4096
    buffer_load_dwordx4 v16, s[44:47], s88 offen lds
    s_add_u32 s88, s88, 262144
    s_mov_b32 s44, s10
    s_mov_b32 s45, s11
    s_and_b32 s45, s45, 0xffff
    s_mov_b32 s46, 0x500000
    s_mov_b32 s47, 0x20000
    s_lshl_b32 s94, s73, 7
    v_lshrrev_b32 v16, 5, v0
    s_and_b32 s88, s28, 2
    v_or_b32 v16, s88, v16
    v_lshlrev_b32 v16, 1, v16
    v_and_b32 v17, 7, v0
    v_xor_b32 v16, v16, v17
    v_lshlrev_b32 v16, 4, v16
    v_lshrrev_b32 v17, 3, v0
    v_lshlrev_b32 v17, 13, v17
    v_add_u32 v16, v16, v17
    s_lshl_b32 s88, s28, 16
    s_add_u32 s88, s88, s94
    s_lshl_b32 s89, s28, 10
    s_add_u32 s89, s89, 81920
    s_mov_b32 m0, s89
    s_add_u32 s89, s89, 4096
    buffer_load_dwordx4 v16, s[44:47], s88 offen lds
    s_add_u32 s88, s88, 262144
    s_mov_b32 m0, s89
    s_add_u32 s89, s89, 4096
    buffer_load_dwordx4 v16, s[44:47], s88 offen lds
    s_add_u32 s88, s88, 262144
    s_mov_b32 m0, s89
    s_add_u32 s89, s89, 4096
    buffer_load_dwordx4 v16, s[44:47], s88 offen lds
    s_add_u32 s88, s88, 262144
    s_mov_b32 m0, s89
    s_add_u32 s89, s89, 4096
    buffer_load_dwordx4 v16, s[44:47], s88 offen lds
    s_add_u32 s88, s88, 262144
    s_mov_b32 m0, s89
    s_add_u32 s89, s89, 4096
    buffer_load_dwordx4 v16, s[44:47], s88 offen lds
    s_add_u32 s88, s88, 262144
    s_mov_b32 m0, s89
    s_add_u32 s89, s89, 4096
    buffer_load_dwordx4 v16, s[44:47], s88 offen lds
    s_add_u32 s88, s88, 262144
    s_mov_b32 m0, s89
    s_add_u32 s89, s89, 4096
    buffer_load_dwordx4 v16, s[44:47], s88 offen lds
    s_add_u32 s88, s88, 262144
    s_mov_b32 m0, s89
    s_add_u32 s89, s89, 4096
    buffer_load_dwordx4 v16, s[44:47], s88 offen lds
    s_add_u32 s88, s88, 262144
    s_mov_b32 m0, s89
    s_add_u32 s89, s89, 4096
    buffer_load_dwordx4 v16, s[44:47], s88 offen lds
    s_add_u32 s88, s88, 262144
    s_mov_b32 m0, s89
    s_add_u32 s89, s89, 4096
    buffer_load_dwordx4 v16, s[44:47], s88 offen lds
    s_add_u32 s88, s88, 262144
    s_mov_b32 s44, s10
    s_mov_b32 s45, s11
    s_and_b32 s45, s45, 0xffff
    s_mov_b32 s46, 0x500000
    s_mov_b32 s47, 0x20000
    s_lshl_b32 s94, s73, 7
    s_add_u32 s94, s94, 2621440
    v_lshrrev_b32 v16, 5, v0
    s_and_b32 s88, s28, 2
    v_or_b32 v16, s88, v16
    v_lshlrev_b32 v16, 1, v16
    v_and_b32 v17, 7, v0
    v_xor_b32 v16, v16, v17
    v_lshlrev_b32 v16, 4, v16
    v_lshrrev_b32 v17, 3, v0
    v_lshlrev_b32 v17, 13, v17
    v_add_u32 v16, v16, v17
    s_lshl_b32 s88, s28, 16
    s_add_u32 s88, s88, s94
    s_lshl_b32 s89, s28, 10
    s_add_u32 s89, s89, 122880
    s_mov_b32 m0, s89
    s_add_u32 s89, s89, 4096
    buffer_load_dwordx4 v16, s[44:47], s88 offen lds
    s_add_u32 s88, s88, 262144
    s_mov_b32 m0, s89
    s_add_u32 s89, s89, 4096
    buffer_load_dwordx4 v16, s[44:47], s88 offen lds
    s_add_u32 s88, s88, 262144
    s_mov_b32 m0, s89
    s_add_u32 s89, s89, 4096
    buffer_load_dwordx4 v16, s[44:47], s88 offen lds
    s_add_u32 s88, s88, 262144
    s_mov_b32 m0, s89
    s_add_u32 s89, s89, 4096
    buffer_load_dwordx4 v16, s[44:47], s88 offen lds
    s_add_u32 s88, s88, 262144
    s_mov_b32 m0, s89
    s_add_u32 s89, s89, 4096
    buffer_load_dwordx4 v16, s[44:47], s88 offen lds
    s_add_u32 s88, s88, 262144
    s_mov_b32 m0, s89
    s_add_u32 s89, s89, 4096
    buffer_load_dwordx4 v16, s[44:47], s88 offen lds
    s_add_u32 s88, s88, 262144
    s_mov_b32 m0, s89
    s_add_u32 s89, s89, 4096
    buffer_load_dwordx4 v16, s[44:47], s88 offen lds
    s_add_u32 s88, s88, 262144
    s_mov_b32 m0, s89
    s_add_u32 s89, s89, 4096
    buffer_load_dwordx4 v16, s[44:47], s88 offen lds
    s_add_u32 s88, s88, 262144
    s_mov_b32 m0, s89
    s_add_u32 s89, s89, 4096
    buffer_load_dwordx4 v16, s[44:47], s88 offen lds
    s_add_u32 s88, s88, 262144
    s_mov_b32 m0, s89
    s_add_u32 s89, s89, 4096
    buffer_load_dwordx4 v16, s[44:47], s88 offen lds
    s_add_u32 s88, s88, 262144
    s_waitcnt vmcnt(30)
    s_barrier
    v_bfe_u32 v17, v0, 3, 2
    v_xor_b32 v16, s28, v17
    v_lshlrev_b32_e64 v16, 5, v16
    v_bfe_u32 v17, v0, 4, 1
    v_lshlrev_b32_e64 v17, 4, v17
    v_bfe_u32 v18, v0, 5, 1
    v_lshl_add_u32 v17, v18, 3, v17
    v_bfe_u32 v18, v0, 3, 1
    v_lshl_add_u32 v17, v18, 2, v17
    v_bfe_u32 v18, v0, 2, 1
    v_add_u32 v17, v17, v18
    v_lshlrev_b32 v17, 7, v17
    v_and_b32_e64 v18, 3, v0
    v_lshl_add_u32 v17, v18, 3, v17
    v_add_u32 v16, v16, v17
    v_add_u32 v16, 0, v16
    ds_read_b64_tr_b16 a[0:1], v16 offset:0
    ds_read_b64_tr_b16 a[2:3], v16 offset:256
    ds_read_b64_tr_b16 a[4:5], v16 offset:4096
    ds_read_b64_tr_b16 a[6:7], v16 offset:4352
    ds_read_b64_tr_b16 a[8:9], v16 offset:8192
    ds_read_b64_tr_b16 a[10:11], v16 offset:8448
    ds_read_b64_tr_b16 a[12:13], v16 offset:12288
    ds_read_b64_tr_b16 a[14:15], v16 offset:12544
    ds_read_b64_tr_b16 a[16:17], v16 offset:16384
    ds_read_b64_tr_b16 a[18:19], v16 offset:16640
    ds_read_b64_tr_b16 a[20:21], v16 offset:20480
    ds_read_b64_tr_b16 a[22:23], v16 offset:20736
    s_waitcnt lgkmcnt(0)
    ds_read_b64_tr_b16 a[24:25], v16 offset:24576
    ds_read_b64_tr_b16 a[26:27], v16 offset:24832
    ds_read_b64_tr_b16 a[28:29], v16 offset:28672
    ds_read_b64_tr_b16 a[30:31], v16 offset:28928
    ds_read_b64_tr_b16 a[32:33], v16 offset:32768
    ds_read_b64_tr_b16 a[34:35], v16 offset:33024
    ds_read_b64_tr_b16 a[36:37], v16 offset:36864
    ds_read_b64_tr_b16 a[38:39], v16 offset:37120
    s_waitcnt lgkmcnt(0)
    s_waitcnt lgkmcnt(0)
    s_barrier
    s_mov_b32 s44, s12
    s_mov_b32 s45, s13
    s_and_b32 s45, s45, 0xffff
    s_mov_b32 s46, 0x500000
    s_mov_b32 s47, 0x20000
    s_lshl_b32 s94, s73, 7
    v_lshrrev_b32 v16, 5, v0
    s_and_b32 s88, s28, 2
    v_or_b32 v16, s88, v16
    v_lshlrev_b32 v16, 1, v16
    v_and_b32 v17, 7, v0
    v_xor_b32 v16, v16, v17
    v_lshlrev_b32 v16, 4, v16
    v_lshrrev_b32 v17, 3, v0
    v_lshlrev_b32 v17, 13, v17
    v_add_u32 v16, v16, v17
    s_lshl_b32 s88, s28, 16
    s_add_u32 s88, s88, s94
    s_lshl_b32 s89, s28, 10
    s_add_u32 s89, s89, 0
    s_mov_b32 m0, s89
    s_add_u32 s89, s89, 4096
    buffer_load_dwordx4 v16, s[44:47], s88 offen lds
    s_add_u32 s88, s88, 262144
    s_mov_b32 m0, s89
    s_add_u32 s89, s89, 4096
    buffer_load_dwordx4 v16, s[44:47], s88 offen lds
    s_add_u32 s88, s88, 262144
    s_mov_b32 m0, s89
    s_add_u32 s89, s89, 4096
    buffer_load_dwordx4 v16, s[44:47], s88 offen lds
    s_add_u32 s88, s88, 262144
    s_mov_b32 m0, s89
    s_add_u32 s89, s89, 4096
    buffer_load_dwordx4 v16, s[44:47], s88 offen lds
    s_add_u32 s88, s88, 262144
    s_mov_b32 m0, s89
    s_add_u32 s89, s89, 4096
    buffer_load_dwordx4 v16, s[44:47], s88 offen lds
    s_add_u32 s88, s88, 262144
    s_mov_b32 m0, s89
    s_add_u32 s89, s89, 4096
    buffer_load_dwordx4 v16, s[44:47], s88 offen lds
    s_add_u32 s88, s88, 262144
    s_mov_b32 m0, s89
    s_add_u32 s89, s89, 4096
    buffer_load_dwordx4 v16, s[44:47], s88 offen lds
    s_add_u32 s88, s88, 262144
    s_mov_b32 m0, s89
    s_add_u32 s89, s89, 4096
    buffer_load_dwordx4 v16, s[44:47], s88 offen lds
    s_add_u32 s88, s88, 262144
    s_mov_b32 m0, s89
    s_add_u32 s89, s89, 4096
    buffer_load_dwordx4 v16, s[44:47], s88 offen lds
    s_add_u32 s88, s88, 262144
    s_mov_b32 m0, s89
    s_add_u32 s89, s89, 4096
    buffer_load_dwordx4 v16, s[44:47], s88 offen lds
    s_add_u32 s88, s88, 262144
    s_waitcnt vmcnt(30)
    s_barrier
    v_bfe_u32 v17, v0, 3, 2
    v_xor_b32 v16, s28, v17
    v_lshlrev_b32_e64 v16, 5, v16
    v_bfe_u32 v17, v0, 4, 1
    v_lshlrev_b32_e64 v17, 4, v17
    v_bfe_u32 v18, v0, 5, 1
    v_lshl_add_u32 v17, v18, 3, v17
    v_bfe_u32 v18, v0, 3, 1
    v_lshl_add_u32 v17, v18, 2, v17
    v_bfe_u32 v18, v0, 2, 1
    v_add_u32 v17, v17, v18
    v_lshlrev_b32 v17, 7, v17
    v_and_b32_e64 v18, 3, v0
    v_lshl_add_u32 v17, v18, 3, v17
    v_add_u32_e64 v16, v16, v17
    v_add_u32 v16, 40960, v16
    ds_read_b64_tr_b16 a[40:41], v16 offset:0
    ds_read_b64_tr_b16 a[42:43], v16 offset:256
    ds_read_b64_tr_b16 a[44:45], v16 offset:4096
    ds_read_b64_tr_b16 a[46:47], v16 offset:4352
    ds_read_b64_tr_b16 a[48:49], v16 offset:8192
    ds_read_b64_tr_b16 a[50:51], v16 offset:8448
    ds_read_b64_tr_b16 a[52:53], v16 offset:12288
    ds_read_b64_tr_b16 a[54:55], v16 offset:12544
    ds_read_b64_tr_b16 a[56:57], v16 offset:16384
    ds_read_b64_tr_b16 a[58:59], v16 offset:16640
    ds_read_b64_tr_b16 a[60:61], v16 offset:20480
    ds_read_b64_tr_b16 a[62:63], v16 offset:20736
    s_waitcnt lgkmcnt(0)
    ds_read_b64_tr_b16 a[64:65], v16 offset:24576
    ds_read_b64_tr_b16 a[66:67], v16 offset:24832
    ds_read_b64_tr_b16 a[68:69], v16 offset:28672
    ds_read_b64_tr_b16 a[70:71], v16 offset:28928
    ds_read_b64_tr_b16 a[72:73], v16 offset:32768
    ds_read_b64_tr_b16 a[74:75], v16 offset:33024
    ds_read_b64_tr_b16 a[76:77], v16 offset:36864
    ds_read_b64_tr_b16 a[78:79], v16 offset:37120
    s_waitcnt lgkmcnt(0)
    s_waitcnt lgkmcnt(0)
    s_barrier
    s_mov_b32 s44, s12
    s_mov_b32 s45, s13
    s_and_b32 s45, s45, 0xffff
    s_mov_b32 s46, 0x500000
    s_mov_b32 s47, 0x20000
    s_lshl_b32 s94, s73, 7
    s_add_u32 s94, s94, 2621440
    v_lshrrev_b32 v16, 5, v0
    s_and_b32 s88, s28, 2
    v_or_b32 v16, s88, v16
    v_lshlrev_b32 v16, 1, v16
    v_and_b32 v17, 7, v0
    v_xor_b32 v16, v16, v17
    v_lshlrev_b32 v16, 4, v16
    v_lshrrev_b32 v17, 3, v0
    v_lshlrev_b32 v17, 13, v17
    v_add_u32 v16, v16, v17
    s_lshl_b32 s88, s28, 16
    s_add_u32 s88, s88, s94
    s_lshl_b32 s89, s28, 10
    s_add_u32 s89, s89, 40960
    s_mov_b32 m0, s89
    s_add_u32 s89, s89, 4096
    buffer_load_dwordx4 v16, s[44:47], s88 offen lds
    s_add_u32 s88, s88, 262144
    s_mov_b32 m0, s89
    s_add_u32 s89, s89, 4096
    buffer_load_dwordx4 v16, s[44:47], s88 offen lds
    s_add_u32 s88, s88, 262144
    s_mov_b32 m0, s89
    s_add_u32 s89, s89, 4096
    buffer_load_dwordx4 v16, s[44:47], s88 offen lds
    s_add_u32 s88, s88, 262144
    s_mov_b32 m0, s89
    s_add_u32 s89, s89, 4096
    buffer_load_dwordx4 v16, s[44:47], s88 offen lds
    s_add_u32 s88, s88, 262144
    s_mov_b32 m0, s89
    s_add_u32 s89, s89, 4096
    buffer_load_dwordx4 v16, s[44:47], s88 offen lds
    s_add_u32 s88, s88, 262144
    s_mov_b32 m0, s89
    s_add_u32 s89, s89, 4096
    buffer_load_dwordx4 v16, s[44:47], s88 offen lds
    s_add_u32 s88, s88, 262144
    s_mov_b32 m0, s89
    s_add_u32 s89, s89, 4096
    buffer_load_dwordx4 v16, s[44:47], s88 offen lds
    s_add_u32 s88, s88, 262144
    s_mov_b32 m0, s89
    s_add_u32 s89, s89, 4096
    buffer_load_dwordx4 v16, s[44:47], s88 offen lds
    s_add_u32 s88, s88, 262144
    s_mov_b32 m0, s89
    s_add_u32 s89, s89, 4096
    buffer_load_dwordx4 v16, s[44:47], s88 offen lds
    s_add_u32 s88, s88, 262144
    s_mov_b32 m0, s89
    s_add_u32 s89, s89, 4096
    buffer_load_dwordx4 v16, s[44:47], s88 offen lds
    s_add_u32 s88, s88, 262144
    s_waitcnt vmcnt(30)
    s_barrier
    v_bfe_u32 v17, v0, 3, 2
    v_xor_b32 v16, s28, v17
    v_lshlrev_b32 v16, 5, v16
    v_bfe_u32 v17, v0, 4, 1
    v_lshlrev_b32_e64 v17, 4, v17
    v_bfe_u32 v18, v0, 5, 1
    v_lshl_add_u32 v17, v18, 3, v17
    v_bfe_u32 v18, v0, 3, 1
    v_lshl_add_u32 v17, v18, 2, v17
    v_bfe_u32 v18, v0, 2, 1
    v_add_u32 v17, v17, v18
    v_lshlrev_b32 v17, 7, v17
    v_and_b32_e64 v18, 3, v0
    v_lshl_add_u32 v17, v18, 3, v17
    v_add_u32_e64 v16, v16, v17
    v_add_u32 v16, 81920, v16
    ds_read_b64_tr_b16 a[80:81], v16 offset:0
    ds_read_b64_tr_b16 a[82:83], v16 offset:256
    ds_read_b64_tr_b16 a[84:85], v16 offset:4096
    ds_read_b64_tr_b16 a[86:87], v16 offset:4352
    ds_read_b64_tr_b16 a[88:89], v16 offset:8192
    ds_read_b64_tr_b16 a[90:91], v16 offset:8448
    ds_read_b64_tr_b16 a[92:93], v16 offset:12288
    ds_read_b64_tr_b16 a[94:95], v16 offset:12544
    ds_read_b64_tr_b16 a[96:97], v16 offset:16384
    ds_read_b64_tr_b16 a[98:99], v16 offset:16640
    ds_read_b64_tr_b16 a[100:101], v16 offset:20480
    ds_read_b64_tr_b16 a[102:103], v16 offset:20736
    s_waitcnt lgkmcnt(0)
    ds_read_b64_tr_b16 a[104:105], v16 offset:24576
    ds_read_b64_tr_b16 a[106:107], v16 offset:24832
    ds_read_b64_tr_b16 a[108:109], v16 offset:28672
    ds_read_b64_tr_b16 a[110:111], v16 offset:28928
    ds_read_b64_tr_b16 a[112:113], v16 offset:32768
    ds_read_b64_tr_b16 a[114:115], v16 offset:33024
    ds_read_b64_tr_b16 a[116:117], v16 offset:36864
    ds_read_b64_tr_b16 a[118:119], v16 offset:37120
    s_waitcnt lgkmcnt(0)
    s_waitcnt lgkmcnt(0)
    s_barrier
    s_mov_b32 s44, s14
    s_mov_b32 s45, s15
    s_and_b32 s45, s45, 0xffff
    s_mov_b32 s46, 0x500000
    s_mov_b32 s47, 0x20000
    s_mul_i32 s94, s73, 81920
    s_lshl_b32 s89, s28, 10
    s_add_u32 s89, s89, 81920
    s_lshl_b32 s88, s28, 6
    v_add_u32 v16, s88, v0
    s_mov_b32 s90, 52429
    v_mul_lo_u32 v17, v16, s90
    v_lshrrev_b32 v17, 22, v17
    v_mul_u32_u24 v18, 80, v17
    v_sub_u32 v18, v16, v18
    v_and_b32 v19, 7, v17
    v_lshlrev_b32 v19, 1, v19
    v_xor_b32 v18, v18, v19
    v_mul_u32_u24 v17, 1280, v17
    v_lshl_add_u32 v17, v18, 4, v17
    s_mov_b32 m0, s89
    s_add_u32 s89, s89, 4096
    buffer_load_dwordx4 v17, s[44:47], s94 offen lds
    v_add_u32 v16, 256, v16
    v_mul_lo_u32 v20, v16, s90
    v_lshrrev_b32 v20, 22, v20
    v_mul_u32_u24 v21, 80, v20
    v_sub_u32 v21, v16, v21
    v_and_b32 v22, 7, v20
    v_lshlrev_b32 v22, 1, v22
    v_xor_b32 v21, v21, v22
    v_mul_u32_u24 v20, 1280, v20
    v_lshl_add_u32 v20, v21, 4, v20
    s_mov_b32 m0, s89
    s_add_u32 s89, s89, 4096
    buffer_load_dwordx4 v20, s[44:47], s94 offen lds
    v_add_u32 v16, 256, v16
    v_mul_lo_u32 v17, v16, s90
    v_lshrrev_b32 v17, 22, v17
    v_mul_u32_u24 v18, 80, v17
    v_sub_u32 v18, v16, v18
    v_and_b32 v19, 7, v17
    v_lshlrev_b32 v19, 1, v19
    v_xor_b32 v18, v18, v19
    v_mul_u32_u24 v17, 1280, v17
    v_lshl_add_u32 v17, v18, 4, v17
    s_mov_b32 m0, s89
    s_add_u32 s89, s89, 4096
    buffer_load_dwordx4 v17, s[44:47], s94 offen lds
    v_add_u32 v16, 256, v16
    v_mul_lo_u32 v20, v16, s90
    v_lshrrev_b32 v20, 22, v20
    v_mul_u32_u24 v21, 80, v20
    v_sub_u32 v21, v16, v21
    v_and_b32 v22, 7, v20
    v_lshlrev_b32 v22, 1, v22
    v_xor_b32 v21, v21, v22
    v_mul_u32_u24 v20, 1280, v20
    v_lshl_add_u32 v20, v21, 4, v20
    s_mov_b32 m0, s89
    s_add_u32 s89, s89, 4096
    buffer_load_dwordx4 v20, s[44:47], s94 offen lds
    v_add_u32 v16, 256, v16
    v_mul_lo_u32 v17, v16, s90
    v_lshrrev_b32 v17, 22, v17
    v_mul_u32_u24 v18, 80, v17
    v_sub_u32 v18, v16, v18
    v_and_b32 v19, 7, v17
    v_lshlrev_b32 v19, 1, v19
    v_xor_b32 v18, v18, v19
    v_mul_u32_u24 v17, 1280, v17
    v_lshl_add_u32 v17, v18, 4, v17
    s_mov_b32 m0, s89
    s_add_u32 s89, s89, 4096
    buffer_load_dwordx4 v17, s[44:47], s94 offen lds
    v_add_u32 v16, 256, v16
    v_mul_lo_u32 v20, v16, s90
    v_lshrrev_b32 v20, 22, v20
    v_mul_u32_u24 v21, 80, v20
    v_sub_u32 v21, v16, v21
    v_and_b32 v22, 7, v20
    v_lshlrev_b32 v22, 1, v22
    v_xor_b32 v21, v21, v22
    v_mul_u32_u24 v20, 1280, v20
    v_lshl_add_u32 v20, v21, 4, v20
    s_mov_b32 m0, s89
    s_add_u32 s89, s89, 4096
    buffer_load_dwordx4 v20, s[44:47], s94 offen lds
    v_add_u32 v16, 256, v16
    v_mul_lo_u32 v17, v16, s90
    v_lshrrev_b32 v17, 22, v17
    v_mul_u32_u24 v18, 80, v17
    v_sub_u32 v18, v16, v18
    v_and_b32 v19, 7, v17
    v_lshlrev_b32 v19, 1, v19
    v_xor_b32 v18, v18, v19
    v_mul_u32_u24 v17, 1280, v17
    v_lshl_add_u32 v17, v18, 4, v17
    s_mov_b32 m0, s89
    s_add_u32 s89, s89, 4096
    buffer_load_dwordx4 v17, s[44:47], s94 offen lds
    v_add_u32 v16, 256, v16
    v_mul_lo_u32 v20, v16, s90
    v_lshrrev_b32 v20, 22, v20
    v_mul_u32_u24 v21, 80, v20
    v_sub_u32 v21, v16, v21
    v_and_b32 v22, 7, v20
    v_lshlrev_b32 v22, 1, v22
    v_xor_b32 v21, v21, v22
    v_mul_u32_u24 v20, 1280, v20
    v_lshl_add_u32 v20, v21, 4, v20
    s_mov_b32 m0, s89
    s_add_u32 s89, s89, 4096
    buffer_load_dwordx4 v20, s[44:47], s94 offen lds
    v_add_u32 v16, 256, v16
    v_mul_lo_u32 v17, v16, s90
    v_lshrrev_b32 v17, 22, v17
    v_mul_u32_u24 v18, 80, v17
    v_sub_u32 v18, v16, v18
    v_and_b32 v19, 7, v17
    v_lshlrev_b32 v19, 1, v19
    v_xor_b32 v18, v18, v19
    v_mul_u32_u24 v17, 1280, v17
    v_lshl_add_u32 v17, v18, 4, v17
    s_mov_b32 m0, s89
    s_add_u32 s89, s89, 4096
    buffer_load_dwordx4 v17, s[44:47], s94 offen lds
    v_add_u32 v16, 256, v16
    v_mul_lo_u32 v20, v16, s90
    v_lshrrev_b32 v20, 22, v20
    v_mul_u32_u24 v21, 80, v20
    v_sub_u32 v21, v16, v21
    v_and_b32 v22, 7, v20
    v_lshlrev_b32 v22, 1, v22
    v_xor_b32 v21, v21, v22
    v_mul_u32_u24 v20, 1280, v20
    v_lshl_add_u32 v20, v21, 4, v20
    s_mov_b32 m0, s89
    s_add_u32 s89, s89, 4096
    buffer_load_dwordx4 v20, s[44:47], s94 offen lds
    v_add_u32 v16, 256, v16
    s_waitcnt vmcnt(30)
    s_barrier
    v_bfe_u32 v17, v0, 3, 2
    v_xor_b32 v16, s28, v17
    v_lshlrev_b32_e64 v16, 5, v16
    v_bfe_u32 v17, v0, 4, 1
    v_lshlrev_b32_e64 v17, 4, v17
    v_bfe_u32 v18, v0, 5, 1
    v_lshl_add_u32 v17, v18, 3, v17
    v_bfe_u32 v18, v0, 3, 1
    v_lshl_add_u32 v17, v18, 2, v17
    v_bfe_u32 v18, v0, 2, 1
    v_add_u32 v17, v17, v18
    v_lshlrev_b32 v17, 7, v17
    v_and_b32_e64 v18, 3, v0
    v_lshl_add_u32 v17, v18, 3, v17
    v_add_u32_e64 v16, v16, v17
    v_add_u32 v16, 122880, v16
    ds_read_b64_tr_b16 a[120:121], v16 offset:0
    ds_read_b64_tr_b16 a[122:123], v16 offset:256
    ds_read_b64_tr_b16 a[124:125], v16 offset:4096
    ds_read_b64_tr_b16 a[126:127], v16 offset:4352
    ds_read_b64_tr_b16 a[128:129], v16 offset:8192
    ds_read_b64_tr_b16 a[130:131], v16 offset:8448
    ds_read_b64_tr_b16 a[132:133], v16 offset:12288
    ds_read_b64_tr_b16 a[134:135], v16 offset:12544
    ds_read_b64_tr_b16 a[136:137], v16 offset:16384
    ds_read_b64_tr_b16 a[138:139], v16 offset:16640
    ds_read_b64_tr_b16 a[140:141], v16 offset:20480
    ds_read_b64_tr_b16 a[142:143], v16 offset:20736
    s_waitcnt lgkmcnt(0)
    ds_read_b64_tr_b16 a[144:145], v16 offset:24576
    ds_read_b64_tr_b16 a[146:147], v16 offset:24832
    ds_read_b64_tr_b16 a[148:149], v16 offset:28672
    ds_read_b64_tr_b16 a[150:151], v16 offset:28928
    ds_read_b64_tr_b16 a[152:153], v16 offset:32768
    ds_read_b64_tr_b16 a[154:155], v16 offset:33024
    ds_read_b64_tr_b16 a[156:157], v16 offset:36864
    ds_read_b64_tr_b16 a[158:159], v16 offset:37120
    s_waitcnt lgkmcnt(0)
    s_waitcnt lgkmcnt(0)
    s_barrier
    s_mov_b32 s44, s14
    s_mov_b32 s45, s15
    s_and_b32 s45, s45, 0xffff
    s_mov_b32 s46, 0x500000
    s_mov_b32 s47, 0x20000
    s_mul_i32 s94, s73, 81920
    s_add_u32 s94, s94, 40960
    s_lshl_b32 s89, s28, 10
    s_add_u32 s89, s89, 122880
    s_lshl_b32 s88, s28, 6
    v_add_u32 v16, s88, v0
    s_mov_b32 s90, 52429
    v_mul_lo_u32 v17, v16, s90
    v_lshrrev_b32 v17, 22, v17
    v_mul_u32_u24 v18, 80, v17
    v_sub_u32 v18, v16, v18
    v_and_b32 v19, 7, v17
    v_lshlrev_b32 v19, 1, v19
    v_xor_b32 v18, v18, v19
    v_mul_u32_u24 v17, 1280, v17
    v_lshl_add_u32 v17, v18, 4, v17
    s_mov_b32 m0, s89
    s_add_u32 s89, s89, 4096
    buffer_load_dwordx4 v17, s[44:47], s94 offen lds
    v_add_u32 v16, 256, v16
    v_mul_lo_u32 v20, v16, s90
    v_lshrrev_b32 v20, 22, v20
    v_mul_u32_u24 v21, 80, v20
    v_sub_u32 v21, v16, v21
    v_and_b32 v22, 7, v20
    v_lshlrev_b32 v22, 1, v22
    v_xor_b32 v21, v21, v22
    v_mul_u32_u24 v20, 1280, v20
    v_lshl_add_u32 v20, v21, 4, v20
    s_mov_b32 m0, s89
    s_add_u32 s89, s89, 4096
    buffer_load_dwordx4 v20, s[44:47], s94 offen lds
    v_add_u32 v16, 256, v16
    v_mul_lo_u32 v17, v16, s90
    v_lshrrev_b32 v17, 22, v17
    v_mul_u32_u24 v18, 80, v17
    v_sub_u32 v18, v16, v18
    v_and_b32 v19, 7, v17
    v_lshlrev_b32 v19, 1, v19
    v_xor_b32 v18, v18, v19
    v_mul_u32_u24 v17, 1280, v17
    v_lshl_add_u32 v17, v18, 4, v17
    s_mov_b32 m0, s89
    s_add_u32 s89, s89, 4096
    buffer_load_dwordx4 v17, s[44:47], s94 offen lds
    v_add_u32 v16, 256, v16
    v_mul_lo_u32 v20, v16, s90
    v_lshrrev_b32 v20, 22, v20
    v_mul_u32_u24 v21, 80, v20
    v_sub_u32 v21, v16, v21
    v_and_b32 v22, 7, v20
    v_lshlrev_b32 v22, 1, v22
    v_xor_b32 v21, v21, v22
    v_mul_u32_u24 v20, 1280, v20
    v_lshl_add_u32 v20, v21, 4, v20
    s_mov_b32 m0, s89
    s_add_u32 s89, s89, 4096
    buffer_load_dwordx4 v20, s[44:47], s94 offen lds
    v_add_u32 v16, 256, v16
    v_mul_lo_u32 v17, v16, s90
    v_lshrrev_b32 v17, 22, v17
    v_mul_u32_u24 v18, 80, v17
    v_sub_u32 v18, v16, v18
    v_and_b32 v19, 7, v17
    v_lshlrev_b32 v19, 1, v19
    v_xor_b32 v18, v18, v19
    v_mul_u32_u24 v17, 1280, v17
    v_lshl_add_u32 v17, v18, 4, v17
    s_mov_b32 m0, s89
    s_add_u32 s89, s89, 4096
    buffer_load_dwordx4 v17, s[44:47], s94 offen lds
    v_add_u32 v16, 256, v16
    v_mul_lo_u32 v20, v16, s90
    v_lshrrev_b32 v20, 22, v20
    v_mul_u32_u24 v21, 80, v20
    v_sub_u32 v21, v16, v21
    v_and_b32 v22, 7, v20
    v_lshlrev_b32 v22, 1, v22
    v_xor_b32 v21, v21, v22
    v_mul_u32_u24 v20, 1280, v20
    v_lshl_add_u32 v20, v21, 4, v20
    s_mov_b32 m0, s89
    s_add_u32 s89, s89, 4096
    buffer_load_dwordx4 v20, s[44:47], s94 offen lds
    v_add_u32 v16, 256, v16
    v_mul_lo_u32 v17, v16, s90
    v_lshrrev_b32 v17, 22, v17
    v_mul_u32_u24 v18, 80, v17
    v_sub_u32 v18, v16, v18
    v_and_b32 v19, 7, v17
    v_lshlrev_b32 v19, 1, v19
    v_xor_b32 v18, v18, v19
    v_mul_u32_u24 v17, 1280, v17
    v_lshl_add_u32 v17, v18, 4, v17
    s_mov_b32 m0, s89
    s_add_u32 s89, s89, 4096
    buffer_load_dwordx4 v17, s[44:47], s94 offen lds
    v_add_u32 v16, 256, v16
    v_mul_lo_u32 v20, v16, s90
    v_lshrrev_b32 v20, 22, v20
    v_mul_u32_u24 v21, 80, v20
    v_sub_u32 v21, v16, v21
    v_and_b32 v22, 7, v20
    v_lshlrev_b32 v22, 1, v22
    v_xor_b32 v21, v21, v22
    v_mul_u32_u24 v20, 1280, v20
    v_lshl_add_u32 v20, v21, 4, v20
    s_mov_b32 m0, s89
    s_add_u32 s89, s89, 4096
    buffer_load_dwordx4 v20, s[44:47], s94 offen lds
    v_add_u32 v16, 256, v16
    v_mul_lo_u32 v17, v16, s90
    v_lshrrev_b32 v17, 22, v17
    v_mul_u32_u24 v18, 80, v17
    v_sub_u32 v18, v16, v18
    v_and_b32 v19, 7, v17
    v_lshlrev_b32 v19, 1, v19
    v_xor_b32 v18, v18, v19
    v_mul_u32_u24 v17, 1280, v17
    v_lshl_add_u32 v17, v18, 4, v17
    s_mov_b32 m0, s89
    s_add_u32 s89, s89, 4096
    buffer_load_dwordx4 v17, s[44:47], s94 offen lds
    v_add_u32 v16, 256, v16
    v_mul_lo_u32 v20, v16, s90
    v_lshrrev_b32 v20, 22, v20
    v_mul_u32_u24 v21, 80, v20
    v_sub_u32 v21, v16, v21
    v_and_b32 v22, 7, v20
    v_lshlrev_b32 v22, 1, v22
    v_xor_b32 v21, v21, v22
    v_mul_u32_u24 v20, 1280, v20
    v_lshl_add_u32 v20, v21, 4, v20
    s_mov_b32 m0, s89
    s_add_u32 s89, s89, 4096
    buffer_load_dwordx4 v20, s[44:47], s94 offen lds
    v_add_u32 v16, 256, v16
    s_waitcnt vmcnt(30)
    s_barrier
    v_bfe_u32 v17, v0, 3, 2
    v_xor_b32 v16, s28, v17
    v_lshlrev_b32_e64 v16, 5, v16
    v_bfe_u32 v17, v0, 4, 1
    v_lshlrev_b32_e64 v17, 4, v17
    v_bfe_u32 v18, v0, 5, 1
    v_lshl_add_u32 v17, v18, 3, v17
    v_bfe_u32 v18, v0, 3, 1
    v_lshl_add_u32 v17, v18, 2, v17
    v_bfe_u32 v18, v0, 2, 1
    v_add_u32 v17, v17, v18
    v_lshlrev_b32 v17, 7, v17
    v_and_b32_e64 v18, 3, v0
    v_lshl_add_u32 v17, v18, 3, v17
    v_add_u32 v16, v16, v17
    v_add_u32 v16, 0, v16
    ds_read_b64_tr_b16 a[160:161], v16 offset:0
    ds_read_b64_tr_b16 a[162:163], v16 offset:256
    ds_read_b64_tr_b16 a[164:165], v16 offset:4096
    ds_read_b64_tr_b16 a[166:167], v16 offset:4352
    ds_read_b64_tr_b16 a[168:169], v16 offset:8192
    ds_read_b64_tr_b16 a[170:171], v16 offset:8448
    ds_read_b64_tr_b16 a[172:173], v16 offset:12288
    ds_read_b64_tr_b16 a[174:175], v16 offset:12544
    ds_read_b64_tr_b16 a[176:177], v16 offset:16384
    ds_read_b64_tr_b16 a[178:179], v16 offset:16640
    ds_read_b64_tr_b16 a[180:181], v16 offset:20480
    ds_read_b64_tr_b16 a[182:183], v16 offset:20736
    s_waitcnt lgkmcnt(0)
    ds_read_b64_tr_b16 a[184:185], v16 offset:24576
    ds_read_b64_tr_b16 a[186:187], v16 offset:24832
    ds_read_b64_tr_b16 a[188:189], v16 offset:28672
    ds_read_b64_tr_b16 a[190:191], v16 offset:28928
    ds_read_b64_tr_b16 a[192:193], v16 offset:32768
    ds_read_b64_tr_b16 a[194:195], v16 offset:33024
    ds_read_b64_tr_b16 a[196:197], v16 offset:36864
    ds_read_b64_tr_b16 a[198:199], v16 offset:37120
    s_waitcnt lgkmcnt(0)
    s_waitcnt lgkmcnt(0)
    s_barrier
    s_waitcnt vmcnt(20)
    s_barrier
    v_bfe_u32 v17, v0, 3, 2
    v_xor_b32 v16, s28, v17
    v_lshlrev_b32 v16, 5, v16
    v_bfe_u32 v17, v0, 4, 1
    v_lshlrev_b32_e64 v17, 4, v17
    v_bfe_u32 v18, v0, 5, 1
    v_lshl_add_u32 v17, v18, 3, v17
    v_bfe_u32 v18, v0, 3, 1
    v_lshl_add_u32 v17, v18, 2, v17
    v_bfe_u32 v18, v0, 2, 1
    v_add_u32 v17, v17, v18
    v_lshlrev_b32 v17, 7, v17
    v_and_b32_e64 v18, 3, v0
    v_lshl_add_u32 v17, v18, 3, v17
    v_add_u32_e64 v16, v16, v17
    v_add_u32 v16, 40960, v16
    ds_read_b64_tr_b16 a[200:201], v16 offset:0
    ds_read_b64_tr_b16 a[202:203], v16 offset:256
    ds_read_b64_tr_b16 a[204:205], v16 offset:4096
    ds_read_b64_tr_b16 a[206:207], v16 offset:4352
    ds_read_b64_tr_b16 a[208:209], v16 offset:8192
    ds_read_b64_tr_b16 a[210:211], v16 offset:8448
    ds_read_b64_tr_b16 a[212:213], v16 offset:12288
    ds_read_b64_tr_b16 a[214:215], v16 offset:12544
    ds_read_b64_tr_b16 a[216:217], v16 offset:16384
    ds_read_b64_tr_b16 a[218:219], v16 offset:16640
    ds_read_b64_tr_b16 a[220:221], v16 offset:20480
    ds_read_b64_tr_b16 a[222:223], v16 offset:20736
    s_waitcnt lgkmcnt(0)
    ds_read_b64_tr_b16 a[224:225], v16 offset:24576
    ds_read_b64_tr_b16 a[226:227], v16 offset:24832
    ds_read_b64_tr_b16 a[228:229], v16 offset:28672
    ds_read_b64_tr_b16 a[230:231], v16 offset:28928
    ds_read_b64_tr_b16 a[232:233], v16 offset:32768
    ds_read_b64_tr_b16 a[234:235], v16 offset:33024
    ds_read_b64_tr_b16 a[236:237], v16 offset:36864
    ds_read_b64_tr_b16 a[238:239], v16 offset:37120
    s_waitcnt lgkmcnt(0)
    s_waitcnt lgkmcnt(0)
    s_barrier
    s_add_u32 s32, s26, 0x5000000
    s_addc_u32 s33, s27, 0
    s_and_b32 s33, s33, 0xffff
    s_mov_b32 s34, 0xa0000
    s_mov_b32 s35, 0x20000
    s_mul_i32 s88, s30, 327680
    s_add_u32 s32, s32, s88
    s_addc_u32 s33, s33, 0
    s_mov_b32 s34, 327680
    s_add_u32 s36, s26, 0x50a0000
    s_addc_u32 s37, s27, 0
    s_and_b32 s37, s37, 0xffff
    s_mov_b32 s38, 0x20000
    s_mov_b32 s39, 0x20000
    s_add_u32 s40, s26, 0x5c0ffff
    s_addc_u32 s41, s27, 0
    s_and_b32 s40, s40, 0xffff0000
    s_and_b32 s41, s41, 0xffff
    s_mov_b32 s42, 0x400000
    s_mov_b32 s43, 0x20000
    s_add_u32 s44, s26, 0x4000000
    s_addc_u32 s45, s27, 0
    s_and_b32 s45, s45, 0xffff
    s_mov_b32 s46, 0x800000
    s_mov_b32 s47, 0x20000
    s_add_u32 s48, s26, 0x4800000
    s_addc_u32 s49, s27, 0
    s_and_b32 s49, s49, 0xffff
    s_mov_b32 s50, 0x400000
    s_mov_b32 s51, 0x20000
    s_mov_b32 s52, s26
    s_mov_b32 s53, s27
    s_and_b32 s53, s53, 0xffff
    s_mov_b32 s54, 0x1000000
    s_mov_b32 s55, 0x20000
    s_add_u32 s56, s26, 0x2000000
    s_addc_u32 s57, s27, 0
    s_and_b32 s57, s57, 0xffff
    s_mov_b32 s58, 0x1000000
    s_mov_b32 s59, 0x20000
    s_add_u32 s60, s26, 0x5500000
    s_addc_u32 s61, s27, 0
    s_and_b32 s61, s61, 0xffff
    s_mov_b32 s62, 0x8000
    s_mov_b32 s63, 0x20000
    s_lshl_b32 s88, s30, 5
    s_add_u32 s88, s88, s31
    s_mul_i32 s67, s88, 2048
    s_lshl_b32 s96, s88, 4
    s_add_u32 s96, s96, 17408
    s_xor_b32 s88, s88, 1
    s_mul_i32 s68, s88, 2048
    s_mov_b32 s80, 16384
    s_mov_b32 s81, 32768
    s_mov_b32 s82, 49152
    s_mov_b32 s83, 65536
    s_lshl_b32 s88, s28, 5
    s_add_u32 s88, s88, s31
    s_lshl_b32 s69, s88, 12
    s_cmp_lt_u32 s88, 80
    s_cselect_b32 s69, s69, -1
    s_lshl_b32 s70, s88, 7
    s_lshr_b32 s89, s88, 5
    s_lshl_b32 s90, s89, 12
    s_cmp_eq_u32 s89, 2
    s_cselect_b32 s90, 16384, s90
    s_and_b32 s89, s88, 31
    s_lshl_b32 s89, s89, 7
    s_add_u32 s90, s90, s89
    s_mul_i32 s71, s30, 32768
    s_add_u32 s71, s71, s90
    s_mov_b32 s72, 0
    s_mov_b32 s77, 0
    s_lshl_b32 s74, s73, 11
    s_lshl_b32 s75, s73, 10
    s_lshl_b32 s76, s73, 12
    s_mov_b32 s87, 0
    s_mov_b32 s78, 0x3e0293ee
    s_mov_b32 s79, 0x3e0293ee
    v_lshrrev_b32 v16, 4, v0
    v_and_b32_e64 v17, 15, v0
    v_bfe_u32 v18, v0, 2, 2
    v_and_b32 v19, 3, v0
    v_lshlrev_b32 v2, 4, v0
    v_cmp_lt_u32_e64 vcc, 7, v17
    v_mov_b32 v1, 0x4444
    v_mov_b32 v20, 0xeeee
    v_cndmask_b32 v1, v1, v20, vcc
    v_and_b32 v20, 7, v0
    v_lshl_add_u32 v20, v16, 3, v20
    v_lshlrev_b32 v10, 4, v20
    v_mov_b32 v21, 1073741824
    v_cndmask_b32 v11, v10, v21, vcc
    s_mul_i32 s88, s28, 81920
    s_lshl_b32 s89, s31, 7
    s_add_u32 s88, s88, s89
    v_lshlrev_b32 v20, 12, v16
    v_lshl_add_u32 v20, v17, 4, v20
    v_add_u32 v20, s88, v20
    v_cndmask_b32 v12, v20, v21, vcc
    v_lshlrev_b32_e64 v20, 4, v17
    v_lshl_add_u32 v20, v16, 3, v20
    v_cndmask_b32 v20, v20, v21, vcc
    v_cmp_lt_u32 vcc, 31, v0
    s_nop 1
    v_cndmask_b32 v13, v20, v21, vcc
    s_lshl_b32 s88, s28, 4
    v_add_u32 v20, s88, v17
    v_and_b32 v21, 1, v16
    v_lshlrev_b32 v22, 4, v20
    v_lshl_add_u32 v22, v21, 3, v22
    v_add_u32 v22, 20480, v22
    v_lshlrev_b32_e64 v23, 5, v20
    v_lshl_add_u32 v23, v21, 4, v23
    v_add_u32 v23, 21504, v23
    v_cndmask_b32 v3, v22, v23, vcc
    v_add_u32 v22, 4, v22
    v_add_u32 v23, 8, v23
    v_cndmask_b32 v4, v22, v23, vcc
    v_lshlrev_b32_e64 v22, 4, v20
    v_lshl_add_u32 v22, v21, 3, v22
    v_lshrrev_b32_e64 v23, 5, v0
    v_lshl_add_u32 v22, v23, 2, v22
    v_add_u32 v5, 23552, v22
    v_lshl_add_u32 v20, v16, 2, v18
    v_and_b32 v21, 1, v19
    v_lshlrev_b32 v21, 3, v21
    v_lshl_add_u32 v6, v20, 4, v21
    v_add_u32 v6, 20480, v6
    v_lshlrev_b32_e64 v21, 3, v19
    v_lshl_add_u32 v7, v20, 5, v21
    v_add_u32 v7, 21504, v7
    v_add_u32 v8, 32768, v2
    v_lshlrev_b32_e64 v21, 2, v16
    v_lshl_add_u32 v9, v17, 4, v21
    v_add_u32 v9, 23552, v9
    s_mul_i32 s88, s28, 160
    v_add_u32 v20, s88, v0
    v_lshlrev_b32 v15, 4, v20
    v_lshrrev_b32 v21, 8, v20
    v_lshlrev_b32 v22, 12, v21
    v_cmp_eq_u32_e64 vcc, 2, v21
    v_mov_b32 v23, 16384
    s_nop 0
    v_cndmask_b32 v22, v22, v23, vcc
    v_and_b32 v21, 255, v20
    v_lshl_add_u32 v14, v21, 4, v22
    v_add_u32 v20, 64, v20
    v_lshrrev_b32 v21, 8, v20
    v_lshlrev_b32 v22, 12, v21
    v_cmp_eq_u32 vcc, 2, v21
    v_mov_b32 v23, 16384
    s_nop 0
    v_cndmask_b32 v22, v22, v23, vcc
    v_and_b32 v21, 255, v20
    v_lshl_add_u32 v188, v21, 4, v22
    v_lshrrev_b32 v20, 1, v0
    v_add_u32 v20, s88, v20
    v_add_u32 v20, 128, v20
    v_lshlrev_b32 v190, 4, v20
    v_lshrrev_b32 v21, 8, v20
    v_lshlrev_b32 v22, 12, v21
    v_cmp_eq_u32 vcc, 2, v21
    v_mov_b32 v23, 16384
    s_nop 0
    v_cndmask_b32 v22, v22, v23, vcc
    v_and_b32 v21, 255, v20
    v_lshl_add_u32 v189, v21, 4, v22
    v_and_b32 v20, 1, v0
    v_lshlrev_b32 v20, 3, v20
    v_add_u32 v189, v189, v20
    v_add_u32 v190, v190, v20
    v_mov_b32 v24, 0x3f803f80
    v_mov_b32 v25, 0x3f803f80
    v_mov_b32 v26, 0x3f803f80
    v_mov_b32 v27, 0x3f803f80
    v_mov_b32 v20, 0x3f80
    v_mov_b32 v21, 0x3f800000
    v_cmp_eq_u32 vcc, 0, v17
    s_nop 1
    v_cndmask_b32 v28, 0, v20, vcc
    v_cmp_eq_u32 vcc, 1, v17
    s_nop 1
    v_cndmask_b32 v28, v28, v21, vcc
    v_cmp_eq_u32 vcc, 2, v17
    s_nop 1
    v_cndmask_b32 v29, 0, v20, vcc
    v_cmp_eq_u32 vcc, 3, v17
    s_nop 1
    v_cndmask_b32 v29, v29, v21, vcc
    v_cmp_eq_u32 vcc, 4, v17
    s_nop 1
    v_cndmask_b32 v30, 0, v20, vcc
    v_cmp_eq_u32 vcc, 5, v17
    s_nop 1
    v_cndmask_b32 v30, v30, v21, vcc
    v_cmp_eq_u32 vcc, 6, v17
    s_nop 1
    v_cndmask_b32 v31, 0, v20, vcc
    v_cmp_eq_u32 vcc, 7, v17
    s_nop 1
    v_cndmask_b32 v31, v31, v21, vcc
    s_lshl_b32 s88, s28, 10
    v_add_u32_e64 v16, s88, v2
    ds_write_b128 v16, v[124:127] offset:0
    ds_write_b128 v16, v[128:131] offset:4096
    s_cmp_ge_u32 s28, 2
    s_cbranch_scc1 m0skip_73
    ds_write_b128 v16, v[132:135] offset:8192
m0skip_73:
    v_lshrrev_b32 v16, 1, v16
    v_mov_b32 v18, 0
    v_mov_b32_e64 v19, 0
    ds_write_b64 v16, v[18:19] offset:21504
    s_mov_b32 s64, 0
    s_mov_b32 s65, 0
    s_waitcnt vmcnt(10)
    s_barrier
    v_lshrrev_b32_e64 v16, 4, v0
    v_bfe_u32 v17, v0, 2, 2
    v_lshl_add_u32 v17, v16, 2, v17
    v_and_b32 v19, 7, v17
    v_lshlrev_b32 v19, 1, v19
    v_mul_u32_u24 v22, 1280, v17
    v_and_b32_e64 v20, 1, v0
    v_lshl_add_u32 v22, v20, 3, v22
    v_add_u32 v22, 81920, v22
    v_bfe_u32 v20, v0, 1, 1
    s_mul_i32 s88, s28, 20
    s_add_u32 s89, s88, 0
    v_add_u32 v16, s89, v20
    v_xor_b32 v16, v16, v19
    v_lshl_add_u32 v16, v16, 4, v22
    ds_read_b64_tr_b16 a[240:241], v16 offset:0
    ds_read_b64_tr_b16 a[242:243], v16 offset:20480
    s_add_u32 s89, s88, 2
    v_add_u32 v17, s89, v20
    v_xor_b32_e64 v17, v17, v19
    v_lshl_add_u32 v17, v17, 4, v22
    ds_read_b64_tr_b16 a[248:249], v17 offset:0
    ds_read_b64_tr_b16 a[250:251], v17 offset:20480
    s_add_u32 s89, s88, 4
    v_add_u32 v16, s89, v20
    v_xor_b32_e64 v16, v16, v19
    v_lshl_add_u32 v16, v16, 4, v22
    ds_read_b64_tr_b16 v[192:193], v16 offset:0
    ds_read_b64_tr_b16 v[194:195], v16 offset:20480
    s_add_u32 s89, s88, 6
    v_add_u32 v17, s89, v20
    v_xor_b32_e64 v17, v17, v19
    v_lshl_add_u32 v17, v17, 4, v22
    ds_read_b64_tr_b16 v[200:201], v17 offset:0
    ds_read_b64_tr_b16 v[202:203], v17 offset:20480
    s_add_u32 s89, s88, 8
    v_add_u32 v16, s89, v20
    v_xor_b32_e64 v16, v16, v19
    v_lshl_add_u32 v16, v16, 4, v22
    ds_read_b64_tr_b16 v[208:209], v16 offset:0
    ds_read_b64_tr_b16 v[210:211], v16 offset:20480
    s_waitcnt lgkmcnt(0)
    s_add_u32 s89, s88, 10
    v_add_u32 v17, s89, v20
    v_xor_b32 v17, v17, v19
    v_lshl_add_u32 v17, v17, 4, v22
    ds_read_b64_tr_b16 v[216:217], v17 offset:0
    ds_read_b64_tr_b16 v[218:219], v17 offset:20480
    s_add_u32 s89, s88, 12
    v_add_u32 v16, s89, v20
    v_xor_b32_e64 v16, v16, v19
    v_lshl_add_u32 v16, v16, 4, v22
    ds_read_b64_tr_b16 v[224:225], v16 offset:0
    ds_read_b64_tr_b16 v[226:227], v16 offset:20480
    s_add_u32 s89, s88, 14
    v_add_u32 v17, s89, v20
    v_xor_b32_e64 v17, v17, v19
    v_lshl_add_u32 v17, v17, 4, v22
    ds_read_b64_tr_b16 v[232:233], v17 offset:0
    ds_read_b64_tr_b16 v[234:235], v17 offset:20480
    s_add_u32 s89, s88, 16
    v_add_u32 v16, s89, v20
    v_xor_b32_e64 v16, v16, v19
    v_lshl_add_u32 v16, v16, 4, v22
    ds_read_b64_tr_b16 v[240:241], v16 offset:0
    ds_read_b64_tr_b16 v[242:243], v16 offset:20480
    s_add_u32 s89, s88, 18
    v_add_u32 v17, s89, v20
    v_xor_b32_e64 v17, v17, v19
    v_lshl_add_u32 v17, v17, 4, v22
    ds_read_b64_tr_b16 v[248:249], v17 offset:0
    ds_read_b64_tr_b16 v[250:251], v17 offset:20480
    s_waitcnt lgkmcnt(0)
    s_waitcnt vmcnt(0)
    s_barrier
    v_lshrrev_b32 v16, 4, v0
    v_bfe_u32 v17, v0, 2, 2
    v_lshl_add_u32 v17, v16, 2, v17
    v_and_b32 v19, 7, v17
    v_lshlrev_b32 v19, 1, v19
    v_mul_u32_u24 v22, 1280, v17
    v_and_b32_e64 v20, 1, v0
    v_lshl_add_u32 v22, v20, 3, v22
    v_add_u32 v22, 122880, v22
    v_bfe_u32 v20, v0, 1, 1
    s_mul_i32 s88, s28, 20
    s_add_u32 s89, s88, 0
    v_add_u32 v16, s89, v20
    v_xor_b32 v16, v16, v19
    v_lshl_add_u32 v16, v16, 4, v22
    ds_read_b64_tr_b16 a[244:245], v16 offset:0
    ds_read_b64_tr_b16 a[246:247], v16 offset:20480
    s_add_u32 s89, s88, 2
    v_add_u32 v17, s89, v20
    v_xor_b32_e64 v17, v17, v19
    v_lshl_add_u32 v17, v17, 4, v22
    ds_read_b64_tr_b16 a[252:253], v17 offset:0
    ds_read_b64_tr_b16 a[254:255], v17 offset:20480
    s_add_u32 s89, s88, 4
    v_add_u32 v16, s89, v20
    v_xor_b32_e64 v16, v16, v19
    v_lshl_add_u32 v16, v16, 4, v22
    ds_read_b64_tr_b16 v[196:197], v16 offset:0
    ds_read_b64_tr_b16 v[198:199], v16 offset:20480
    s_add_u32 s89, s88, 6
    v_add_u32 v17, s89, v20
    v_xor_b32_e64 v17, v17, v19
    v_lshl_add_u32 v17, v17, 4, v22
    ds_read_b64_tr_b16 v[204:205], v17 offset:0
    ds_read_b64_tr_b16 v[206:207], v17 offset:20480
    s_add_u32 s89, s88, 8
    v_add_u32 v16, s89, v20
    v_xor_b32_e64 v16, v16, v19
    v_lshl_add_u32 v16, v16, 4, v22
    ds_read_b64_tr_b16 v[212:213], v16 offset:0
    ds_read_b64_tr_b16 v[214:215], v16 offset:20480
    s_waitcnt lgkmcnt(0)
    s_add_u32 s89, s88, 10
    v_add_u32 v17, s89, v20
    v_xor_b32 v17, v17, v19
    v_lshl_add_u32 v17, v17, 4, v22
    ds_read_b64_tr_b16 v[220:221], v17 offset:0
    ds_read_b64_tr_b16 v[222:223], v17 offset:20480
    s_add_u32 s89, s88, 12
    v_add_u32 v16, s89, v20
    v_xor_b32_e64 v16, v16, v19
    v_lshl_add_u32 v16, v16, 4, v22
    ds_read_b64_tr_b16 v[228:229], v16 offset:0
    ds_read_b64_tr_b16 v[230:231], v16 offset:20480
    s_add_u32 s89, s88, 14
    v_add_u32 v17, s89, v20
    v_xor_b32_e64 v17, v17, v19
    v_lshl_add_u32 v17, v17, 4, v22
    ds_read_b64_tr_b16 v[236:237], v17 offset:0
    ds_read_b64_tr_b16 v[238:239], v17 offset:20480
    s_add_u32 s89, s88, 16
    v_add_u32 v16, s89, v20
    v_xor_b32_e64 v16, v16, v19
    v_lshl_add_u32 v16, v16, 4, v22
    ds_read_b64_tr_b16 v[244:245], v16 offset:0
    ds_read_b64_tr_b16 v[246:247], v16 offset:20480
    s_add_u32 s89, s88, 18
    v_add_u32 v17, s89, v20
    v_xor_b32_e64 v17, v17, v19
    v_lshl_add_u32 v17, v17, 4, v22
    ds_read_b64_tr_b16 v[252:253], v17 offset:0
    ds_read_b64_tr_b16 v[254:255], v17 offset:20480
    s_waitcnt lgkmcnt(0)
    s_waitcnt lgkmcnt(0)
    s_lshl_b32 s8, s73, 4
    s_add_u32 s8, s8, 0
    s_add_u32 s9, s8, 1024
    v_mov_b32 v112, 0
    v_mov_b32 v113, 0
    v_mov_b32 v114, 0
    v_mov_b32 v115, 0
    v_mov_b32 v116, 0
    v_mov_b32 v117, 0
    v_mov_b32 v118, 0
    v_mov_b32 v119, 0
    v_mov_b32 v120, 0
    v_mov_b32 v121, 0
    v_mov_b32_e64 v122, 0
    v_mov_b32 v123, 0
    s_cmp_eq_u32 s28, 3
    s_cbranch_scc0 pf0skip_74
    s_lshr_b32 s88, s64, 2
    s_add_u32 s88, s88, 1
    s_min_u32 s88, s88, 16
    s_cmp_ge_u32 s87, s88
    s_cbranch_scc1 w1ok_75
    v_mov_b32 v16, 0
    s_mov_b32 s66, 0
w1poll_76:
    buffer_load_dwordx4 v[144:147], v16, s[60:63], s8 offen sc1
    buffer_load_dwordx4 v[140:143], v16, s[60:63], s9 offen sc1
    s_waitcnt vmcnt(0)
    v_min3_u32 v17, v144, v145, v146
    v_min3_u32 v17, v147, v140, v17
    v_min3_u32 v17, v141, v142, v17
    v_min_u32 v17, v143, v17
    s_nop 0
    v_readfirstlane_b32 s87, v17
    s_cmp_ge_u32 s87, s88
    s_cbranch_scc1 w1ok_75
    s_add_u32 s66, s66, 1
    s_cmp_lt_u32 s66, 400000
    s_cbranch_scc1 w1poll_76
    s_branch k_fail
w1ok_75:
    s_mov_b32 s93, 32768
    s_lshl_b32 s88, s64, 18
    s_add_u32 s88, s88, s76
    s_mov_b32 m0, s93
    s_nop 0
    buffer_load_dwordx4 v2, s[52:55], s88 offen offset:0 sc1 lds
    buffer_load_dwordx4 v2, s[52:55], s88 offen offset:1024 sc1 lds
    buffer_load_dwordx4 v2, s[52:55], s88 offen offset:2048 sc1 lds
    buffer_load_dwordx4 v2, s[52:55], s88 offen offset:3072 sc1 lds
    s_add_u32 s89, s93, 4096
    s_mov_b32 m0, s89
    s_nop 0
    buffer_load_dwordx4 v2, s[56:59], s88 offen offset:0 sc1 lds
    buffer_load_dwordx4 v2, s[56:59], s88 offen offset:1024 sc1 lds
    buffer_load_dwordx4 v2, s[56:59], s88 offen offset:2048 sc1 lds
    buffer_load_dwordx4 v2, s[56:59], s88 offen offset:3072 sc1 lds
    s_mov_b32 s93, 40960
    s_mov_b32 s94, 1
    s_lshl_b32 s88, s94, 18
    s_add_u32 s88, s88, s76
    s_mov_b32 m0, s93
    s_nop 0
    buffer_load_dwordx4 v2, s[52:55], s88 offen offset:0 sc1 lds
    buffer_load_dwordx4 v2, s[52:55], s88 offen offset:1024 sc1 lds
    buffer_load_dwordx4 v2, s[52:55], s88 offen offset:2048 sc1 lds
    buffer_load_dwordx4 v2, s[52:55], s88 offen offset:3072 sc1 lds
    s_add_u32 s89, s93, 4096
    s_mov_b32 m0, s89
    s_nop 0
    buffer_load_dwordx4 v2, s[56:59], s88 offen offset:0 sc1 lds
    buffer_load_dwordx4 v2, s[56:59], s88 offen offset:1024 sc1 lds
    buffer_load_dwordx4 v2, s[56:59], s88 offen offset:2048 sc1 lds
    buffer_load_dwordx4 v2, s[56:59], s88 offen offset:3072 sc1 lds
pf0skip_74:
    s_lshr_b32 s18, s40, 21
    s_xor_b32 s18, s18, 0
    s_add_u32 s88, s40, s72
    s_lshr_b32 s88, s88, 21
    s_xor_b32 s88, s88, s18
    s_and_b32 s88, s88, 1
    s_lshl_b32 s19, s88, 13
    s_mov_b32 s77, 0x3f80
    s_mov_b32 s70, 0x3f800000
    s_mov_b32 s86, 0xffff0000
    s_cmp_lt_u32 s28, 2
    s_mov_b32 s89, 75497472
    s_cselect_b32 s88, 67108864, s89
    s_add_u32 s44, s26, s88
    s_addc_u32 s45, s27, 0
    s_and_b32 s45, s45, 0xffff
    s_mov_b32 s46, 8388608
    s_mov_b32 s47, 0x20000
    s_lshl_b32 s88, s28, 10
    s_add_u32 s88, s88, s74
    s_cmp_lt_u32 s28, 2
    s_cselect_b32 s100, s88, s75
    s_mov_b32 s89, 65536
    s_cselect_b32 s74, 131072, s89
    s_lshl_b32 s88, s28, 10
    s_add_u32 s88, s88, 21504
    s_cmp_lt_u32 s28, 2
    s_cselect_b32 s88, s88, 23552
    v_add_u32 v22, s88, v2
    s_cmp_eq_u32 s28, 3
    s_cselect_b32 s88, 1073741824, 0
    v_add_u32 v21, s88, v2
    s_lshl_b32 s89, s30, 7
    s_add_u32 s89, s89, 16384
    v_mov_b32 v23, 1073741824
    v_mov_b32 v20, s89
    v_cmp_eq_u32 vcc, 0, v0
    s_nop 1
    v_cndmask_b32 v23, v23, v20, vcc
    s_or_b32 s95, s31, s28
    s_cmp_lt_u32 s28, 2
    s_mov_b32 s89, 33554432
    s_cselect_b32 s88, 0, s89
    s_add_u32 s52, s26, s88
    s_addc_u32 s53, s27, 0
    s_and_b32 s53, s53, 0xffff
    s_mov_b32 s54, 16777216
    s_mov_b32 s55, 0x20000
    s_and_b32 s88, s28, 1
    s_lshl_b32 s88, s88, 11
    s_add_u32 s101, s88, s76
    s_lshl_b32 s85, s28, 11
    s_add_u32 s85, s85, 32768
    s_waitcnt vmcnt(0) lgkmcnt(0)
    s_barrier
    ds_read_b128 v[72:75], v2 offset:0
    ds_read_b128 v[76:79], v2 offset:1024
    ds_read_b128 v[80:83], v2 offset:2048
    ds_read_b128 v[84:87], v2 offset:3072
    s_waitcnt lgkmcnt(3)
    v_smfmac_f32_16x16x64_bf16 v[112:115], v[72:75], a[0:7], v1
    ds_read_b128 v[88:91], v2 offset:4096
    v_smfmac_f32_16x16x64_bf16 v[116:119], v[72:75], a[80:87], v1
    s_waitcnt lgkmcnt(3)
    v_smfmac_f32_16x16x64_bf16 v[112:115], v[76:79], a[8:15], v1
    ds_read_b128 v[92:95], v2 offset:5120
    v_smfmac_f32_16x16x64_bf16 v[116:119], v[76:79], a[88:95], v1
    s_waitcnt lgkmcnt(3)
    v_smfmac_f32_16x16x64_bf16 v[112:115], v[80:83], a[16:23], v1
    ds_read_b128 v[96:99], v2 offset:6144
    v_smfmac_f32_16x16x64_bf16 v[116:119], v[80:83], a[96:103], v1
    s_waitcnt lgkmcnt(3)
    v_smfmac_f32_16x16x64_bf16 v[112:115], v[84:87], a[24:31], v1
    ds_read_b128 v[100:103], v2 offset:7168
    v_smfmac_f32_16x16x64_bf16 v[116:119], v[84:87], a[104:111], v1
    s_waitcnt lgkmcnt(3)
    v_smfmac_f32_16x16x64_bf16 v[112:115], v[88:91], a[32:39], v1
    ds_read_b128 v[104:107], v2 offset:8192
    v_smfmac_f32_16x16x64_bf16 v[116:119], v[88:91], a[112:119], v1
    s_waitcnt lgkmcnt(3)
    v_smfmac_f32_16x16x64_bf16 v[112:115], v[92:95], a[40:47], v1
    ds_read_b128 v[108:111], v2 offset:9216
    v_smfmac_f32_16x16x64_bf16 v[116:119], v[92:95], a[120:127], v1
    s_waitcnt lgkmcnt(3)
    v_smfmac_f32_16x16x64_bf16 v[112:115], v[96:99], a[48:55], v1
    ds_read_b128 v[140:143], v8 offset:0
    ds_read_b128 v[144:147], v8 offset:1024
    v_smfmac_f32_16x16x64_bf16 v[116:119], v[96:99], a[128:135], v1
    s_waitcnt lgkmcnt(4)
    v_smfmac_f32_16x16x64_bf16 v[112:115], v[100:103], a[56:63], v1
    ds_read_b128 v[148:151], v8 offset:2048
    ds_read_b128 v[152:155], v8 offset:3072
    v_smfmac_f32_16x16x64_bf16 v[116:119], v[100:103], a[136:143], v1
    s_waitcnt lgkmcnt(5)
    v_smfmac_f32_16x16x64_bf16 v[112:115], v[104:107], a[64:71], v1
    v_smfmac_f32_16x16x64_bf16 v[116:119], v[104:107], a[144:151], v1
    s_waitcnt lgkmcnt(4)
    v_smfmac_f32_16x16x64_bf16 v[112:115], v[108:111], a[72:79], v1
    v_smfmac_f32_16x16x64_bf16 v[116:119], v[108:111], a[152:159], v1
    s_branch phaseB_77
.p2align 6
    s_nop 0
    s_nop 0
step_78:
    s_waitcnt vmcnt(0) lgkmcnt(0)
    s_barrier
    s_add_u32 s64, s64, 1
    s_xor_b32 s65, s65, 1
    s_add_u32 s71, s71, 65536
    s_add_u32 s72, s72, 65536
    s_add_u32 s91, s40, s72
    s_lshr_b32 s91, s91, 21
    s_xor_b32 s91, s91, s18
    s_and_b32 s91, s91, 1
    s_lshl_b32 s19, s91, 13
    v_xor_b32 v8, 0x2000, v8
ag_79:
    buffer_load_dwordx4 v[124:127], v14, s[40:43], s97 offen sc1
    buffer_load_dwordx4 v[128:131], v188, s[40:43], s97 offen sc1
    buffer_load_dwordx2 v[132:133], v189, s[40:43], s97 offen sc1
    buffer_load_dwordx4 v[134:137], v14, s[40:43], s98 offen sc1
    buffer_load_dwordx4 v[138:141], v188, s[40:43], s98 offen sc1
    buffer_load_dwordx2 v[142:143], v189, s[40:43], s98 offen sc1
.p2align 5
    s_waitcnt vmcnt(0)
    v_max3_u32 v16, v124, v126, v128
    v_max3_u32 v17, v130, v132, v134
    v_max3_u32 v16, v136, v138, v16
    v_max3_u32 v17, v140, v142, v17
    v_max_u32 v16, v16, v17
    v_cmp_eq_u32 vcc, -1, v16
    s_cbranch_vccnz ag_retry_80
    v_lshlrev_b32 v156, 16, v124
    v_and_b32 v157, s86, v124
    v_lshlrev_b32 v158, 16, v125
    v_and_b32 v159, s86, v125
    v_lshlrev_b32 v160, 16, v126
    v_and_b32 v161, s86, v126
    v_lshlrev_b32 v162, 16, v127
    v_and_b32 v163, s86, v127
    v_dot2c_f32_bf16 v156, s77, v134
    v_dot2c_f32_bf16 v157, s70, v134
    v_dot2c_f32_bf16 v158, s77, v135
    v_dot2c_f32_bf16 v159, s70, v135
    v_dot2c_f32_bf16 v160, s77, v136
    v_dot2c_f32_bf16 v161, s70, v136
    v_dot2c_f32_bf16 v162, s77, v137
    v_dot2c_f32_bf16 v163, s70, v137
    v_cvt_pk_bf16_f32 v124, v156, v157
    v_cvt_pk_bf16_f32 v125, v158, v159
    v_cvt_pk_bf16_f32 v126, v160, v161
    v_cvt_pk_bf16_f32 v127, v162, v163
    ds_write_b128 v15, v[124:127]
    v_lshlrev_b32 v164, 16, v128
    v_and_b32 v165, s86, v128
    v_lshlrev_b32 v166, 16, v129
    v_and_b32 v167, s86, v129
    v_lshlrev_b32 v168, 16, v130
    v_and_b32 v169, s86, v130
    v_lshlrev_b32 v170, 16, v131
    v_and_b32 v171, s86, v131
    v_dot2c_f32_bf16 v164, s77, v138
    v_dot2c_f32_bf16 v165, s70, v138
    v_dot2c_f32_bf16 v166, s77, v139
    v_dot2c_f32_bf16 v167, s70, v139
    v_dot2c_f32_bf16 v168, s77, v140
    v_dot2c_f32_bf16 v169, s70, v140
    v_dot2c_f32_bf16 v170, s77, v141
    v_dot2c_f32_bf16 v171, s70, v141
    v_cvt_pk_bf16_f32 v128, v164, v165
    v_cvt_pk_bf16_f32 v129, v166, v167
    v_cvt_pk_bf16_f32 v130, v168, v169
    v_cvt_pk_bf16_f32 v131, v170, v171
    ds_write_b128 v15, v[128:131] offset:1024
    v_lshlrev_b32 v172, 16, v132
    v_and_b32 v173, s86, v132
    v_lshlrev_b32_e64 v174, 16, v133
    v_and_b32 v175, s86, v133
    v_dot2c_f32_bf16 v172, s77, v142
    v_dot2c_f32_bf16 v173, s70, v142
    v_dot2c_f32_bf16 v174, s77, v143
    v_dot2c_f32_bf16 v175, s70, v143
    s_nop 0
    v_cvt_pk_bf16_f32 v132, v172, v173
    s_nop 0
    v_cvt_pk_bf16_f32 v133, v174, v175
    ds_write_b64 v190, v[132:133]
    v_mov_b32 v20, s10
    buffer_store_dword v20, v23, s[60:63], s29 offen sc1
    buffer_store_dwordx4 v[176:179], v21, s[44:47], s100 offen sc1
    s_add_u32 s100, s100, s74
    buffer_load_dwordx4 v2, s[52:55], s17 offen offset:0 sc1 lds
    buffer_load_dwordx4 v2, s[52:55], s17 offen offset:1024 sc1 lds
.p2align 5
    s_waitcnt lgkmcnt(0)
    s_barrier
    ds_read_b128 v[72:75], v2 offset:0
    ds_read_b128 v[76:79], v2 offset:1024
    ds_read_b128 v[80:83], v2 offset:2048
    ds_read_b128 v[84:87], v2 offset:3072
    s_waitcnt lgkmcnt(3)
    v_smfmac_f32_16x16x64_bf16 v[112:115], v[72:75], a[0:7], v1
    ds_read_b128 v[88:91], v2 offset:4096
    v_smfmac_f32_16x16x64_bf16 v[116:119], v[72:75], a[80:87], v1
    s_waitcnt lgkmcnt(3)
    v_smfmac_f32_16x16x64_bf16 v[112:115], v[76:79], a[8:15], v1
    ds_read_b128 v[92:95], v2 offset:5120
    v_smfmac_f32_16x16x64_bf16 v[116:119], v[76:79], a[88:95], v1
    s_waitcnt lgkmcnt(3)
    v_smfmac_f32_16x16x64_bf16 v[112:115], v[80:83], a[16:23], v1
    ds_read_b128 v[96:99], v2 offset:6144
    v_smfmac_f32_16x16x64_bf16 v[116:119], v[80:83], a[96:103], v1
    s_waitcnt lgkmcnt(3)
    v_smfmac_f32_16x16x64_bf16 v[112:115], v[84:87], a[24:31], v1
    ds_read_b128 v[100:103], v2 offset:7168
    v_smfmac_f32_16x16x64_bf16 v[116:119], v[84:87], a[104:111], v1
    s_waitcnt lgkmcnt(3)
    v_smfmac_f32_16x16x64_bf16 v[112:115], v[88:91], a[32:39], v1
    ds_read_b128 v[104:107], v2 offset:8192
    v_smfmac_f32_16x16x64_bf16 v[116:119], v[88:91], a[112:119], v1
    s_waitcnt lgkmcnt(3)
    v_smfmac_f32_16x16x64_bf16 v[112:115], v[92:95], a[40:47], v1
    ds_read_b128 v[108:111], v2 offset:9216
    v_smfmac_f32_16x16x64_bf16 v[116:119], v[92:95], a[120:127], v1
    s_waitcnt lgkmcnt(3)
    v_smfmac_f32_16x16x64_bf16 v[112:115], v[96:99], a[48:55], v1
    ds_read_b128 v[140:143], v8 offset:0
    ds_read_b128 v[144:147], v8 offset:1024
    v_smfmac_f32_16x16x64_bf16 v[116:119], v[96:99], a[128:135], v1
    s_waitcnt lgkmcnt(4)
    v_smfmac_f32_16x16x64_bf16 v[112:115], v[100:103], a[56:63], v1
    ds_read_b128 v[148:151], v8 offset:2048
    ds_read_b128 v[152:155], v8 offset:3072
    v_smfmac_f32_16x16x64_bf16 v[116:119], v[100:103], a[136:143], v1
    s_waitcnt lgkmcnt(5)
    v_smfmac_f32_16x16x64_bf16 v[112:115], v[104:107], a[64:71], v1
    v_smfmac_f32_16x16x64_bf16 v[116:119], v[104:107], a[144:151], v1
    s_waitcnt lgkmcnt(4)
    v_smfmac_f32_16x16x64_bf16 v[112:115], v[108:111], a[72:79], v1
    v_smfmac_f32_16x16x64_bf16 v[116:119], v[108:111], a[152:159], v1
phaseB_77:
    v_smfmac_f32_16x16x64_bf16 v[120:123], v[72:75], a[160:167], v1
    s_nop 6
    v_permlane32_swap_b32 v112, v116
    v_permlane32_swap_b32 v113, v117
    v_permlane32_swap_b32 v114, v118
    v_permlane32_swap_b32 v115, v119
    v_add_f32 v112, v112, v116
    v_add_f32 v113, v113, v117
    v_add_f32 v114, v114, v118
    v_add_f32_e64 v115, v115, v119
    v_cvt_pk_bf16_f32 v116, v112, v113
    v_cvt_pk_bf16_f32 v117, v114, v115
    ds_write_b32 v3, v116
    ds_write_b32 v4, v117
    v_smfmac_f32_16x16x64_bf16 v[120:123], v[76:79], a[168:175], v1
    v_smfmac_f32_16x16x64_bf16 v[120:123], v[80:83], a[176:183], v1
.p2align 5
    s_waitcnt lgkmcnt(0)
    s_barrier
    ds_read_b64_tr_b16 v[124:125], v6 offset:0
    ds_read_b64_tr_b16 v[126:127], v6 offset:256
    ds_read_b64_tr_b16 v[132:133], v7 offset:0
    ds_read_b64_tr_b16 v[134:135], v7 offset:512
    ds_read_b64_tr_b16 v[128:129], v6 offset:512
    ds_read_b64_tr_b16 v[130:131], v6 offset:768
    ds_read_b64_tr_b16 v[136:137], v7 offset:1024
    ds_read_b64_tr_b16 v[138:139], v7 offset:1536
    v_smfmac_f32_16x16x64_bf16 v[120:123], v[84:87], a[184:191], v1
    v_smfmac_f32_16x16x64_bf16 v[120:123], v[88:91], a[192:199], v1
    s_waitcnt lgkmcnt(6)
    v_mfma_f32_16x16x32_bf16 v[160:163], v[140:143], v[124:127], 0
    v_mfma_f32_16x16x32_bf16 v[164:167], v[144:147], v[124:127], 0
    s_waitcnt lgkmcnt(4)
    v_mfma_f32_16x16x32_bf16 v[156:159], v[132:135], v[124:127], 0
    s_waitcnt lgkmcnt(2)
    v_mfma_f32_16x16x32_bf16 v[160:163], v[148:151], v[128:131], v[160:163]
    v_mfma_f32_16x16x32_bf16 v[164:167], v[152:155], v[128:131], v[164:167]
    s_waitcnt lgkmcnt(0)
    v_mfma_f32_16x16x32_bf16 v[156:159], v[136:139], v[128:131], v[156:159]
    v_smfmac_f32_16x16x64_bf16 v[120:123], v[92:95], a[200:207], v1
    v_smfmac_f32_16x16x64_bf16 v[120:123], v[96:99], a[208:215], v1
    s_cmp_eq_u32 s28, 0
    s_cbranch_scc0 pairskip_82
    s_nop 0
    v_and_or_b32 v160, v160, -2, s65
    v_and_or_b32 v164, v164, -2, s65
    s_nop 0
    v_and_or_b32 v156, v156, -2, s65
    buffer_store_dwordx4 v[160:163], v11, s[36:39], s67 offen sc1
    buffer_store_dwordx4 v[164:167], v11, s[36:39], s67 offen offset:512 sc1
    buffer_store_dwordx2 v[156:157], v11, s[36:39], s67 offen offset:1024 sc1
pairskip_82:
    v_smfmac_f32_16x16x64_bf16 v[120:123], v[100:103], a[216:223], v1
    v_smfmac_f32_16x16x64_bf16 v[120:123], v[104:107], a[224:231], v1
    v_smfmac_f32_16x16x64_bf16 v[120:123], v[108:111], a[232:239], v1
    ds_read_b128 v[124:127], v8 offset:4096
    ds_read_b128 v[128:131], v8 offset:5120
    ds_read_b128 v[132:135], v8 offset:6144
    ds_read_b128 v[136:139], v8 offset:7168
    v_mov_b32 v141, 0
    v_mov_b32 v143, 0
    v_mov_b32 v145, 0
    v_mov_b32 v147, 0
    v_mov_b32_e64 v117, 0
    s_and_b32 s88, s64, 7
    s_cmp_eq_u32 s88, 0
    s_cselect_b32 s29, 0, 1073741824
    s_cmp_ge_u32 s64, 58
    s_cselect_b32 s29, 0, s29
    s_cmp_eq_u32 s95, 0
    s_cselect_b32 s29, s29, 1073741824
    s_add_u32 s88, s64, 2
    s_min_u32 s88, s88, 63
    s_and_b32 s89, s64, 1
    s_lshl_b32 s88, s88, 18
    s_lshl_b32 s89, s89, 13
    s_add_u32 s17, s88, s101
    s_add_u32 m0, s89, s85
    buffer_load_dwordx4 v[168:171], v10, s[36:39], s68 offen sc1
    buffer_load_dwordx4 v[172:175], v10, s[36:39], s68 offen offset:512 sc1
    buffer_load_dwordx2 v[176:177], v10, s[36:39], s68 offen offset:1024 sc1
    v_permlane32_swap_b32 v120, v122
    v_permlane32_swap_b32 v121, v123
    v_add_f32 v120, v120, v122
    v_add_f32 v121, v121, v123
    v_cvt_pk_bf16_f32 v120, v120, v121
    ds_write_b32 v5, v120
    s_waitcnt lgkmcnt(0)
    s_barrier
    s_cmp_eq_u32 s64, 63
    s_cbranch_scc1 laststep_81
    ds_read_b32 v140, v9 offset:0
    ds_read_b32 v142, v9 offset:256
    ds_read_b32 v144, v9 offset:512
    ds_read_b32 v146, v9 offset:768
    s_mov_b32 s66, 0
.p2align 5
    s_waitcnt vmcnt(0)
    v_bitop3_b32 v16, v168, v172, s65 bitop3:0x7e
    v_bitop3_b32 v16, v16, v176, s65 bitop3:0xf6
    v_and_b32 v16, 1, v16
    v_cmp_ne_u32 vcc, 0, v16
    s_cbranch_vccnz pair2_83
    v_pk_add_f32 v[160:161], v[160:161], v[168:169]
    v_pk_add_f32 v[162:163], v[162:163], v[170:171]
    v_pk_add_f32 v[164:165], v[164:165], v[172:173]
    v_pk_add_f32 v[166:167], v[166:167], v[174:175]
    v_pk_add_f32 v[156:157], v[156:157], v[176:177]
pairjoin_85:
    v_max3_f32 v16, v160, v161, v162
    v_max3_f32 v17, v163, v164, v165
    v_max3_f32 v16, v166, v167, v16
    v_max3_f32 v17, v156, v157, v17
    v_max_f32 v16, v16, v17
    v_mov_b32 v17, v16
    s_nop 1
    v_permlane16_swap_b32 v16, v17
    v_max_f32 v16, v16, v17
    v_mov_b32 v17, v16
    s_nop 1
    v_permlane32_swap_b32 v16, v17
    v_max_f32 v16, v16, v17
    v_mul_f32 v16, s78, v16
    v_pk_fma_f32 v[160:161], v[160:161], s[78:79], v[16:17] op_sel_hi:[1,1,0] neg_lo:[0,0,1] neg_hi:[0,0,1]
    v_pk_fma_f32 v[162:163], v[162:163], s[78:79], v[16:17] op_sel_hi:[1,1,0] neg_lo:[0,0,1] neg_hi:[0,0,1]
    v_pk_fma_f32 v[164:165], v[164:165], s[78:79], v[16:17] op_sel_hi:[1,1,0] neg_lo:[0,0,1] neg_hi:[0,0,1]
    v_pk_fma_f32 v[166:167], v[166:167], s[78:79], v[16:17] op_sel_hi:[1,1,0] neg_lo:[0,0,1] neg_hi:[0,0,1]
    v_pk_fma_f32 v[156:157], v[156:157], s[78:79], v[16:17] op_sel_hi:[1,1,0] neg_lo:[0,0,1] neg_hi:[0,0,1]
    v_exp_f32 v160, v160
    v_exp_f32 v161, v161
    v_exp_f32 v162, v162
    v_exp_f32 v163, v163
    v_exp_f32 v164, v164
    v_exp_f32 v165, v165
    v_exp_f32 v166, v166
    v_exp_f32 v167, v167
    v_exp_f32 v156, v156
    v_exp_f32 v157, v157
    v_cvt_pk_bf16_f32 v112, v160, v161
    v_cvt_pk_bf16_f32 v113, v162, v163
    v_cvt_pk_bf16_f32 v114, v164, v165
    v_cvt_pk_bf16_f32 v115, v166, v167
    v_cvt_pk_bf16_f32 v116, v156, v157
    s_waitcnt vmcnt(0) lgkmcnt(0)
    v_mfma_f32_16x16x32_bf16 v[184:187], v[24:27], v[112:115], 0
    v_mfma_f32_16x16x32_bf16 v[168:171], v[124:127], v[112:115], 0
    v_mfma_f32_16x16x16_bf16 v[184:187], v[24:25], v[116:117], v[184:187]
    v_mfma_f32_16x16x32_bf16 v[172:175], v[128:131], v[112:115], 0
    v_mfma_f32_16x16x16_bf16 v[168:171], v[140:141], v[116:117], v[168:171]
    v_mfma_f32_16x16x16_bf16 v[172:175], v[142:143], v[116:117], v[172:175]
    v_mfma_f32_16x16x32_bf16 v[176:179], v[132:135], v[112:115], 0
    v_mfma_f32_16x16x32_bf16 v[180:183], v[136:139], v[112:115], 0
    v_mfma_f32_16x16x16_bf16 v[176:179], v[144:145], v[116:117], v[176:179]
    s_nop 1
    v_rcp_f32_e64 v16, v184
    v_mfma_f32_16x16x16_bf16 v[180:183], v[146:147], v[116:117], v[180:183]
    v_pk_mul_f32 v[168:169], v[168:169], v[16:17] op_sel_hi:[1,0]
    v_pk_mul_f32 v[170:171], v[170:171], v[16:17] op_sel_hi:[1,0]
    v_pk_mul_f32 v[172:173], v[172:173], v[16:17] op_sel_hi:[1,0]
    v_pk_mul_f32 v[174:175], v[174:175], v[16:17] op_sel_hi:[1,0]
    v_cvt_pk_bf16_f32 v156, v168, v169
    v_cvt_pk_bf16_f32 v157, v170, v171
    v_cvt_pk_bf16_f32 v158, v172, v173
    v_cvt_pk_bf16_f32 v159, v174, v175
    v_pk_mul_f32 v[176:177], v[176:177], v[16:17] op_sel_hi:[1,0]
    v_pk_mul_f32 v[178:179], v[178:179], v[16:17] op_sel_hi:[1,0]
    v_pk_mul_f32 v[180:181], v[180:181], v[16:17] op_sel_hi:[1,0]
    v_pk_mul_f32 v[182:183], v[182:183], v[16:17] op_sel_hi:[1,0]
    v_cvt_pk_bf16_f32 v160, v176, v177
    v_cvt_pk_bf16_f32 v161, v178, v179
    v_cvt_pk_bf16_f32 v162, v180, v181
    v_cvt_pk_bf16_f32 v163, v182, v183
    v_mfma_f32_16x16x32_bf16 v[32:35], a[240:243], v[156:159], 0
    v_mfma_f32_16x16x32_bf16 v[36:39], a[248:251], v[156:159], 0
    v_mfma_f32_16x16x32_bf16 v[32:35], a[244:247], v[160:163], v[32:35]
    v_mfma_f32_16x16x32_bf16 v[36:39], a[252:255], v[160:163], v[36:39]
    v_mfma_f32_16x16x32_bf16 v[40:43], v[192:195], v[156:159], 0
    v_mfma_f32_16x16x32_bf16 v[44:47], v[200:203], v[156:159], 0
    v_mfma_f32_16x16x32_bf16 v[40:43], v[196:199], v[160:163], v[40:43]
    v_mfma_f32_16x16x32_bf16 v[44:47], v[204:207], v[160:163], v[44:47]
    v_mfma_f32_16x16x32_bf16 v[48:51], v[208:211], v[156:159], 0
    v_mfma_f32_16x16x32_bf16 v[52:55], v[216:219], v[156:159], 0
    v_mfma_f32_16x16x32_bf16 v[48:51], v[212:215], v[160:163], v[48:51]
    v_cvt_pk_bf16_f32 v168, v32, v33
    v_cvt_pk_bf16_f32 v169, v34, v35
    v_mfma_f32_16x16x32_bf16 v[52:55], v[220:223], v[160:163], v[52:55]
    v_cvt_pk_bf16_f32 v170, v36, v37
    v_cvt_pk_bf16_f32 v171, v38, v39
    v_mfma_f32_16x16x32_bf16 v[56:59], v[224:227], v[156:159], 0
    v_and_or_b32 v168, v168, -2, s65
    buffer_store_dwordx4 v[168:171], v12, s[32:35], 0 offen sc1
    v_mfma_f32_16x16x32_bf16 v[60:63], v[232:235], v[156:159], 0
    v_mfma_f32_16x16x32_bf16 v[56:59], v[228:231], v[160:163], v[56:59]
    v_cvt_pk_bf16_f32 v172, v40, v41
    v_cvt_pk_bf16_f32 v173, v42, v43
    v_mfma_f32_16x16x32_bf16 v[60:63], v[236:239], v[160:163], v[60:63]
    v_cvt_pk_bf16_f32 v174, v44, v45
    v_cvt_pk_bf16_f32 v175, v46, v47
    v_mfma_f32_16x16x32_bf16 v[64:67], v[240:243], v[156:159], 0
    v_and_or_b32 v172, v172, -2, s65
    buffer_store_dwordx4 v[172:175], v12, s[32:35], s80 offen sc1
    v_mfma_f32_16x16x32_bf16 v[68:71], v[248:251], v[156:159], 0
    v_mfma_f32_16x16x32_bf16 v[64:67], v[244:247], v[160:163], v[64:67]
    v_cvt_pk_bf16_f32 v168, v48, v49
    v_cvt_pk_bf16_f32 v169, v50, v51
    v_mfma_f32_16x16x32_bf16 v[68:71], v[252:255], v[160:163], v[68:71]
    v_cvt_pk_bf16_f32 v170, v52, v53
    v_cvt_pk_bf16_f32 v171, v54, v55
    v_and_or_b32 v168, v168, -2, s65
    buffer_store_dwordx4 v[168:171], v12, s[32:35], s81 offen sc1
    v_cvt_pk_bf16_f32 v172, v56, v57
    v_cvt_pk_bf16_f32 v173, v58, v59
    v_cvt_pk_bf16_f32 v174, v60, v61
    v_cvt_pk_bf16_f32 v175, v62, v63
    v_and_or_b32 v172, v172, -2, s65
    buffer_store_dwordx4 v[172:175], v12, s[32:35], s82 offen sc1
    v_cvt_pk_bf16_f32 v168, v64, v65
    v_cvt_pk_bf16_f32 v169, v66, v67
    v_cvt_pk_bf16_f32 v170, v68, v69
    v_cvt_pk_bf16_f32 v171, v70, v71
    v_and_or_b32 v168, v168, -2, s65
    buffer_store_dwordx4 v[168:171], v12, s[32:35], s83 offen sc1
    ds_read_b128 v[176:179], v22
    s_cmp_eq_u32 s28, 3
    s_cbranch_scc1 w3_87
    s_cmp_eq_u32 s69, -1
    s_cbranch_scc1 nonowner_88
    s_mov_b32 s66, 0
.p2align 5
    s_waitcnt vmcnt(0)
    v_mov_b32 v112, 0
    v_mov_b32 v113, 0
    v_mov_b32 v114, 0
    v_mov_b32 v115, 0
    v_mov_b32 v116, 0
    v_mov_b32 v117, 0
    v_mov_b32 v118, 0
    v_mov_b32 v119, 0
    v_mov_b32 v120, 0
    v_mov_b32 v121, 0
    v_mov_b32 v122, 0
    v_mov_b32_e64 v123, 0
    buffer_load_dwordx4 v[124:127], v2, s[32:35], s69 offen offset:0 sc1
    buffer_load_dwordx4 v[128:131], v2, s[32:35], s69 offen offset:1024 sc1
    buffer_load_dwordx4 v[132:135], v2, s[32:35], s69 offen offset:2048 sc1
    buffer_load_dwordx4 v[136:139], v2, s[32:35], s69 offen offset:3072 sc1
.p2align 5
    s_waitcnt vmcnt(0)
    v_bitop3_b32 v16, v124, v128, s65 bitop3:0x7e
    v_bitop3_b32 v17, v132, v136, s65 bitop3:0x7e
    v_or_b32 v16, v16, v17
    v_and_b32_e64 v16, 1, v16
    v_cmp_ne_u32 vcc, 0, v16
    s_cbranch_vccnz rs2_89
    v_mfma_f32_16x16x32_bf16 v[184:187], v[28:31], v[124:127], 0
    v_mfma_f32_16x16x32_bf16 v[184:187], v[28:31], v[128:131], v[184:187]
    v_mfma_f32_16x16x32_bf16 v[184:187], v[28:31], v[132:135], v[184:187]
    v_mfma_f32_16x16x32_bf16 v[184:187], v[28:31], v[136:139], v[184:187]
rsjoin_91:
    s_nop 7
    s_nop 0
    v_add_f32_dpp v184, v184, v184 row_ror:8 row_mask:0xf bank_mask:0xf
    v_add_f32_dpp v185, v185, v185 row_ror:8 row_mask:0xf bank_mask:0xf
    v_add_f32_dpp v186, v186, v186 row_ror:8 row_mask:0xf bank_mask:0xf
    v_add_f32_dpp v187, v187, v187 row_ror:8 row_mask:0xf bank_mask:0xf
    v_cvt_pk_bf16_f32 v168, v184, v185
    v_cvt_pk_bf16_f32 v169, v186, v187
    s_add_u32 s88, s71, s19
    buffer_store_dwordx2 v[168:169], v13, s[40:43], s88 offen sc1
agbar_86:
    s_mov_b32 s10, s64
    s_mov_b32 s66, 0
    s_add_u32 s97, s72, s19
    s_add_u32 s98, s97, 32768
    s_branch step_78
w3_87:
    v_mov_b32 v112, 0
    v_mov_b32 v113, 0
    v_mov_b32 v114, 0
    v_mov_b32 v115, 0
    v_mov_b32 v116, 0
    v_mov_b32 v117, 0
    v_mov_b32 v118, 0
    v_mov_b32 v119, 0
    v_mov_b32 v120, 0
    v_mov_b32 v121, 0
    v_mov_b32 v122, 0
    v_mov_b32 v123, 0
    s_add_u32 s94, s64, 2
    s_min_u32 s94, s94, 63
    s_lshr_b32 s88, s94, 2
    s_add_u32 s88, s88, 1
    s_min_u32 s88, s88, 16
    s_cmp_ge_u32 s87, s88
    s_cbranch_scc1 w1ok_92
    v_mov_b32 v16, 0
    s_mov_b32 s66, 0
w1poll_93:
    buffer_load_dwordx4 v[144:147], v16, s[60:63], s8 offen sc1
    buffer_load_dwordx4 v[140:143], v16, s[60:63], s9 offen sc1
    s_waitcnt vmcnt(0)
    v_min3_u32 v17, v144, v145, v146
    v_min3_u32 v17, v147, v140, v17
    v_min3_u32 v17, v141, v142, v17
    v_min_u32 v17, v143, v17
    s_nop 0
    v_readfirstlane_b32 s87, v17
    s_cmp_ge_u32 s87, s88
    s_cbranch_scc1 w1ok_92
    s_add_u32 s66, s66, 1
    s_cmp_lt_u32 s66, 400000
    s_cbranch_scc1 w1poll_93
    s_branch k_fail
w1ok_92:
    s_branch agbar_86
laststep_81:
    s_waitcnt vmcnt(0)
    ds_read_b128 v[176:179], v22
    s_waitcnt lgkmcnt(0)
    buffer_store_dwordx4 v[176:179], v21, s[44:47], s100 offen sc1
    s_add_u32 s100, s100, s74
    s_waitcnt vmcnt(0)
    s_barrier
    s_cmp_eq_u32 s28, 0
    s_cbranch_scc0 lastflag_94
    v_mov_b32 v16, 64
    v_mov_b32 v17, s96
    s_mov_b64 exec, 1
    buffer_store_dword v16, v17, s[60:63], 0 offen sc1
    s_mov_b64 exec, -1
lastflag_94:
    s_waitcnt vmcnt(0)
    s_branch k_exit
ag_retry_80:
    s_add_u32 s66, s66, 1
    s_cmp_lt_u32 s66, 400000
    s_cbranch_scc0 k_fail
    s_branch ag_79
pair2_83:
    buffer_load_dwordx4 v[178:181], v10, s[36:39], s68 offen sc1
    buffer_load_dwordx4 v[182:185], v10, s[36:39], s68 offen offset:512 sc1
    buffer_load_dwordx2 v[186:187], v10, s[36:39], s68 offen offset:1024 sc1
    s_waitcnt vmcnt(0)
pair2chk_95:
    v_bitop3_b32 v16, v178, v182, s65 bitop3:0x7e
    v_bitop3_b32 v16, v16, v186, s65 bitop3:0xf6
    v_and_b32 v16, 1, v16
    v_cmp_ne_u32 vcc, 0, v16
    s_cbranch_vccnz pair3_84
    v_pk_add_f32 v[160:161], v[160:161], v[178:179]
    v_pk_add_f32 v[162:163], v[162:163], v[180:181]
    v_pk_add_f32 v[164:165], v[164:165], v[182:183]
    v_pk_add_f32 v[166:167], v[166:167], v[184:185]
    v_pk_add_f32 v[156:157], v[156:157], v[186:187]
    s_branch pairjoin_85
pair3_84:
    s_add_u32 s66, s66, 1
    s_cmp_lt_u32 s66, 400000
    s_cbranch_scc0 k_fail
    buffer_load_dwordx4 v[178:181], v10, s[36:39], s68 offen sc1
    buffer_load_dwordx4 v[182:185], v10, s[36:39], s68 offen offset:512 sc1
    buffer_load_dwordx2 v[186:187], v10, s[36:39], s68 offen offset:1024 sc1
    s_waitcnt vmcnt(0)
    s_branch pair2chk_95
nonowner_88:
    v_mov_b32 v112, 0
    v_mov_b32 v113, 0
    v_mov_b32 v114, 0
    v_mov_b32 v115, 0
    v_mov_b32 v116, 0
    v_mov_b32 v117, 0
    v_mov_b32 v118, 0
    v_mov_b32 v119, 0
    v_mov_b32 v120, 0
    v_mov_b32 v121, 0
    v_mov_b32 v122, 0
    v_mov_b32 v123, 0
    s_branch agbar_86
rs2_89:
    buffer_load_dwordx4 v[140:143], v2, s[32:35], s69 offen offset:0 sc1
    buffer_load_dwordx4 v[144:147], v2, s[32:35], s69 offen offset:1024 sc1
    buffer_load_dwordx4 v[148:151], v2, s[32:35], s69 offen offset:2048 sc1
    buffer_load_dwordx4 v[152:155], v2, s[32:35], s69 offen offset:3072 sc1
    s_waitcnt vmcnt(0)
rs2chk_96:
    v_bitop3_b32 v16, v140, v144, s65 bitop3:0x7e
    v_bitop3_b32 v17, v148, v152, s65 bitop3:0x7e
    v_or_b32 v16, v16, v17
    v_and_b32_e64 v16, 1, v16
    v_cmp_ne_u32 vcc, 0, v16
    s_cbranch_vccnz rs3_90
    v_mfma_f32_16x16x32_bf16 v[184:187], v[28:31], v[140:143], 0
    v_mfma_f32_16x16x32_bf16 v[184:187], v[28:31], v[144:147], v[184:187]
    v_mfma_f32_16x16x32_bf16 v[184:187], v[28:31], v[148:151], v[184:187]
    v_mfma_f32_16x16x32_bf16 v[184:187], v[28:31], v[152:155], v[184:187]
    s_branch rsjoin_91
rs3_90:
    s_add_u32 s66, s66, 1
    s_cmp_lt_u32 s66, 400000
    s_cbranch_scc0 k_fail
    buffer_load_dwordx4 v[140:143], v2, s[32:35], s69 offen offset:0 sc1
    buffer_load_dwordx4 v[144:147], v2, s[32:35], s69 offen offset:1024 sc1
    buffer_load_dwordx4 v[148:151], v2, s[32:35], s69 offen offset:2048 sc1
    buffer_load_dwordx4 v[152:155], v2, s[32:35], s69 offen offset:3072 sc1
    s_waitcnt vmcnt(0)
    s_branch rs2chk_96
k_fail:
    v_mov_b32 v1, 252
    v_mov_b32 v2, 0xdead
    s_mov_b64 exec, 1
    global_store_dword v1, v2, s[24:25] sc1
    s_waitcnt vmcnt(0)
k_exit:
    s_endpgm

.section .rodata,"a"
.p2align 6
.amdhsa_kernel concat_heads__memory_aug_recurrent_mem_tr__linear_attn_block__prompt_kernel
  .amdhsa_next_free_vgpr 512
  .amdhsa_next_free_sgpr 102
  .amdhsa_accum_offset 256
  .amdhsa_group_segment_fixed_size 0
  .amdhsa_kernarg_size 104
  .amdhsa_user_sgpr_count 2
  .amdhsa_user_sgpr_kernarg_segment_ptr 1
  .amdhsa_system_sgpr_workgroup_id_x 1
  .amdhsa_float_denorm_mode_32 3
.end_amdhsa_kernel
```
